```python
import torch

def _softmax(x, axis=-1):
    return torch.softmax(x, dim=axis)
def _gelu(x):
    return torch.nn.functional.gelu(x, approximate="tanh")
def _silu(x):
    return torch.nn.functional.silu(x)
def _sigmoid(x):
    return torch.sigmoid(x)
def _layernorm(x, axis=-1, eps=1e-5):
    m = x.mean(dim=axis, keepdim=True)
    v = x.var(dim=axis, keepdim=True, unbiased=False)
    return (x - m) / torch.sqrt(v + eps)
def _scatter_add(tgt, idx, src, axis=0):
    return tgt.clone().index_add_(axis, idx, src)
def _segment_sum(src, seg, n):
    out = torch.zeros((n,) + src.shape[1:], dtype=src.dtype)
    return out.index_add_(0, seg, src)
def _pad(x, pw):
    flat = tuple(v for pair in reversed(pw) for v in pair)
    return torch.nn.functional.pad(x, flat)

kernel_name = 'sequential_preLN__sliding_local_dilated__glu_gated_swiglu__prompt'

def setup_inputs():

    _w = (lambda a: (lambda t: t.to(torch.bfloat16) if t.is_floating_point() else t)(torch.as_tensor(a)))
    def _A_setup():
        B, S, D = 1, 2048, 640
        return {
            "x": _w((lambda *s: torch.randn(*s, dtype=torch.bfloat16) * 0.05)(B, S, D)),
            "wqkv": _w((lambda *s: torch.randn(*s, dtype=torch.bfloat16) * 0.05)(D, 3 * D)),
            "wo": _w((lambda *s: torch.randn(*s, dtype=torch.bfloat16) * 0.05)(D, D)),
        }
    _A_in = _A_setup()

    def _B_setup():
        B, S, D, F = 1, 2048, 640, 1536
        return {
            "x": _w((lambda *s: torch.randn(*s, dtype=torch.bfloat16) * 0.05)(B, S, D)),
            "w1": _w((lambda *s: torch.randn(*s, dtype=torch.bfloat16) * 0.8)(D, F) * (2.0 / D) ** 0.5),
            "w3": _w((lambda *s: torch.randn(*s, dtype=torch.bfloat16) * 0.8)(D, F) * (2.0 / D) ** 0.5),
            "w2": _w((lambda *s: torch.randn(*s, dtype=torch.bfloat16) * 0.8)(F, D) * (2.0 / F) ** 0.5),
        }
    _B_in = _B_setup()

    return {
        "A_x": _A_in["x"],
        "A_wqkv": _A_in["wqkv"],
        "A_wo": _A_in["wo"],
        "B_x": _B_in["x"],
        "B_w1": _B_in["w1"],
        "B_w3": _B_in["w3"],
        "B_w2": _B_in["w2"],
    }

def reference(A_x, A_wqkv, A_wo, B_x, B_w1, B_w3, B_w2):
    def _A_ref(x, wqkv, wo):
        B, S, D = x.shape
        H = 32; Dh = D // H
        W, dil = 8, 2
        qkv = (lambda x, *d: x.permute(*d))((x @ wqkv).reshape(B, S, 3, H, Dh), 2, 0, 3, 1, 4)
        q, k, v = qkv[0], qkv[1], qkv[2]
        scale = Dh ** -0.5
        pos = torch.arange(S)
        off = torch.arange(W) * dil
        idx = pos[:, None] - off[None, :]
        mask = idx >= 0
        idx_c = torch.where(mask, idx, 0).reshape(-1)
        kg = k[:, :, idx_c, :].reshape(B, H, S, W, Dh)
        vg = v[:, :, idx_c, :].reshape(B, H, S, W, Dh)
        logits = torch.einsum("bhsd,bhswd->bhsw", q, kg) * scale
        logits = torch.where(mask[None, None, :, :], logits, -1e9)
        attn = _softmax(logits, axis=-1)
        o = torch.einsum("bhsw,bhswd->bhsd", attn, vg)
        return (lambda x, *d: x.permute(*d))(o, 0, 2, 1, 3).reshape(B, S, D) @ wo

    def _B_ref(x, w1, w3, w2):
        gate = torch.einsum("bsd,df->bsf", x, w1)
        up = torch.einsum("bsd,df->bsf", x, w3)
        h = _silu(gate) * up
        out = torch.einsum("bsf,fd->bsd", h, w2)
        return out

    x = A_x
    h = x + _A_ref(_layernorm(x, axis=-1), A_wqkv, A_wo)
    h2 = h + _B_ref(_layernorm(h, axis=-1), B_w1, B_w3, B_w2)
    return h2
```

```asm
; @launch grid=(256,1,1) block=(512,1,1) lds=163840
.amdgcn_target "amdgcn-amd-amdhsa--gfx950"
.text
.globl sequential_preLN__sliding_local_dilated__glu_gated_swiglu__prompt_kernel
.p2align 12
.p2align 8
.type sequential_preLN__sliding_local_dilated__glu_gated_swiglu__prompt_kernel,@function
sequential_preLN__sliding_local_dilated__glu_gated_swiglu__prompt_kernel:
    s_cmp_ge_u32 s2, 256
    s_cbranch_scc1 L_end
    s_load_dwordx16 s[64:79], s[0:1], 0
    s_load_dwordx4 s[80:83], s[0:1], 64
    v_lshrrev_b32 v1, 6, v0
    s_and_b32 s41, s2, 7
    s_lshr_b32 s42, s2, 3
    v_readfirstlane_b32 s40, v1
    v_and_b32 v1, 63, v0
    v_lshrrev_b32 v3, 4, v1
    s_cmp_lg_u32 s40, 2
    s_cbranch_scc1 L_noct
    s_getpc_b64 s[48:49]
L_pc:
    s_mul_i32 s50, s42, 13*128
    v_lshl_add_u32 v4, v1, 7, s50
    v_min_u32 v4, L_end-L_pc, v4
    s_bfm_b64 exec, 13, 0
    global_load_dword v26, v4, s[48:49]
    s_mov_b64 exec, -1
L_noct:
    s_cmp_lt_u32 s40, 4
    s_cbranch_scc1 L_c0
    s_mov_b32 s3, 1
    s_cmp_ge_u32 s42, 30
    s_cbranch_scc1 L_h0
    s_mul_i32 s43, s42, 26
    s_lshr_b32 s43, s43, 8
    s_mul_i32 s48, s43, 10
    s_sub_u32 s44, s42, s48
    s_lshl_b32 s62, s41, 8
    s_mul_i32 s48, s43, 88
    s_add_u32 s62, s62, s48
    s_and_b32 s60, s40, 3
    s_lshl_b32 s46, s60, 10
    s_mov_b32 s6, 2621440
    s_mov_b32 s7, 0x20000
    s_mov_b32 s10, 2457600
    s_mov_b32 s11, 0x20000
L_ld0:
    s_setprio 2
    v_lshrrev_b32 v4, 3, v1
    v_and_b32 v5, 7, v1
    s_and_b32 s48, s60, 1
    s_lshl_b32 s48, s48, 2
    v_and_b32 v57, 1, v3
    v_lshlrev_b32 v57, 1, v57
    v_or_b32 v57, s48, v57
    v_xor_b32 v42, v57, v5
    s_lshl_b32 s49, s44, 7
    v_lshl_add_u32 v13, v42, 4, s49
    s_lshl_b32 s49, s60, 3
    s_add_u32 s56, s62, s49
    s_sub_u32 s56, s56, 16
    v_add_u32 v57, s56, v4
    s_movk_i32 s57, 1280
    v_mul_lo_u32 v57, v57, s57
    v_or_b32 v58, s48, v3
    v_xor_b32 v58, v58, v5
    v_lshl_add_u32 v6, v58, 4, v57
    v_add_u32 v7, 40960, v6
    v_add_u32 v8, 81920, v6
    s_add_u32 s56, s62, 80
    v_add_u32_e64 v57, s56, v4
    v_mul_lo_u32 v57, v57, s57
    v_xor_b32_e64 v58, v3, v5
    v_lshl_add_u32 v9, v58, 4, v57
    v_add_u32 v57, s49, v4
    s_movk_i32 s57, 3840
    v_mad_u32_u24 v10, v57, s57, v13
    s_lshl_b32 s49, s60, 4
    s_bfm_b64 s[52:53], 16, s49
    s_mul_i32 s88, s41, 10
    s_lshr_b32 s88, s88, 3
    s_add_u32 s88, s88, 8
    s_add_u32 s88, s88, s44
    s_mov_b32 s89, 0x12492492
    s_waitcnt lgkmcnt(0)
    s_mov_b64 s[4:5], s[64:65]
    s_mov_b64 s[8:9], s[66:67]
    s_bfe_u32 s59, s89, 0x30000
    s_add_u32 s59, s59, s88
    s_add_u32 s59, s59, 0
    s_mul_i32 s56, s59, 26
    s_lshr_b32 s56, s56, 8
    s_mul_i32 s56, s56, 10
    s_sub_u32 s59, s59, s56
    s_lshl_b32 s56, s59, 7
    s_mul_i32 s57, s59, 245760
    s_add_u32 s58, s57, 122880
    s_add_u32 m0, s46, 57344
    s_nop 0
    buffer_load_dwordx4 v10, s[8:11], s57 offen offset:0 lds
    s_add_u32 m0, s46, 0
    s_nop 0
    buffer_load_dwordx4 v6, s[4:7], s56 offen nt lds
    s_add_u32 m0, s46, 64256
    s_nop 0
    buffer_load_dwordx4 v10, s[8:11], s57 offen offset:1280 lds
    s_add_u32 m0, s46, 71168
    s_nop 0
    buffer_load_dwordx4 v10, s[8:11], s57 offen offset:2560 lds
    s_add_u32 m0, s46, 4096
    s_nop 0
    buffer_load_dwordx4 v7, s[4:7], s56 offen nt lds
    s_add_u32 m0, s46, 61440
    s_nop 0
    buffer_load_dwordx4 v10, s[8:11], s58 offen offset:0 lds
    s_add_u32 m0, s46, 68352
    s_nop 0
    buffer_load_dwordx4 v10, s[8:11], s58 offen offset:1280 lds
    s_add_u32 m0, s46, 8192
    s_nop 0
    buffer_load_dwordx4 v8, s[4:7], s56 offen nt lds
    s_add_u32 m0, s46, 75264
    s_nop 0
    buffer_load_dwordx4 v10, s[8:11], s58 offen offset:2560 lds
    s_mov_b32 m0, 12288
    s_mov_b64 exec, s[52:53]
    buffer_load_dwordx4 v9, s[4:7], s56 offen nt lds
    s_mov_b64 exec, -1
    v_and_b32 v2, 15, v0
    s_sub_u32 s48, s44, 5
    s_cmp_ge_u32 s44, 5
    s_cselect_b32 s45, s48, s44
    s_cmp_eq_u32 s43, 2
    s_cselect_b32 s54, 40, 44
    s_lshl_b32 s55, s42, 3
    s_add_u32 s55, s55, 1327104
    s_getreg_b32 s63, hwreg(HW_REG_XCC_ID)
    s_and_b32 s63, s63, 7
    s_mov_b32 s47, 1
    s_lshl_b32 s61, s41, 21
    s_nop 0
    s_mov_b32 s14, 819200
    s_mov_b32 s15, 0x20000
    s_mov_b32 s18, 1966080
    s_mov_b32 s19, 0x20000
    s_mov_b32 s22, 1966080
    s_mov_b32 s23, 0x20000
    s_mov_b32 s26, 1966080
    s_mov_b32 s27, 0x20000
    s_mov_b32 s30, 2621440
    s_mov_b32 s31, 0x20000
    s_mov_b32 s34, 2097152
    s_mov_b32 s35, 0x20000
    s_mov_b32 s38, 256
    s_mov_b32 s39, 0x20000
    s_mov_b32 s94, 3948544
    s_mov_b32 s95, 0x20000
    s_mov_b64 s[12:13], s[68:69]
    s_mov_b64 s[16:17], s[72:73]
    s_mov_b64 s[20:21], s[74:75]
    s_mov_b64 s[24:25], s[76:77]
    s_mov_b64 s[28:29], s[78:79]
    s_mov_b64 s[36:37], s[80:81]
    s_add_u32 s32, s82, s61
    s_addc_u32 s33, s83, 0
    s_add_u32 s92, s82, 16777216
    s_addc_u32 s93, s83, 0
    s_lshl_b32 s83, s41, 5
    s_mul_i32 s48, s42, 5120
    s_mul_i32 s49, s60, 1280
    s_add_u32 s48, s48, s49
    s_add_u32 s48, s48, 1155072
    v_lshl_add_u32 v25, v1, 4, s48
    s_mul_i32 s48, s41, 30
    s_add_u32 s48, s48, s42
    s_lshl_b32 s48, s48, 1
    s_and_b32 s49, s60, 1
    s_add_u32 s48, s48, s49
    s_lshl_b32 s48, s48, 7
    s_add_u32 s48, s48, 1474560
    s_cmp_lt_u32 s60, 2
    s_cselect_b32 s98, s16, s20
    s_cselect_b32 s99, s17, s21
    s_add_u32 s98, s98, s48
    s_addc_u32 s99, s99, 0
    v_mov_b32 v92, -1
    v_mov_b32 v93, -1
    v_mov_b32 v94, -1
    v_mov_b32 v95, -1
    v_lshrrev_b32 v57, 5, v1
    v_and_b32 v56, 3, v4
    s_movk_i32 s49, 1280
    v_mad_u32_u24 v12, v4, s49, v13
    s_movk_i32 s48, 80
    v_mad_u32_u24 v58, v57, s48, v56
    v_mad_u32_u24 v55, v58, s49, v13
    v_lshl_add_u32 v58, v57, 4, v56
    v_mad_u32_u24 v14, v58, s49, v13
    s_lshr_b32 s48, s60, 1
    s_mul_i32 s73, s48, 25600
    s_and_b32 s48, s60, 1
    s_mul_i32 s48, s48, 10240
    s_add_u32 s73, s73, s48
    s_nop 0
    s_mul_i32 s74, s60, 25600
    s_add_u32 s74, s74, 20480
    s_mul_i32 s80, s60, 5120
    s_mul_i32 s81, s60, 10240
    s_mul_i32 s75, s60, 2816
    s_bfm_b64 s[76:77], 48, 0
    s_lshr_b32 s65, s40, 2
    s_xor_b32 s64, s40, s65
    s_and_b32 s64, s64, 3
    s_mul_i32 s66, s45, 3
    s_add_u32 s66, s66, s64
    s_mul_i32 s67, s66, 40
    s_lshl_b32 s48, s45, 7
    s_sub_u32 s67, s67, s48
    s_add_u32 s67, s67, 53264
    s_cmp_ge_u32 s44, 5
    s_cselect_b32 s48, 16, 0
    s_add_u32 s66, s66, s48
    s_mul_i32 s48, s65, 25800
    s_add_u32 s67, s67, s48
    s_cmp_lt_u32 s45, 2
    s_cselect_b32 s48, 3, 0
    s_cmp_eq_u32 s45, 2
    s_cselect_b32 s48, 9, s48
    s_cmp_lg_u32 s64, s48
    s_cselect_b32 s68, 1, 0
    v_lshlrev_b32 v60, 2, v3
    v_and_b32 v59, 40, v1
    v_cmp_eq_u32 vcc, 8, v59
    v_add_u32 v59, 16, v60
    s_nop 0
    v_cndmask_b32 v60, v60, v59, vcc
    v_sub_u32 v59, v2, v60
    v_mov_b32 v58, 0xf149f2ca
    s_or_b32 s48, s41, s43
    s_cmp_eq_u32 s48, 0
    s_cselect_b32 s48, 8, 0
    v_add_u32 v57, 8, v59
    v_cmp_gt_u32 vcc, 8, v57
    s_nop 1
    v_cndmask_b32 v224, v58, 0, vcc
    v_add_u32 v57, 0, v60
    v_cmp_gt_u32 vcc, s48, v57
    s_nop 1
    v_cndmask_b32 v228, v224, v58, vcc
    v_mov_b32 v236, 0x3f803f80
    v_add_u32 v57, 7, v59
    v_cmp_gt_u32 vcc, 8, v57
    s_nop 1
    v_cndmask_b32 v225, v58, 0, vcc
    v_add_u32 v57, 1, v60
    v_cmp_gt_u32 vcc, s48, v57
    s_nop 1
    v_cndmask_b32_e64 v229, v225, v58, vcc
    v_mov_b32 v237, 0x3f803f80
    v_add_u32 v57, 6, v59
    v_cmp_gt_u32 vcc, 8, v57
    s_nop 1
    v_cndmask_b32 v226, v58, 0, vcc
    v_add_u32 v57, 2, v60
    v_cmp_gt_u32 vcc, s48, v57
    s_nop 1
    v_cndmask_b32_e64 v230, v226, v58, vcc
    v_mov_b32 v238, 0x3f803f80
    v_add_u32 v57, 5, v59
    v_cmp_gt_u32 vcc, 8, v57
    s_nop 1
    v_cndmask_b32 v227, v58, 0, vcc
    v_add_u32 v57, 3, v60
    v_cmp_gt_u32 vcc, s48, v57
    s_nop 1
    v_cndmask_b32_e64 v231, v227, v58, vcc
    v_mov_b32 v239, 0x3f803f80
    s_movk_i32 s48, 496
    s_branch L_ldloop
L_helper:
    s_cmp_lg_u32 s40, 2
    s_cbranch_scc1 L_helper2
    s_waitcnt vmcnt(0)
L_helper2:
    s_lshl_b32 s64, s41, 1
    s_add_u32 s64, s64, s42
    s_sub_u32 s64, s64, 30
    v_lshlrev_b32 v4, 7, v1
    s_lshl_b32 s65, s40, 4
    s_add_u32 s65, s65, s64
    s_lshl_b32 s49, s65, 13
    buffer_load_dword v10, v4, s[12:15], s49 offen
    s_cmp_lt_u32 s64, 8
    s_cselect_b32 s96, s16, s20
    s_cselect_b32 s97, s17, s21
    s_mov_b32 s98, 1966080
    s_mov_b32 s99, 0x20000
    v_lshrrev_b32 v5, 3, v1
    v_and_b32 v6, 7, v1
    s_lshl_b32 s48, s40, 3
    v_add_u32 v7, s48, v5
    s_movk_i32 s48, 3072
    v_mul_u32_u24 v5, s48, v7
    s_and_b32 s50, s64, 7
    s_mul_i32 s48, s50, 384
    v_lshl_add_u32 v5, v6, 4, v5
    v_add_u32_e64 v5, s48, v5
    s_mul_i32 s48, s50, 491520
    s_add_u32 s48, s48, 16384
    s_lshr_b32 s49, s64, 3
    v_mul_u32_u24 v13, 384, v7
    v_add_u32 v13, s48, v13
    s_lshl_b32 s48, s49, 7
    v_lshl_add_u32 v15, v6, 4, v13
    v_add_u32 v15, s48, v15
    v_lshrrev_b32_e64 v14, 2, v6
    v_mul_u32_u24 v14, 245760, v14
    v_add_u32 v14, v14, v13
    v_and_b32 v13, 3, v6
    v_lshl_add_u32 v14, v13, 4, v14
    s_lshl_b32 s48, s49, 6
    s_add_u32 s48, s48, 256
    v_add_u32 v14, s48, v14
    s_mov_b32 s48, 0
    s_nop 0
    buffer_load_dwordx4 v[64:67], v5, s[96:99], s48 offen offset:0
    buffer_load_dwordx4 v[68:71], v5, s[96:99], s48 offen offset:128
    buffer_load_dwordx4 v[72:75], v5, s[96:99], s48 offen offset:256
    s_mov_b32 s48, 196608
    buffer_load_dwordx4 v[76:79], v5, s[96:99], s48 offen offset:0
    buffer_load_dwordx4 v[80:83], v5, s[96:99], s48 offen offset:128
    buffer_load_dwordx4 v[84:87], v5, s[96:99], s48 offen offset:256
    v_mov_b32 v8, 0x3f80
    v_mov_b32 v9, 0x3f800000
    v_mov_b32 v16, 0
    v_mov_b32 v17, 0
    v_mov_b32 v18, 0
    v_mov_b32 v19, 0
    v_mov_b32 v20, 0
    v_mov_b32 v21, 0
    v_mov_b32 v22, 0
    v_mov_b32 v23, 0
    v_mov_b32 v24, 0
    v_mov_b32 v25, 0
    v_mov_b32 v26, 0
    v_mov_b32 v27, 0
    v_mov_b32 v28, 0
    v_mov_b32 v29, 0
    v_mov_b32 v30, 0
    v_mov_b32 v31, 0
    v_mov_b32 v32, 0
    v_mov_b32 v33, 0
    v_mov_b32 v34, 0
    v_mov_b32 v35, 0
    v_mov_b32 v36, 0
    v_mov_b32 v37, 0
    v_mov_b32 v38, 0
    v_mov_b32 v39, 0
    s_waitcnt vmcnt(3)
    s_mov_b32 s48, 393216
    buffer_load_dwordx4 v[88:91], v5, s[96:99], s48 offen offset:0
    buffer_load_dwordx4 v[92:95], v5, s[96:99], s48 offen offset:128
    buffer_load_dwordx4 v[96:99], v5, s[96:99], s48 offen offset:256
    v_dot2c_f32_bf16 v16, v64, v8
    v_dot2c_f32_bf16 v17, v64, v9
    v_dot2c_f32_bf16 v18, v65, v8
    v_dot2c_f32_bf16 v19, v65, v9
    v_dot2c_f32_bf16 v20, v66, v8
    v_dot2c_f32_bf16 v21, v66, v9
    v_dot2c_f32_bf16 v22, v67, v8
    v_dot2c_f32_bf16 v23, v67, v9
    v_dot2c_f32_bf16 v24, v68, v8
    v_dot2c_f32_bf16 v25, v68, v9
    v_dot2c_f32_bf16 v26, v69, v8
    v_dot2c_f32_bf16 v27, v69, v9
    v_dot2c_f32_bf16 v28, v70, v8
    v_dot2c_f32_bf16 v29, v70, v9
    v_dot2c_f32_bf16 v30, v71, v8
    v_dot2c_f32_bf16 v31, v71, v9
    v_dot2c_f32_bf16 v32, v72, v8
    v_dot2c_f32_bf16 v33, v72, v9
    v_dot2c_f32_bf16 v34, v73, v8
    v_dot2c_f32_bf16 v35, v73, v9
    v_dot2c_f32_bf16 v36, v74, v8
    v_dot2c_f32_bf16 v37, v74, v9
    v_dot2c_f32_bf16 v38, v75, v8
    v_dot2c_f32_bf16 v39, v75, v9
    s_waitcnt vmcnt(3)
    s_mov_b32 s48, 589824
    buffer_load_dwordx4 v[100:103], v5, s[96:99], s48 offen offset:0
    buffer_load_dwordx4 v[104:107], v5, s[96:99], s48 offen offset:128
    buffer_load_dwordx4 v[108:111], v5, s[96:99], s48 offen offset:256
    v_dot2c_f32_bf16 v16, v76, v8
    v_dot2c_f32_bf16 v17, v76, v9
    v_dot2c_f32_bf16 v18, v77, v8
    v_dot2c_f32_bf16 v19, v77, v9
    v_dot2c_f32_bf16 v20, v78, v8
    v_dot2c_f32_bf16 v21, v78, v9
    v_dot2c_f32_bf16 v22, v79, v8
    v_dot2c_f32_bf16 v23, v79, v9
    v_dot2c_f32_bf16 v24, v80, v8
    v_dot2c_f32_bf16 v25, v80, v9
    v_dot2c_f32_bf16 v26, v81, v8
    v_dot2c_f32_bf16 v27, v81, v9
    v_dot2c_f32_bf16 v28, v82, v8
    v_dot2c_f32_bf16 v29, v82, v9
    v_dot2c_f32_bf16 v30, v83, v8
    v_dot2c_f32_bf16 v31, v83, v9
    v_dot2c_f32_bf16 v32, v84, v8
    v_dot2c_f32_bf16 v33, v84, v9
    v_dot2c_f32_bf16 v34, v85, v8
    v_dot2c_f32_bf16 v35, v85, v9
    v_dot2c_f32_bf16 v36, v86, v8
    v_dot2c_f32_bf16 v37, v86, v9
    v_dot2c_f32_bf16 v38, v87, v8
    v_dot2c_f32_bf16 v39, v87, v9
    s_waitcnt vmcnt(3)
    s_mov_b32 s48, 786432
    buffer_load_dwordx4 v[112:115], v5, s[96:99], s48 offen offset:0
    buffer_load_dwordx4 v[116:119], v5, s[96:99], s48 offen offset:128
    buffer_load_dwordx4 v[120:123], v5, s[96:99], s48 offen offset:256
    v_dot2c_f32_bf16 v16, v88, v8
    v_dot2c_f32_bf16 v17, v88, v9
    v_dot2c_f32_bf16 v18, v89, v8
    v_dot2c_f32_bf16 v19, v89, v9
    v_dot2c_f32_bf16 v20, v90, v8
    v_dot2c_f32_bf16 v21, v90, v9
    v_dot2c_f32_bf16 v22, v91, v8
    v_dot2c_f32_bf16 v23, v91, v9
    v_dot2c_f32_bf16 v24, v92, v8
    v_dot2c_f32_bf16 v25, v92, v9
    v_dot2c_f32_bf16 v26, v93, v8
    v_dot2c_f32_bf16 v27, v93, v9
    v_dot2c_f32_bf16 v28, v94, v8
    v_dot2c_f32_bf16 v29, v94, v9
    v_dot2c_f32_bf16 v30, v95, v8
    v_dot2c_f32_bf16 v31, v95, v9
    v_dot2c_f32_bf16 v32, v96, v8
    v_dot2c_f32_bf16 v33, v96, v9
    v_dot2c_f32_bf16 v34, v97, v8
    v_dot2c_f32_bf16 v35, v97, v9
    v_dot2c_f32_bf16 v36, v98, v8
    v_dot2c_f32_bf16 v37, v98, v9
    v_dot2c_f32_bf16 v38, v99, v8
    v_dot2c_f32_bf16 v39, v99, v9
    s_waitcnt vmcnt(3)
    s_mov_b32 s48, 983040
    buffer_load_dwordx4 v[124:127], v5, s[96:99], s48 offen offset:0
    buffer_load_dwordx4 v[128:131], v5, s[96:99], s48 offen offset:128
    buffer_load_dwordx4 v[132:135], v5, s[96:99], s48 offen offset:256
    v_dot2c_f32_bf16 v16, v100, v8
    v_dot2c_f32_bf16 v17, v100, v9
    v_dot2c_f32_bf16 v18, v101, v8
    v_dot2c_f32_bf16 v19, v101, v9
    v_dot2c_f32_bf16 v20, v102, v8
    v_dot2c_f32_bf16 v21, v102, v9
    v_dot2c_f32_bf16 v22, v103, v8
    v_dot2c_f32_bf16 v23, v103, v9
    v_dot2c_f32_bf16 v24, v104, v8
    v_dot2c_f32_bf16 v25, v104, v9
    v_dot2c_f32_bf16 v26, v105, v8
    v_dot2c_f32_bf16 v27, v105, v9
    v_dot2c_f32_bf16 v28, v106, v8
    v_dot2c_f32_bf16 v29, v106, v9
    v_dot2c_f32_bf16 v30, v107, v8
    v_dot2c_f32_bf16 v31, v107, v9
    v_dot2c_f32_bf16 v32, v108, v8
    v_dot2c_f32_bf16 v33, v108, v9
    v_dot2c_f32_bf16 v34, v109, v8
    v_dot2c_f32_bf16 v35, v109, v9
    v_dot2c_f32_bf16 v36, v110, v8
    v_dot2c_f32_bf16 v37, v110, v9
    v_dot2c_f32_bf16 v38, v111, v8
    v_dot2c_f32_bf16 v39, v111, v9
    s_waitcnt vmcnt(3)
    s_mov_b32 s48, 1179648
    buffer_load_dwordx4 v[136:139], v5, s[96:99], s48 offen offset:0
    buffer_load_dwordx4 v[140:143], v5, s[96:99], s48 offen offset:128
    buffer_load_dwordx4 v[144:147], v5, s[96:99], s48 offen offset:256
    s_mov_b32 s49, 98304
    s_mov_b32 s51, 344064
    buffer_store_dwordx4 v[116:119], v14, s[92:95], s49 offen sc1
    buffer_store_dwordx4 v[112:115], v15, s[92:95], s49 offen sc1
    buffer_store_dwordx4 v[120:123], v15, s[92:95], s51 offen sc1
    v_dot2c_f32_bf16 v16, v112, v8
    v_dot2c_f32_bf16 v17, v112, v9
    v_dot2c_f32_bf16 v18, v113, v8
    v_dot2c_f32_bf16 v19, v113, v9
    v_dot2c_f32_bf16 v20, v114, v8
    v_dot2c_f32_bf16 v21, v114, v9
    v_dot2c_f32_bf16 v22, v115, v8
    v_dot2c_f32_bf16 v23, v115, v9
    v_dot2c_f32_bf16 v24, v116, v8
    v_dot2c_f32_bf16 v25, v116, v9
    v_dot2c_f32_bf16 v26, v117, v8
    v_dot2c_f32_bf16 v27, v117, v9
    v_dot2c_f32_bf16 v28, v118, v8
    v_dot2c_f32_bf16 v29, v118, v9
    v_dot2c_f32_bf16 v30, v119, v8
    v_dot2c_f32_bf16 v31, v119, v9
    v_dot2c_f32_bf16 v32, v120, v8
    v_dot2c_f32_bf16 v33, v120, v9
    v_dot2c_f32_bf16 v34, v121, v8
    v_dot2c_f32_bf16 v35, v121, v9
    v_dot2c_f32_bf16 v36, v122, v8
    v_dot2c_f32_bf16 v37, v122, v9
    v_dot2c_f32_bf16 v38, v123, v8
    v_dot2c_f32_bf16 v39, v123, v9
    s_waitcnt vmcnt(6)
    s_nop 0
    s_mov_b32 s48, 1376256
    buffer_load_dwordx4 v[148:151], v5, s[96:99], s48 offen offset:0
    buffer_load_dwordx4 v[152:155], v5, s[96:99], s48 offen offset:128
    buffer_load_dwordx4 v[156:159], v5, s[96:99], s48 offen offset:256
    s_mov_b32 s49, 122880
    s_mov_b32 s51, 368640
    buffer_store_dwordx4 v[128:131], v14, s[92:95], s49 offen sc1
    buffer_store_dwordx4 v[124:127], v15, s[92:95], s49 offen sc1
    buffer_store_dwordx4 v[132:135], v15, s[92:95], s51 offen sc1
    v_dot2c_f32_bf16 v16, v124, v8
    v_dot2c_f32_bf16 v17, v124, v9
    v_dot2c_f32_bf16 v18, v125, v8
    v_dot2c_f32_bf16 v19, v125, v9
    v_dot2c_f32_bf16 v20, v126, v8
    v_dot2c_f32_bf16 v21, v126, v9
    v_dot2c_f32_bf16 v22, v127, v8
    v_dot2c_f32_bf16 v23, v127, v9
    v_dot2c_f32_bf16 v24, v128, v8
    v_dot2c_f32_bf16 v25, v128, v9
    v_dot2c_f32_bf16 v26, v129, v8
    v_dot2c_f32_bf16 v27, v129, v9
    v_dot2c_f32_bf16 v28, v130, v8
    v_dot2c_f32_bf16 v29, v130, v9
    v_dot2c_f32_bf16 v30, v131, v8
    v_dot2c_f32_bf16 v31, v131, v9
    v_dot2c_f32_bf16 v32, v132, v8
    v_dot2c_f32_bf16 v33, v132, v9
    v_dot2c_f32_bf16 v34, v133, v8
    v_dot2c_f32_bf16 v35, v133, v9
    v_dot2c_f32_bf16 v36, v134, v8
    v_dot2c_f32_bf16 v37, v134, v9
    v_dot2c_f32_bf16 v38, v135, v8
    v_dot2c_f32_bf16 v39, v135, v9
    s_waitcnt vmcnt(9)
    s_nop 0
    s_mov_b32 s48, 1572864
    buffer_load_dwordx4 v[160:163], v5, s[96:99], s48 offen offset:0
    buffer_load_dwordx4 v[164:167], v5, s[96:99], s48 offen offset:128
    buffer_load_dwordx4 v[168:171], v5, s[96:99], s48 offen offset:256
    s_mov_b32 s49, 147456
    s_mov_b32 s51, 393216
    buffer_store_dwordx4 v[140:143], v14, s[92:95], s49 offen sc1
    buffer_store_dwordx4 v[136:139], v15, s[92:95], s49 offen sc1
    buffer_store_dwordx4 v[144:147], v15, s[92:95], s51 offen sc1
    v_dot2c_f32_bf16 v16, v136, v8
    v_dot2c_f32_bf16 v17, v136, v9
    v_dot2c_f32_bf16 v18, v137, v8
    v_dot2c_f32_bf16 v19, v137, v9
    v_dot2c_f32_bf16 v20, v138, v8
    v_dot2c_f32_bf16 v21, v138, v9
    v_dot2c_f32_bf16 v22, v139, v8
    v_dot2c_f32_bf16 v23, v139, v9
    v_dot2c_f32_bf16 v24, v140, v8
    v_dot2c_f32_bf16 v25, v140, v9
    v_dot2c_f32_bf16 v26, v141, v8
    v_dot2c_f32_bf16 v27, v141, v9
    v_dot2c_f32_bf16 v28, v142, v8
    v_dot2c_f32_bf16 v29, v142, v9
    v_dot2c_f32_bf16 v30, v143, v8
    v_dot2c_f32_bf16 v31, v143, v9
    v_dot2c_f32_bf16 v32, v144, v8
    v_dot2c_f32_bf16 v33, v144, v9
    v_dot2c_f32_bf16 v34, v145, v8
    v_dot2c_f32_bf16 v35, v145, v9
    v_dot2c_f32_bf16 v36, v146, v8
    v_dot2c_f32_bf16 v37, v146, v9
    v_dot2c_f32_bf16 v38, v147, v8
    v_dot2c_f32_bf16 v39, v147, v9
    s_waitcnt vmcnt(9)
    s_nop 0
    s_mov_b32 s48, 1769472
    buffer_load_dwordx4 v[172:175], v5, s[96:99], s48 offen offset:0
    buffer_load_dwordx4 v[176:179], v5, s[96:99], s48 offen offset:128
    buffer_load_dwordx4 v[180:183], v5, s[96:99], s48 offen offset:256
    s_mov_b32 s49, 172032
    s_mov_b32 s51, 417792
    buffer_store_dwordx4 v[152:155], v14, s[92:95], s49 offen sc1
    buffer_store_dwordx4 v[148:151], v15, s[92:95], s49 offen sc1
    buffer_store_dwordx4 v[156:159], v15, s[92:95], s51 offen sc1
    v_dot2c_f32_bf16 v16, v148, v8
    v_dot2c_f32_bf16 v17, v148, v9
    v_dot2c_f32_bf16 v18, v149, v8
    v_dot2c_f32_bf16 v19, v149, v9
    v_dot2c_f32_bf16 v20, v150, v8
    v_dot2c_f32_bf16 v21, v150, v9
    v_dot2c_f32_bf16 v22, v151, v8
    v_dot2c_f32_bf16 v23, v151, v9
    v_dot2c_f32_bf16 v24, v152, v8
    v_dot2c_f32_bf16 v25, v152, v9
    v_dot2c_f32_bf16 v26, v153, v8
    v_dot2c_f32_bf16 v27, v153, v9
    v_dot2c_f32_bf16 v28, v154, v8
    v_dot2c_f32_bf16 v29, v154, v9
    v_dot2c_f32_bf16 v30, v155, v8
    v_dot2c_f32_bf16 v31, v155, v9
    v_dot2c_f32_bf16 v32, v156, v8
    v_dot2c_f32_bf16 v33, v156, v9
    v_dot2c_f32_bf16 v34, v157, v8
    v_dot2c_f32_bf16 v35, v157, v9
    v_dot2c_f32_bf16 v36, v158, v8
    v_dot2c_f32_bf16 v37, v158, v9
    v_dot2c_f32_bf16 v38, v159, v8
    v_dot2c_f32_bf16 v39, v159, v9
    s_waitcnt vmcnt(9)
    s_nop 0
    s_mov_b32 s49, 196608
    s_mov_b32 s51, 442368
    buffer_store_dwordx4 v[164:167], v14, s[92:95], s49 offen sc1
    buffer_store_dwordx4 v[160:163], v15, s[92:95], s49 offen sc1
    buffer_store_dwordx4 v[168:171], v15, s[92:95], s51 offen sc1
    v_dot2c_f32_bf16 v16, v160, v8
    v_dot2c_f32_bf16 v17, v160, v9
    v_dot2c_f32_bf16 v18, v161, v8
    v_dot2c_f32_bf16 v19, v161, v9
    v_dot2c_f32_bf16 v20, v162, v8
    v_dot2c_f32_bf16 v21, v162, v9
    v_dot2c_f32_bf16 v22, v163, v8
    v_dot2c_f32_bf16 v23, v163, v9
    v_dot2c_f32_bf16 v24, v164, v8
    v_dot2c_f32_bf16 v25, v164, v9
    v_dot2c_f32_bf16 v26, v165, v8
    v_dot2c_f32_bf16 v27, v165, v9
    v_dot2c_f32_bf16 v28, v166, v8
    v_dot2c_f32_bf16 v29, v166, v9
    v_dot2c_f32_bf16 v30, v167, v8
    v_dot2c_f32_bf16 v31, v167, v9
    v_dot2c_f32_bf16 v32, v168, v8
    v_dot2c_f32_bf16 v33, v168, v9
    v_dot2c_f32_bf16 v34, v169, v8
    v_dot2c_f32_bf16 v35, v169, v9
    v_dot2c_f32_bf16 v36, v170, v8
    v_dot2c_f32_bf16 v37, v170, v9
    v_dot2c_f32_bf16 v38, v171, v8
    v_dot2c_f32_bf16 v39, v171, v9
    s_waitcnt vmcnt(6)
    s_nop 0
    s_mov_b32 s49, 221184
    s_mov_b32 s51, 466944
    buffer_store_dwordx4 v[176:179], v14, s[92:95], s49 offen sc1
    buffer_store_dwordx4 v[172:175], v15, s[92:95], s49 offen sc1
    buffer_store_dwordx4 v[180:183], v15, s[92:95], s51 offen sc1
    v_dot2c_f32_bf16 v16, v172, v8
    v_dot2c_f32_bf16 v17, v172, v9
    v_dot2c_f32_bf16 v18, v173, v8
    v_dot2c_f32_bf16 v19, v173, v9
    v_dot2c_f32_bf16 v20, v174, v8
    v_dot2c_f32_bf16 v21, v174, v9
    v_dot2c_f32_bf16 v22, v175, v8
    v_dot2c_f32_bf16 v23, v175, v9
    v_dot2c_f32_bf16 v24, v176, v8
    v_dot2c_f32_bf16 v25, v176, v9
    v_dot2c_f32_bf16 v26, v177, v8
    v_dot2c_f32_bf16 v27, v177, v9
    v_dot2c_f32_bf16 v28, v178, v8
    v_dot2c_f32_bf16 v29, v178, v9
    v_dot2c_f32_bf16 v30, v179, v8
    v_dot2c_f32_bf16 v31, v179, v9
    v_dot2c_f32_bf16 v32, v180, v8
    v_dot2c_f32_bf16 v33, v180, v9
    v_dot2c_f32_bf16 v34, v181, v8
    v_dot2c_f32_bf16 v35, v181, v9
    v_dot2c_f32_bf16 v36, v182, v8
    v_dot2c_f32_bf16 v37, v182, v9
    v_dot2c_f32_bf16 v38, v183, v8
    v_dot2c_f32_bf16 v39, v183, v9
    v_add_f32_dpp v16, v16, v16 row_ror:8 row_mask:0xf bank_mask:0xf
    v_add_f32_dpp v17, v17, v17 row_ror:8 row_mask:0xf bank_mask:0xf
    v_add_f32_dpp v18, v18, v18 row_ror:8 row_mask:0xf bank_mask:0xf
    v_add_f32_dpp v19, v19, v19 row_ror:8 row_mask:0xf bank_mask:0xf
    v_add_f32_dpp v20, v20, v20 row_ror:8 row_mask:0xf bank_mask:0xf
    v_add_f32_dpp v21, v21, v21 row_ror:8 row_mask:0xf bank_mask:0xf
    v_add_f32_dpp v22, v22, v22 row_ror:8 row_mask:0xf bank_mask:0xf
    v_add_f32_dpp v23, v23, v23 row_ror:8 row_mask:0xf bank_mask:0xf
    v_add_f32_dpp v24, v24, v24 row_ror:8 row_mask:0xf bank_mask:0xf
    v_add_f32_dpp v25, v25, v25 row_ror:8 row_mask:0xf bank_mask:0xf
    v_add_f32_dpp v26, v26, v26 row_ror:8 row_mask:0xf bank_mask:0xf
    v_add_f32_dpp v27, v27, v27 row_ror:8 row_mask:0xf bank_mask:0xf
    v_add_f32_dpp v28, v28, v28 row_ror:8 row_mask:0xf bank_mask:0xf
    v_add_f32_dpp v29, v29, v29 row_ror:8 row_mask:0xf bank_mask:0xf
    v_add_f32_dpp v30, v30, v30 row_ror:8 row_mask:0xf bank_mask:0xf
    v_add_f32_dpp v31, v31, v31 row_ror:8 row_mask:0xf bank_mask:0xf
    v_add_f32_dpp v32, v32, v32 row_ror:8 row_mask:0xf bank_mask:0xf
    v_add_f32_dpp v33, v33, v33 row_ror:8 row_mask:0xf bank_mask:0xf
    v_add_f32_dpp v34, v34, v34 row_ror:8 row_mask:0xf bank_mask:0xf
    v_add_f32_dpp v35, v35, v35 row_ror:8 row_mask:0xf bank_mask:0xf
    v_add_f32_dpp v36, v36, v36 row_ror:8 row_mask:0xf bank_mask:0xf
    v_add_f32_dpp v37, v37, v37 row_ror:8 row_mask:0xf bank_mask:0xf
    v_add_f32_dpp v38, v38, v38 row_ror:8 row_mask:0xf bank_mask:0xf
    v_add_f32_dpp v39, v39, v39 row_ror:8 row_mask:0xf bank_mask:0xf
    s_lshl_b32 s48, s40, 2
    v_add_u32 v7, s48, v3
    s_movk_i32 s48, 768
    v_mul_u32_u24 v7, s48, v7
    v_lshl_add_u32 v7, v6, 5, v7
    ds_write_b128 v7, v[16:19] offset:49152
    ds_write_b128 v7, v[20:23] offset:49168
    ds_write_b128 v7, v[24:27] offset:49408
    ds_write_b128 v7, v[28:31] offset:49424
    ds_write_b128 v7, v[32:35] offset:49664
    ds_write_b128 v7, v[36:39] offset:49680
    buffer_load_dword v43, off, s[36:39], s83 sc1
    s_waitcnt vmcnt(0)
    s_mov_b32 s50, 0
L_hl_1:
    v_readfirstlane_b32 s49, v43
    s_add_u32 s50, s50, 1
    s_and_b32 s51, s49, 0xff
    s_cmp_eq_u32 s51, 32
    s_cbranch_scc1 L_hok_2
    s_cmp_gt_u32 s50, 200000
    s_cbranch_scc1 L_hok_2
    buffer_load_dword v43, off, s[36:39], s83 sc1
    s_waitcnt vmcnt(0)
    s_branch L_hl_1
L_hok_2:
    s_mul_i32 s50, s63, s63
    s_lshl_b32 s50, s50, 16
    s_lshl_b32 s51, s63, 8
    s_add_u32 s50, s50, s51
    s_add_u32 s50, s50, 1
    s_lshl_b32 s50, s50, 5
    s_cmp_lg_u32 s50, s49
    s_cselect_b32 s47, 1, 0
    v_mov_b32 v43, s47
    v_mov_b32 v60, 156544
    ds_write_b32 v60, v43
    s_waitcnt lgkmcnt(0)
    s_barrier
    s_cmp_eq_u32 s3, 1
    s_cbranch_scc1 L_help_ld
    s_and_b32 s72, s40, 1
    s_lshl_b32 s48, s72, 1
    v_lshrrev_b32 v57, 3, v1
    v_and_b32 v57, 3, v57
    v_xor_b32 v57, s48, v57
    v_lshlrev_b32 v57, 5, v57
    v_and_b32_e64 v58, 3, v1
    v_lshl_add_u32 v57, v58, 3, v57
    v_lshrrev_b32_e64 v58, 2, v2
    v_lshl_add_u32 v58, v3, 3, v58
    v_lshl_add_u32 v57, v58, 7, v57
    v_mov_b32 v40, v57
    v_xor_b32 v41, 32, v57
    v_add_u32 v42, 98304, v40
    v_add_u32 v43, 98304, v41
    s_cmp_eq_u32 s40, 3
    s_cbranch_scc1 L_help_c
    v_lshlrev_b32_e64 v4, 2, v0
    v_add_u32 v5, 49152, v4
    ds_read_b32 v64, v5 offset:0
    ds_read_b32 v65, v5 offset:768
    ds_read_b32 v66, v5 offset:1536
    ds_read_b32 v67, v5 offset:2304
    ds_read_b32 v68, v5 offset:3072
    ds_read_b32 v69, v5 offset:3840
    ds_read_b32 v70, v5 offset:4608
    ds_read_b32 v71, v5 offset:5376
    s_waitcnt lgkmcnt(0)
    s_nop 0
    ds_read_b32 v72, v5 offset:6144
    ds_read_b32 v73, v5 offset:6912
    ds_read_b32 v74, v5 offset:7680
    ds_read_b32 v75, v5 offset:8448
    ds_read_b32 v76, v5 offset:9216
    ds_read_b32 v77, v5 offset:9984
    ds_read_b32 v78, v5 offset:10752
    ds_read_b32 v79, v5 offset:11520
    s_waitcnt lgkmcnt(0)
    s_nop 0
    ds_read_b32 v80, v5 offset:12288
    ds_read_b32 v81, v5 offset:13056
    ds_read_b32 v82, v5 offset:13824
    ds_read_b32 v83, v5 offset:14592
    ds_read_b32 v84, v5 offset:15360
    ds_read_b32 v85, v5 offset:16128
    ds_read_b32 v86, v5 offset:16896
    ds_read_b32 v87, v5 offset:17664
    s_waitcnt lgkmcnt(0)
    s_nop 0
    ds_read_b32 v88, v5 offset:18432
    ds_read_b32 v89, v5 offset:19200
    ds_read_b32 v90, v5 offset:19968
    ds_read_b32 v91, v5 offset:20736
    ds_read_b32 v92, v5 offset:21504
    ds_read_b32 v93, v5 offset:22272
    ds_read_b32 v94, v5 offset:23040
    ds_read_b32 v95, v5 offset:23808
    s_waitcnt lgkmcnt(0)
    v_add_f32 v64, v64, v80
    v_add_f32 v65, v65, v81
    v_add_f32 v66, v66, v82
    v_add_f32 v67, v67, v83
    v_add_f32 v68, v68, v84
    v_add_f32 v69, v69, v85
    v_add_f32 v70, v70, v86
    v_add_f32 v71, v71, v87
    v_add_f32 v72, v72, v88
    v_add_f32 v73, v73, v89
    v_add_f32 v74, v74, v90
    v_add_f32 v75, v75, v91
    v_add_f32 v76, v76, v92
    v_add_f32 v77, v77, v93
    v_add_f32 v78, v78, v94
    v_add_f32 v79, v79, v95
    v_add_f32 v64, v64, v72
    v_add_f32 v65, v65, v73
    v_add_f32 v66, v66, v74
    v_add_f32 v67, v67, v75
    v_add_f32 v68, v68, v76
    v_add_f32 v69, v69, v77
    v_add_f32 v70, v70, v78
    v_add_f32 v71, v71, v79
    v_add_f32 v64, v64, v68
    v_add_f32 v65, v65, v69
    v_add_f32 v66, v66, v70
    v_add_f32 v67, v67, v71
    v_add_f32 v64, v64, v66
    v_add_f32 v65, v65, v67
    v_add_f32 v64, v64, v65
    s_mul_i32 s48, s64, 768
    buffer_store_dword v64, v4, s[92:95], s48 offen sc1
    v_mov_b32 v5, 1
    s_waitcnt vmcnt(0)
    s_mov_b64 exec, 1
    buffer_atomic_add v5, off, s[36:39], 0 offset:16
    s_mov_b64 exec, -1
L_help_c:
    s_barrier
    s_mov_b32 s82, 0
    s_branch L_comp_p3
L_help_ld:
    s_setprio 2
    v_lshrrev_b32 v4, 3, v1
    v_and_b32 v5, 7, v1
    s_and_b32 s48, s60, 1
    s_lshl_b32 s48, s48, 2
    v_and_b32 v57, 1, v3
    v_lshlrev_b32 v57, 1, v57
    v_or_b32 v57, s48, v57
    v_xor_b32 v42, v57, v5
    s_lshl_b32 s49, s44, 7
    v_lshl_add_u32 v13, v42, 4, s49
    v_lshrrev_b32 v57, 5, v1
    v_and_b32 v56, 3, v4
    s_movk_i32 s49, 1280
    v_mad_u32_u24 v12, v4, s49, v13
    s_movk_i32 s48, 80
    v_mad_u32_u24 v58, v57, s48, v56
    v_mad_u32_u24 v55, v58, s49, v13
    v_lshl_add_u32 v58, v57, 4, v56
    v_mad_u32_u24 v14, v58, s49, v13
    s_lshr_b32 s48, s60, 1
    s_mul_i32 s73, s48, 25600
    s_and_b32 s48, s60, 1
    s_mul_i32 s48, s48, 10240
    s_add_u32 s73, s73, s48
    s_mul_i32 s74, s60, 25600
    s_add_u32 s74, s74, 20480
    s_mul_i32 s80, s60, 5120
    s_mul_i32 s81, s60, 10240
    s_mul_i32 s75, s60, 2816
    s_bfm_b64 s[76:77], 48, 0
    s_mul_i32 s48, s43, 88
    s_lshl_b32 s49, s60, 8
    s_add_u32 s48, s48, s49
    s_lshl_b32 s48, s48, 4
    v_lshl_add_u32 v15, v1, 4, s48
    v_add_u32 v16, 1024, v15
    v_add_u32 v57, 14976, v16
    v_cmp_gt_u32 vcc, 24, v1
    s_nop 1
    v_cndmask_b32_e64 v16, v57, v16, vcc
    v_add_u32 v17, 17024, v15
    s_lshl_b32 s48, s43, 1
    s_lshr_b32 s49, s60, 1
    s_add_u32 s48, s48, s49
    s_mul_i32 s48, s48, 12288
    s_and_b32 s49, s60, 1
    s_mul_i32 s49, s49, 3072
    s_add_u32 s48, s48, s49
    s_add_u32 s48, s48, 1328128
    v_lshl_add_u32 v54, v1, 4, s48
    s_and_b32 s48, s42, 15
    s_and_b32 s49, s48, 1
    s_mul_i32 s50, s48, 192
    s_lshl_b32 s51, s49, 6
    s_add_u32 s51, s51, s50
    v_lshrrev_b32 v57, 5, v1
    v_and_b32_e64 v56, 3, v4
    v_lshl_add_u32 v58, v57, 4, v56
    v_mul_u32_u24 v59, 3072, v58
    v_lshl_add_u32 v45, v42, 4, v59
    v_add_u32 v45, s51, v45
    s_xor_b32 s49, s49, 1
    s_lshl_b32 s49, s49, 7
    s_add_u32 s50, s50, s49
    v_and_b32_e64 v57, 3, v42
    v_lshl_add_u32 v47, v57, 4, v59
    v_add_u32_e64 v47, s50, v47
    s_mul_i32 s48, s48, 245760
    s_add_u32 s48, s48, 16384
    v_mul_u32_u24 v58, 384, v58
    v_lshl_add_u32 v46, v42, 4, v58
    v_add_u32_e64 v46, s48, v46
    s_mul_i32 s70, s60, 12288
    s_mul_i32 s71, s60, 1536
    s_and_b32 s48, s60, 1
    s_lshl_b32 s48, s48, 2
    s_lshl_b32 s86, 0x0f0f0f0f, s48
    s_mov_b32 s87, s86
    s_mul_i32 s78, s60, 3072
    s_lshr_b32 s48, s42, 4
    s_lshl_b32 s49, s48, 11
    s_lshl_b32 s50, s60, 12
    s_add_u32 s49, s49, s50
    s_add_u32 s49, s49, 786432
    v_lshl_add_u32 v48, v1, 4, s49
    s_lshl_b32 s79, s60, 11
    s_lshl_b32 s49, s48, 10
    s_lshl_b32 s50, s60, 8
    s_add_u32 s49, s49, s50
    s_add_u32 s49, s49, 1114112
    v_and_b32 v57, 31, v1
    v_lshrrev_b32 v58, 5, v1
    v_lshlrev_b32 v58, 11, v58
    v_lshl_add_u32 v49, v57, 3, v58
    v_add_u32 v49, s49, v49
    s_lshl_b32 s49, s60, 9
    s_add_u32 s49, s49, 156672
    v_lshl_add_u32 v50, v57, 4, s49
    s_and_b32 s48, s42, 15
    s_mul_i32 s48, s48, 384
    v_lshl_add_u32 v11, v1, 4, s48
    v_add_u32 v57, 5760, v11
    v_cmp_gt_u32 vcc, 24, v1
    s_nop 1
    v_cndmask_b32 v11, v57, v11, vcc
    v_lshlrev_b32_e64 v61, 3, v1
    v_add_u32 v61, 1327104, v61
    s_lshl_b32 s48, s2, 2
    s_add_u32 s48, s48, s60
    s_mul_i32 s48, s48, 1920
    s_add_u32 s98, s24, s48
    s_addc_u32 s99, s25, 0
    s_load_dword s96, s[98:99], 0
    s_load_dword s96, s[98:99], 64
    s_load_dword s96, s[98:99], 128
    s_load_dword s96, s[98:99], 192
    s_load_dword s96, s[98:99], 256
    s_load_dword s96, s[98:99], 320
    s_load_dword s96, s[98:99], 384
    s_load_dword s96, s[98:99], 448
    s_load_dword s96, s[98:99], 512
    s_load_dword s96, s[98:99], 576
    s_load_dword s96, s[98:99], 640
    s_load_dword s96, s[98:99], 704
    s_load_dword s96, s[98:99], 768
    s_load_dword s96, s[98:99], 832
    s_load_dword s96, s[98:99], 896
    s_load_dword s96, s[98:99], 960
    s_load_dword s96, s[98:99], 1024
    s_load_dword s96, s[98:99], 1088
    s_load_dword s96, s[98:99], 1152
    s_load_dword s96, s[98:99], 1216
    s_load_dword s96, s[98:99], 1280
    s_load_dword s96, s[98:99], 1344
    s_load_dword s96, s[98:99], 1408
    s_load_dword s96, s[98:99], 1472
    s_load_dword s96, s[98:99], 1536
    s_load_dword s96, s[98:99], 1600
    s_load_dword s96, s[98:99], 1664
    s_load_dword s96, s[98:99], 1728
    s_load_dword s96, s[98:99], 1792
    s_load_dword s96, s[98:99], 1856
    s_barrier
    s_add_u32 s57, s70, 0
    s_add_u32 m0, s46, 106496
    s_nop 0
    buffer_load_dwordx4 v45, s[16:19], s57 offen lds
    s_add_u32 m0, s46, 114688
    s_nop 0
    buffer_load_dwordx4 v45, s[20:23], s57 offen lds
    s_add_u32 m0, s46, 122880
    s_mov_b64 exec, s[86:87]
    buffer_load_dwordx4 v47, s[16:19], s57 offen lds
    s_not_b64 exec, s[86:87]
    buffer_load_dwordx4 v47, s[20:23], s57 offen lds
    s_mov_b64 exec, -1
    s_add_u32 s57, s70, 98304
    s_add_u32 m0, s46, 110592
    s_nop 0
    buffer_load_dwordx4 v45, s[16:19], s57 offen lds
    s_add_u32 m0, s46, 118784
    s_nop 0
    buffer_load_dwordx4 v45, s[20:23], s57 offen lds
    s_add_u32 m0, s46, 126976
    s_mov_b64 exec, s[86:87]
    buffer_load_dwordx4 v47, s[16:19], s57 offen lds
    s_not_b64 exec, s[86:87]
    buffer_load_dwordx4 v47, s[20:23], s57 offen lds
    s_mov_b64 exec, -1
    s_add_u32 s57, s70, 196608
    s_add_u32 m0, s46, 131072
    s_nop 0
    buffer_load_dwordx4 v45, s[16:19], s57 offen lds
    s_add_u32 m0, s46, 139264
    s_nop 0
    buffer_load_dwordx4 v45, s[20:23], s57 offen lds
    s_add_u32 m0, s46, 147456
    s_mov_b64 exec, s[86:87]
    buffer_load_dwordx4 v47, s[16:19], s57 offen lds
    s_not_b64 exec, s[86:87]
    buffer_load_dwordx4 v47, s[20:23], s57 offen lds
    s_mov_b64 exec, -1
    s_branch L_ld_p3
L_h0:
    s_mul_i32 s43, s42, 26
    s_lshr_b32 s43, s43, 8
    s_mul_i32 s48, s43, 10
    s_sub_u32 s44, s42, s48
    s_cmp_ge_u32 s42, 30
    s_cselect_b32 s43, 0, s43
    s_lshl_b32 s62, s41, 8
    s_mul_i32 s48, s43, 88
    s_add_u32 s62, s62, s48
    s_and_b32 s60, s40, 3
    s_lshl_b32 s46, s60, 10
    s_mov_b32 s6, 2621440
    s_mov_b32 s7, 0x20000
    s_mov_b32 s10, 2457600
    s_mov_b32 s11, 0x20000
    v_and_b32 v2, 15, v0
    s_sub_u32 s48, s44, 5
    s_cmp_ge_u32 s44, 5
    s_cselect_b32 s45, s48, s44
    s_cmp_eq_u32 s43, 2
    s_cselect_b32 s54, 40, 44
    s_lshl_b32 s55, s42, 3
    s_add_u32 s55, s55, 1327104
    s_getreg_b32 s63, hwreg(HW_REG_XCC_ID)
    s_and_b32 s63, s63, 7
    s_mov_b32 s47, 1
    s_lshl_b32 s61, s41, 21
    s_nop 0
    s_mov_b32 s14, 819200
    s_mov_b32 s15, 0x20000
    s_mov_b32 s18, 1966080
    s_mov_b32 s19, 0x20000
    s_mov_b32 s22, 1966080
    s_mov_b32 s23, 0x20000
    s_mov_b32 s26, 1966080
    s_mov_b32 s27, 0x20000
    s_mov_b32 s30, 2621440
    s_mov_b32 s31, 0x20000
    s_mov_b32 s34, 2097152
    s_mov_b32 s35, 0x20000
    s_mov_b32 s38, 256
    s_mov_b32 s39, 0x20000
    s_mov_b32 s94, 3948544
    s_mov_b32 s95, 0x20000
    s_waitcnt lgkmcnt(0)
    s_mov_b64 s[4:5], s[64:65]
    s_mov_b64 s[8:9], s[66:67]
    s_mov_b64 s[12:13], s[68:69]
    s_mov_b64 s[16:17], s[72:73]
    s_mov_b64 s[20:21], s[74:75]
    s_mov_b64 s[24:25], s[76:77]
    s_mov_b64 s[28:29], s[78:79]
    s_mov_b64 s[36:37], s[80:81]
    s_add_u32 s32, s82, s61
    s_addc_u32 s33, s83, 0
    s_add_u32 s92, s82, 16777216
    s_addc_u32 s93, s83, 0
    s_lshl_b32 s83, s41, 5
    s_branch L_helper
.p2align 12
L_c0:
    s_mul_i32 s43, s42, 26
    s_lshr_b32 s43, s43, 8
    s_mul_i32 s48, s43, 10
    s_sub_u32 s44, s42, s48
    s_cmp_ge_u32 s42, 30
    s_cselect_b32 s43, 0, s43
    s_lshl_b32 s62, s41, 8
    s_mul_i32 s48, s43, 88
    s_add_u32 s62, s62, s48
    s_and_b32 s60, s40, 3
    s_lshl_b32 s46, s60, 10
    s_mov_b32 s6, 2621440
    s_mov_b32 s7, 0x20000
    s_mov_b32 s10, 2457600
    s_mov_b32 s11, 0x20000
    v_and_b32 v2, 15, v0
    s_sub_u32 s48, s44, 5
    s_cmp_ge_u32 s44, 5
    s_cselect_b32 s45, s48, s44
    s_cmp_eq_u32 s43, 2
    s_cselect_b32 s54, 40, 44
    s_lshl_b32 s55, s42, 3
    s_add_u32 s55, s55, 1327104
    s_getreg_b32 s63, hwreg(HW_REG_XCC_ID)
    s_and_b32 s63, s63, 7
    s_mov_b32 s47, 1
    s_lshl_b32 s61, s41, 21
    s_nop 0
    s_mov_b32 s14, 819200
    s_mov_b32 s15, 0x20000
    s_mov_b32 s18, 1966080
    s_mov_b32 s19, 0x20000
    s_mov_b32 s22, 1966080
    s_mov_b32 s23, 0x20000
    s_mov_b32 s26, 1966080
    s_mov_b32 s27, 0x20000
    s_mov_b32 s30, 2621440
    s_mov_b32 s31, 0x20000
    s_mov_b32 s34, 2097152
    s_mov_b32 s35, 0x20000
    s_mov_b32 s38, 256
    s_mov_b32 s39, 0x20000
    s_mov_b32 s94, 3948544
    s_mov_b32 s95, 0x20000
    s_waitcnt lgkmcnt(0)
    s_mov_b64 s[4:5], s[64:65]
    s_mov_b64 s[8:9], s[66:67]
    s_mov_b64 s[12:13], s[68:69]
    s_mov_b64 s[16:17], s[72:73]
    s_mov_b64 s[20:21], s[74:75]
    s_mov_b64 s[24:25], s[76:77]
    s_mov_b64 s[28:29], s[78:79]
    s_mov_b64 s[36:37], s[80:81]
    s_add_u32 s32, s82, s61
    s_addc_u32 s33, s83, 0
    s_add_u32 s92, s82, 16777216
    s_addc_u32 s93, s83, 0
    s_lshl_b32 s83, s41, 5
    s_cmp_eq_u32 s40, 3
    s_cbranch_scc1 L_w3_3
    s_cmp_lg_u32 s40, 0
    s_cbranch_scc1 L_go_4
    s_cmp_lt_u32 s42, 30
    s_cbranch_scc1 L_go_4
    s_cmp_lg_u32 s42, 31
    s_cbranch_scc1 L_nores_5
    v_mov_b32 v4, 0
    v_mov_b32 v5, 0
    v_mov_b32 v6, 0
    v_mov_b32 v7, 0
    v_lshlrev_b32 v8, 4, v1
    s_mov_b32 s48, 1327104
    buffer_store_dwordx4 v[4:7], v8, s[32:35], s48 offen sc1
    s_waitcnt vmcnt(0)
L_nores_5:
    s_mul_i32 s96, s63, s63
    s_lshl_b32 s96, s96, 16
    s_lshl_b32 s97, s63, 8
    s_add_u32 s96, s96, s97
    s_add_u32 s96, s96, 1
    v_mov_b32 v62, s96
    s_mov_b64 exec, 1
    buffer_atomic_add v62, off, s[36:39], s83
    s_mov_b64 exec, -1
    s_branch L_go_4
L_w3_3:
L_go_4:
    s_mov_b64 exec, -1
    s_mov_b32 s3, 0
    s_cmp_ge_u32 s42, 30
    s_cbranch_scc1 L_helper
L_comp:
    s_mul_i32 s48, s40, 14336
    s_add_u32 s48, s48, 13312
    v_lshl_add_u32 v8, v1, 4, s48
    s_lshr_b32 s65, s40, 2
    s_xor_b32 s64, s40, s65
    s_and_b32 s64, s64, 3
    s_mul_i32 s66, s45, 3
    s_add_u32 s66, s66, s64
    s_mul_i32 s67, s66, 40
    s_lshl_b32 s48, s45, 7
    s_sub_u32 s67, s67, s48
    s_add_u32 s67, s67, 53264
    s_cmp_ge_u32 s44, 5
    s_cselect_b32 s48, 16, 0
    s_add_u32 s66, s66, s48
    s_mul_i32 s48, s65, 25800
    s_add_u32 s67, s67, s48
    s_cmp_lt_u32 s45, 2
    s_cselect_b32 s48, 3, 0
    s_cmp_eq_u32 s45, 2
    s_cselect_b32 s48, 9, s48
    s_cmp_lg_u32 s64, s48
    s_cselect_b32 s68, 1, 0
    v_lshlrev_b32 v60, 2, v3
    v_and_b32 v59, 40, v1
    v_cmp_eq_u32 vcc, 8, v59
    v_add_u32 v59, 16, v60
    s_nop 0
    v_cndmask_b32 v60, v60, v59, vcc
    v_sub_u32_e64 v59, v2, v60
    v_mov_b32 v58, 0xf149f2ca
    s_or_b32 s48, s41, s43
    s_cmp_eq_u32 s48, 0
    s_cselect_b32 s48, 8, 0
    v_add_u32 v57, 8, v59
    v_cmp_gt_u32 vcc, 8, v57
    s_nop 1
    v_cndmask_b32 v224, v58, 0, vcc
    v_add_u32 v57, 0, v60
    v_cmp_gt_u32 vcc, s48, v57
    s_nop 1
    v_cndmask_b32 v228, v224, v58, vcc
    v_mov_b32 v236, 0x3f803f80
    v_add_u32 v57, 7, v59
    v_cmp_gt_u32 vcc, 8, v57
    s_nop 1
    v_cndmask_b32 v225, v58, 0, vcc
    v_add_u32 v57, 1, v60
    v_cmp_gt_u32 vcc, s48, v57
    s_nop 1
    v_cndmask_b32_e64 v229, v225, v58, vcc
    v_mov_b32 v237, 0x3f803f80
    v_add_u32 v57, 6, v59
    v_cmp_gt_u32 vcc, 8, v57
    s_nop 1
    v_cndmask_b32 v226, v58, 0, vcc
    v_add_u32 v57, 2, v60
    v_cmp_gt_u32 vcc, s48, v57
    s_nop 1
    v_cndmask_b32_e64 v230, v226, v58, vcc
    v_mov_b32 v238, 0x3f803f80
    v_add_u32 v57, 5, v59
    v_cmp_gt_u32 vcc, 8, v57
    s_nop 1
    v_cndmask_b32 v227, v58, 0, vcc
    v_add_u32 v57, 3, v60
    v_cmp_gt_u32 vcc, s48, v57
    s_nop 1
    v_cndmask_b32_e64 v231, v227, v58, vcc
    v_mov_b32 v239, 0x3f803f80
    s_movk_i32 s48, 496
    v_mul_u32_u24 v57, s48, v2
    v_add_u32_e64 v57, s67, v57
    v_lshl_add_u32 v240, v3, 3, v57
    v_add_u32 v241, 32, v57
    v_add_u32 v56, 16, v2
    v_cmp_gt_u32 vcc, 8, v2
    s_nop 1
    v_cndmask_b32 v56, v2, v56, vcc
    v_mul_u32_u24 v57, s48, v56
    v_add_u32_e64 v57, s67, v57
    v_lshl_add_u32 v242, v3, 3, v57
    v_add_u32 v243, 32, v57
    v_min_u32 v56, 19, v56
    v_mul_u32_u24 v57, s48, v56
    v_add_u32 v57, s67, v57
    v_lshl_add_u32 v244, v3, 3, v57
    v_add_u32_e64 v245, 32, v57
    v_mov_b32 v58, 49760
    v_cndmask_b32_e64 v232, v58, v240, vcc
    v_cndmask_b32_e64 v234, v240, v58, vcc
    v_cmp_gt_u32 vcc, 8, v1
    s_nop 1
    v_cndmask_b32 v233, v58, v241, vcc
    v_lshrrev_b32 v57, 3, v1
    v_cmp_eq_u32 vcc, 1, v57
    s_nop 1
    v_cndmask_b32 v235, v58, v241, vcc
    v_lshrrev_b32 v57, 2, v1
    v_and_b32 v56, 3, v1
    v_mul_u32_u24 v59, s48, v57
    v_add_u32_e64 v59, s67, v59
    v_lshl_add_u32 v252, v56, 3, v59
    v_min_u32 v57, 3, v57
    v_mul_u32_u24 v57, s48, v57
    v_add_u32_e64 v57, s67, v57
    v_lshl_add_u32 v253, v56, 3, v57
    v_mov_b32 v58, 53376
    v_cmp_eq_u32 vcc, 0, v56
    s_nop 1
    v_cndmask_b32 v249, v58, v59, vcc
    v_cmp_eq_u32 vcc, 1, v56
    s_nop 1
    v_cndmask_b32 v250, v58, v59, vcc
    v_cmp_eq_u32 vcc, 2, v56
    s_nop 1
    v_cndmask_b32_e64 v251, v58, v59, vcc
    v_cndmask_b32_e64 v254, v58, v57, vcc
    s_lshl_b32 s49, s65, 3
    s_add_u32 s49, s49, 155776
    v_lshl_add_u32 v255, v2, 4, s49
    s_mul_i32 s49, s43, 88
    s_mul_i32 s50, s54, s65
    s_add_u32 s49, s49, s50
    s_lshl_b32 s49, s49, 4
    s_lshl_b32 s50, s66, 13
    s_add_u32 s49, s49, s50
    s_add_u32 s49, s49, 786432
    v_lshrrev_b32 v57, 1, v3
    v_lshlrev_b32 v57, 12, v57
    v_lshl_add_u32 v57, v2, 4, v57
    v_add_u32 v57, s49, v57
    v_and_b32 v56, 1, v3
    v_lshl_add_u32 v246, v56, 8, v57
    v_mov_b32 v58, 0x80000000
    s_sub_u32 s50, s54, 32
    v_lshl_add_u32 v56, v56, 4, v2
    v_cmp_gt_u32 vcc, s50, v56
    s_nop 1
    v_cndmask_b32 v247, v58, v57, vcc
    s_lshl_b32 s49, s43, 1
    s_add_u32 s49, s49, s65
    s_lshl_b32 s49, s49, 5
    s_add_u32 s49, s49, s66
    s_mul_i32 s49, s49, 384
    s_add_u32 s49, s49, 1328128
    v_lshl_add_u32 v57, v1, 3, s49
    v_cmp_gt_u32 vcc, 48, v1
    s_nop 1
    v_cndmask_b32_e64 v248, v58, v57, vcc
    ds_write_b128 v8, v[236:239]
    v_lshrrev_b32 v57, 1, v2
    v_xor_b32 v57, v57, v3
    v_lshlrev_b32_e64 v57, 4, v57
    v_lshl_add_u32 v4, v2, 7, v57
    v_xor_b32 v5, 64, v4
    v_lshrrev_b32 v57, 3, v1
    v_and_b32 v57, 3, v57
    v_xor_b32 v57, s40, v57
    v_lshlrev_b32 v57, 5, v57
    v_and_b32 v58, 3, v1
    v_lshl_add_u32 v57, v58, 3, v57
    v_lshrrev_b32_e64 v58, 2, v2
    v_lshl_add_u32 v58, v3, 3, v58
    v_lshl_add_u32 v57, v58, 7, v57
    v_add_u32 v6, 57344, v57
    v_add_u32 v7, 106496, v57
    v_lshlrev_b32_e64 v8, 3, v2
    v_add_u32 v8, 155648, v8
    v_mov_b32 v28, 0
    v_mov_b32 v29, 0
    s_bfm_b64 exec, 8, 8
    ds_write_b64 v8, v[28:29] offset:768
    s_mov_b64 exec, -1
    v_and_b32 v57, 1, v2
    s_movk_i32 s48, 25800
    v_mul_u32_u24 v57, s48, v57
    v_lshrrev_b32 v58, 1, v2
    s_movk_i32 s48, 496
    v_mad_u32_u24 v57, v58, s48, v57
    v_lshl_add_u32 v57, v3, 3, v57
    s_lshl_b32 s48, s40, 5
    s_add_u32 s48, s48, 53264
    v_add_u32 v9, s48, v57
    v_add_u32 v40, 0, v9
    v_add_u32 v41, 3968, v9
    v_add_u32 v42, 7936, v9
    v_add_u32 v43, 11904, v9
    v_add_u32 v44, 15872, v9
    v_add_u32 v45, 19840, v9
    v_add_u32 v46, 23808, v9
    v_mov_b32 v58, 158720
    v_cmp_gt_u32 vcc, 8, v2
    s_nop 1
    v_cndmask_b32 v46, v58, v46, vcc
    v_lshrrev_b32 v58, 1, v3
    s_lshr_b32 s48, s40, 1
    v_cmp_eq_u32 vcc, s48, v58
    v_mov_b32 v58, 0x80000000
    v_and_b32 v59, 1, v3
    v_lshlrev_b32 v56, 4, v2
    s_movk_i32 s48, 1792
    v_mad_u32_u24 v57, v59, s48, v56
    v_cndmask_b32 v10, v58, v57, vcc
    s_movk_i32 s48, 768
    v_mad_u32_u24 v57, v59, s48, v56
    v_cndmask_b32 v13, v58, v57, vcc
    s_mul_i32 s73, s42, 5120
    s_add_u32 s73, s73, 1155072
    s_add_u32 s74, s73, 3584
    v_mov_b32 v11, 156544
    s_cmp_lt_u32 s45, 2
    s_cselect_b32 s48, 3, 0
    s_cmp_eq_u32 s45, 2
    s_cselect_b32 s48, 9, s48
    s_cmp_eq_u32 s48, s40
    s_cselect_b32 s82, 1, 0
    s_mul_i32 s48, s40, 26
    s_add_u32 s48, s48, 0
    v_add_u32_e64 v57, s48, v2
    v_mov_b32 v58, 104
    v_cmp_gt_u32 vcc, 13, v2
    s_nop 1
    v_cndmask_b32 v57, v58, v57, vcc
    v_lshrrev_b32 v58, 1, v57
    v_and_b32 v58, 7, v58
    v_xor_b32 v58, v58, v3
    v_lshlrev_b32_e64 v58, 4, v58
    v_lshl_add_u32 v38, v57, 7, v58
    v_xor_b32 v39, 64, v38
    s_mul_i32 s48, s40, 26
    s_add_u32 s48, s48, 13
    v_add_u32 v57, s48, v2
    v_mov_b32 v58, 104
    v_cmp_gt_u32 vcc, 13, v2
    s_nop 1
    v_cndmask_b32 v57, v58, v57, vcc
    v_lshrrev_b32 v58, 1, v57
    v_and_b32 v58, 7, v58
    v_xor_b32 v58, v58, v3
    v_lshlrev_b32_e64 v58, 4, v58
    v_lshl_add_u32 v47, v57, 7, v58
    v_xor_b32_e64 v60, 64, v47
    s_mul_i32 s48, s40, 208
    s_add_u32 s48, s48, 155648
    v_lshl_add_u32 v61, v2, 3, s48
    s_mov_b32 s56, 0x22222222
    s_mov_b32 s57, 0x22222222
    s_mov_b32 s58, 0x44444444
    s_mov_b32 s59, 0x44444444
    s_mov_b32 s60, 0x88888888
    s_mov_b32 s61, 0x88888888
    s_mov_b32 s48, 0x3acccccd
    s_mov_b32 s49, 0x3727c5ac
    s_mov_b32 s50, 0x00f0000f
    s_mov_b32 s51, 0x10000f00
    s_mul_i32 s75, s41, 10
    s_lshr_b32 s75, s75, 3
    s_sub_u32 s75, 10, s75
    s_cmp_eq_u32 s75, 10
    s_cselect_b32 s75, 0, s75
    s_and_b32 s76, s40, 1
    s_lshl_b32 s76, s76, 2
    v_lshrrev_b32 v56, 1, v3
    v_or_b32 v56, s76, v56
    s_lshr_b32 s76, s40, 1
    s_mul_i32 s76, s76, 48
    s_lshl_b32 s77, s54, 1
    s_sub_u32 s77, s77, 17
    s_add_u32 s78, s76, 0
    v_add_u32 v57, s78, v2
    v_lshlrev_b32 v58, 1, v57
    v_subrev_u32 v59, s77, v58
    v_add_u32 v58, 16, v58
    v_cmp_gt_u32 vcc, s54, v57
    s_nop 1
    v_cndmask_b32_e64 v58, v59, v58, vcc
    v_min_u32 v58, 111, v58
    v_lshrrev_b32 v59, 1, v58
    v_and_b32 v59, 7, v59
    v_xor_b32 v59, v59, v56
    v_lshlrev_b32 v59, 4, v59
    v_lshl_add_u32 v59, v58, 7, v59
    v_and_b32_e64 v57, 1, v3
    v_lshl_add_u32 v0, v57, 3, v59
    s_add_u32 s78, s76, 16
    v_add_u32 v57, s78, v2
    v_lshlrev_b32 v58, 1, v57
    v_subrev_u32 v59, s77, v58
    v_add_u32 v58, 16, v58
    v_cmp_gt_u32 vcc, s54, v57
    s_nop 1
    v_cndmask_b32 v58, v59, v58, vcc
    v_min_u32 v58, 111, v58
    v_lshrrev_b32 v59, 1, v58
    v_and_b32 v59, 7, v59
    v_xor_b32 v59, v59, v56
    v_lshlrev_b32 v59, 4, v59
    v_lshl_add_u32 v59, v58, 7, v59
    v_and_b32_e64 v57, 1, v3
    v_lshl_add_u32 v9, v57, 3, v59
    s_add_u32 s78, s76, 32
    v_add_u32 v57, s78, v2
    v_lshlrev_b32 v58, 1, v57
    v_subrev_u32 v59, s77, v58
    v_add_u32 v58, 16, v58
    v_cmp_gt_u32 vcc, s54, v57
    s_nop 1
    v_cndmask_b32 v58, v59, v58, vcc
    v_min_u32 v58, 111, v58
    v_lshrrev_b32 v59, 1, v58
    v_and_b32 v59, 7, v59
    v_xor_b32 v59, v59, v56
    v_lshlrev_b32 v59, 4, v59
    v_lshl_add_u32 v59, v58, 7, v59
    v_and_b32_e64 v57, 1, v3
    v_lshl_add_u32 v12, v57, 3, v59
    s_mul_i32 s96, s63, s63
    s_lshl_b32 s96, s96, 16
    s_lshl_b32 s97, s63, 8
    s_add_u32 s96, s96, s97
    s_add_u32 s96, s96, 1
    v_mov_b32 v62, s96
    s_mov_b32 s3, 2
    s_mov_b64 exec, 0
    s_cmp_eq_u32 s40, 0
    s_cbranch_scc1 L_pad0
    s_cmp_eq_u32 s40, 1
    s_cbranch_scc1 L_pad3
    s_cmp_eq_u32 s40, 2
    s_cbranch_scc1 L_pad7
    s_branch L_pad10
L_back:
    s_mov_b64 exec, -1
    s_mov_b32 s3, 0
    s_waitcnt lgkmcnt(0) vmcnt(0)
    s_barrier
    s_nop 0
    ds_read_b64_tr_b16 v[172:173], v6 offset:0
    ds_read_b64_tr_b16 v[174:175], v6 offset:512
    ds_read_b64_tr_b16 v[176:177], v6 offset:8192
    ds_read_b64_tr_b16 v[178:179], v6 offset:8704
    ds_read_b64_tr_b16 v[180:181], v6 offset:16384
    ds_read_b64_tr_b16 v[182:183], v6 offset:16896
    ds_read_b128 v[144:147], v4 offset:0
    ds_read_b128 v[148:151], v4 offset:2048
    ds_read_b128 v[152:155], v4 offset:4096
    ds_read_b128 v[156:159], v4 offset:6144
    ds_read_b128 v[160:163], v4 offset:8192
    ds_read_b128 v[164:167], v4 offset:10240
    ds_read_b128 v[168:171], v4 offset:12288
    ds_read_b128 v[14:17], v38 offset:0
    ds_read_b128 v[18:21], v39 offset:0
    ds_read_b128 v[22:25], v47 offset:0
    ds_read_b128 v[56:59], v60 offset:0
    s_waitcnt lgkmcnt(4)
    v_mfma_f32_16x16x32_bf16 v[88:91], v[176:179], v[144:147], 0
    s_cmp_lg_u32 s75, 0
    s_cbranch_scc1 L_xr_7
    ds_read_b64 v[26:27], v0 offset:0
    v_xor_b32 v0, 32, v0
    ds_read_b64 v[28:29], v0 offset:0
    ds_read_b64 v[30:31], v9 offset:0
    v_xor_b32_e64 v9, 32, v9
    ds_read_b64 v[32:33], v9 offset:0
    ds_read_b64 v[34:35], v12 offset:0
    v_xor_b32_e64 v12, 32, v12
    ds_read_b64 v[36:37], v12 offset:0
L_xr_7:
    v_mfma_f32_16x16x32_bf16 v[116:119], v[180:183], v[144:147], 0
    ds_read_b64_tr_b16 v[212:213], v6 offset:4096
    v_mfma_f32_16x16x32_bf16 v[64:67], v[172:175], v[148:151], 0
    ds_read_b64_tr_b16 v[214:215], v6 offset:4608
    v_mfma_f32_16x16x32_bf16 v[92:95], v[176:179], v[148:151], 0
    ds_read_b64_tr_b16 v[216:217], v6 offset:12288
    v_mfma_f32_16x16x32_bf16 v[120:123], v[180:183], v[148:151], 0
    ds_read_b64_tr_b16 v[218:219], v6 offset:12800
    v_mfma_f32_16x16x32_bf16 v[68:71], v[172:175], v[152:155], 0
    ds_read_b64_tr_b16 v[220:221], v6 offset:20480
    v_mfma_f32_16x16x32_bf16 v[96:99], v[176:179], v[152:155], 0
    ds_read_b64_tr_b16 v[222:223], v6 offset:20992
    v_mfma_f32_16x16x32_bf16 v[124:127], v[180:183], v[152:155], 0
    ds_read_b128 v[184:187], v5 offset:0
    v_mfma_f32_16x16x32_bf16 v[72:75], v[172:175], v[156:159], 0
    ds_read_b128 v[188:191], v5 offset:2048
    v_mfma_f32_16x16x32_bf16 v[100:103], v[176:179], v[156:159], 0
    ds_read_b128 v[192:195], v5 offset:4096
    v_mfma_f32_16x16x32_bf16 v[128:131], v[180:183], v[156:159], 0
    ds_read_b128 v[196:199], v5 offset:6144
    v_mfma_f32_16x16x32_bf16 v[76:79], v[172:175], v[160:163], 0
    ds_read_b128 v[200:203], v5 offset:8192
    v_mfma_f32_16x16x32_bf16 v[104:107], v[176:179], v[160:163], 0
    ds_read_b128 v[204:207], v5 offset:10240
    v_mfma_f32_16x16x32_bf16 v[132:135], v[180:183], v[160:163], 0
    ds_read_b128 v[208:211], v5 offset:12288
    v_mfma_f32_16x16x32_bf16 v[80:83], v[172:175], v[164:167], 0
    v_mfma_f32_16x16x32_bf16 v[108:111], v[176:179], v[164:167], 0
    v_mfma_f32_16x16x32_bf16 v[136:139], v[180:183], v[164:167], 0
    v_mfma_f32_16x16x32_bf16 v[84:87], v[172:175], v[168:171], 0
    v_mfma_f32_16x16x32_bf16 v[112:115], v[176:179], v[168:171], 0
    v_mfma_f32_16x16x32_bf16 v[140:143], v[180:183], v[168:171], 0
    s_waitcnt lgkmcnt(13)
    v_mfma_f32_16x16x32_bf16 v[48:51], v[14:17], v[14:17], 0
    v_mfma_f32_16x16x32_bf16 v[52:55], v[22:25], v[22:25], 0
    v_mfma_f32_16x16x32_bf16 v[48:51], v[18:21], v[18:21], v[48:51]
    v_mfma_f32_16x16x32_bf16 v[52:55], v[56:59], v[56:59], v[52:55]
    s_waitcnt lgkmcnt(0)
    s_barrier
    v_mfma_f32_16x16x32_bf16 v[88:91], v[216:219], v[184:187], v[88:91]
    ds_read_b128 v[14:17], v38 offset:14336
    v_mfma_f32_16x16x32_bf16 v[116:119], v[220:223], v[184:187], v[116:119]
    ds_read_b128 v[18:21], v39 offset:14336
    v_mfma_f32_16x16x32_bf16 v[64:67], v[212:215], v[188:191], v[64:67]
    ds_read_b128 v[22:25], v47 offset:14336
    v_mfma_f32_16x16x32_bf16 v[92:95], v[216:219], v[188:191], v[92:95]
    ds_read_b128 v[56:59], v60 offset:14336
    v_mfma_f32_16x16x32_bf16 v[120:123], v[220:223], v[188:191], v[120:123]
    ds_read_b64_tr_b16 v[172:173], v6 offset:24576
    v_mfma_f32_16x16x32_bf16 v[68:71], v[212:215], v[192:195], v[68:71]
    ds_read_b64_tr_b16 v[174:175], v6 offset:25088
    v_mfma_f32_16x16x32_bf16 v[96:99], v[216:219], v[192:195], v[96:99]
    ds_read_b64_tr_b16 v[176:177], v6 offset:32768
    v_mfma_f32_16x16x32_bf16 v[124:127], v[220:223], v[192:195], v[124:127]
    ds_read_b64_tr_b16 v[178:179], v6 offset:33280
    v_mfma_f32_16x16x32_bf16 v[72:75], v[212:215], v[196:199], v[72:75]
    ds_read_b64_tr_b16 v[180:181], v6 offset:40960
    v_mfma_f32_16x16x32_bf16 v[100:103], v[216:219], v[196:199], v[100:103]
    ds_read_b64_tr_b16 v[182:183], v6 offset:41472
    v_mfma_f32_16x16x32_bf16 v[128:131], v[220:223], v[196:199], v[128:131]
    ds_read_b128 v[144:147], v4 offset:14336
    v_mfma_f32_16x16x32_bf16 v[76:79], v[212:215], v[200:203], v[76:79]
    ds_read_b128 v[148:151], v4 offset:16384
    v_mfma_f32_16x16x32_bf16 v[104:107], v[216:219], v[200:203], v[104:107]
    ds_read_b128 v[152:155], v4 offset:18432
    v_mfma_f32_16x16x32_bf16 v[132:135], v[220:223], v[200:203], v[132:135]
    ds_read_b128 v[156:159], v4 offset:20480
    v_mfma_f32_16x16x32_bf16 v[80:83], v[212:215], v[204:207], v[80:83]
    ds_read_b128 v[160:163], v4 offset:22528
    v_mfma_f32_16x16x32_bf16 v[108:111], v[216:219], v[204:207], v[108:111]
    ds_read_b128 v[164:167], v4 offset:24576
    v_mfma_f32_16x16x32_bf16 v[136:139], v[220:223], v[204:207], v[136:139]
    ds_read_b128 v[168:171], v4 offset:26624
    v_mfma_f32_16x16x32_bf16 v[84:87], v[212:215], v[208:211], v[84:87]
    v_mfma_f32_16x16x32_bf16 v[112:115], v[216:219], v[208:211], v[112:115]
    v_mfma_f32_16x16x32_bf16 v[140:143], v[220:223], v[208:211], v[140:143]
    s_waitcnt lgkmcnt(13)
    v_mfma_f32_16x16x32_bf16 v[48:51], v[14:17], v[14:17], v[48:51]
    v_mfma_f32_16x16x32_bf16 v[52:55], v[22:25], v[22:25], v[52:55]
    v_mfma_f32_16x16x32_bf16 v[48:51], v[18:21], v[18:21], v[48:51]
    v_mfma_f32_16x16x32_bf16 v[52:55], v[56:59], v[56:59], v[52:55]
    s_waitcnt lgkmcnt(0)
    v_mfma_f32_16x16x32_bf16 v[88:91], v[176:179], v[144:147], v[88:91]
    ds_read_b64_tr_b16 v[212:213], v6 offset:28672
    v_mfma_f32_16x16x32_bf16 v[116:119], v[180:183], v[144:147], v[116:119]
    ds_read_b64_tr_b16 v[214:215], v6 offset:29184
    v_mfma_f32_16x16x32_bf16 v[64:67], v[172:175], v[148:151], v[64:67]
    ds_read_b64_tr_b16 v[216:217], v6 offset:36864
    v_mfma_f32_16x16x32_bf16 v[92:95], v[176:179], v[148:151], v[92:95]
    ds_read_b64_tr_b16 v[218:219], v6 offset:37376
    v_mfma_f32_16x16x32_bf16 v[120:123], v[180:183], v[148:151], v[120:123]
    ds_read_b64_tr_b16 v[220:221], v6 offset:45056
    v_mfma_f32_16x16x32_bf16 v[68:71], v[172:175], v[152:155], v[68:71]
    ds_read_b64_tr_b16 v[222:223], v6 offset:45568
    v_mfma_f32_16x16x32_bf16 v[96:99], v[176:179], v[152:155], v[96:99]
    ds_read_b128 v[184:187], v5 offset:14336
    v_mfma_f32_16x16x32_bf16 v[124:127], v[180:183], v[152:155], v[124:127]
    ds_read_b128 v[188:191], v5 offset:16384
    v_mfma_f32_16x16x32_bf16 v[72:75], v[172:175], v[156:159], v[72:75]
    ds_read_b128 v[192:195], v5 offset:18432
    v_mfma_f32_16x16x32_bf16 v[100:103], v[176:179], v[156:159], v[100:103]
    ds_read_b128 v[196:199], v5 offset:20480
    v_mfma_f32_16x16x32_bf16 v[128:131], v[180:183], v[156:159], v[128:131]
    ds_read_b128 v[200:203], v5 offset:22528
    v_mfma_f32_16x16x32_bf16 v[76:79], v[172:175], v[160:163], v[76:79]
    ds_read_b128 v[204:207], v5 offset:24576
    v_mfma_f32_16x16x32_bf16 v[104:107], v[176:179], v[160:163], v[104:107]
    ds_read_b128 v[208:211], v5 offset:26624
    v_mfma_f32_16x16x32_bf16 v[132:135], v[180:183], v[160:163], v[132:135]
    v_mfma_f32_16x16x32_bf16 v[80:83], v[172:175], v[164:167], v[80:83]
    v_mfma_f32_16x16x32_bf16 v[108:111], v[176:179], v[164:167], v[108:111]
    v_mfma_f32_16x16x32_bf16 v[136:139], v[180:183], v[164:167], v[136:139]
    v_mfma_f32_16x16x32_bf16 v[84:87], v[172:175], v[168:171], v[84:87]
    v_mfma_f32_16x16x32_bf16 v[112:115], v[176:179], v[168:171], v[112:115]
    v_mfma_f32_16x16x32_bf16 v[140:143], v[180:183], v[168:171], v[140:143]
    s_waitcnt lgkmcnt(0)
    s_barrier
    v_mfma_f32_16x16x32_bf16 v[88:91], v[216:219], v[184:187], v[88:91]
    ds_read_b128 v[14:17], v38 offset:28672
    v_mfma_f32_16x16x32_bf16 v[116:119], v[220:223], v[184:187], v[116:119]
    ds_read_b128 v[18:21], v39 offset:28672
    v_mfma_f32_16x16x32_bf16 v[64:67], v[212:215], v[188:191], v[64:67]
    ds_read_b128 v[22:25], v47 offset:28672
    v_mfma_f32_16x16x32_bf16 v[92:95], v[216:219], v[188:191], v[92:95]
    ds_read_b128 v[56:59], v60 offset:28672
    v_mfma_f32_16x16x32_bf16 v[120:123], v[220:223], v[188:191], v[120:123]
    ds_read_b64_tr_b16 v[172:173], v7 offset:0
    v_mfma_f32_16x16x32_bf16 v[68:71], v[212:215], v[192:195], v[68:71]
    ds_read_b64_tr_b16 v[174:175], v7 offset:512
    v_mfma_f32_16x16x32_bf16 v[96:99], v[216:219], v[192:195], v[96:99]
    ds_read_b64_tr_b16 v[176:177], v7 offset:8192
    v_mfma_f32_16x16x32_bf16 v[124:127], v[220:223], v[192:195], v[124:127]
    ds_read_b64_tr_b16 v[178:179], v7 offset:8704
    v_mfma_f32_16x16x32_bf16 v[72:75], v[212:215], v[196:199], v[72:75]
    ds_read_b64_tr_b16 v[180:181], v7 offset:16384
    v_mfma_f32_16x16x32_bf16 v[100:103], v[216:219], v[196:199], v[100:103]
    ds_read_b64_tr_b16 v[182:183], v7 offset:16896
    v_mfma_f32_16x16x32_bf16 v[128:131], v[220:223], v[196:199], v[128:131]
    ds_read_b128 v[144:147], v4 offset:28672
    v_mfma_f32_16x16x32_bf16 v[76:79], v[212:215], v[200:203], v[76:79]
    ds_read_b128 v[148:151], v4 offset:30720
    v_mfma_f32_16x16x32_bf16 v[104:107], v[216:219], v[200:203], v[104:107]
    ds_read_b128 v[152:155], v4 offset:32768
    v_mfma_f32_16x16x32_bf16 v[132:135], v[220:223], v[200:203], v[132:135]
    ds_read_b128 v[156:159], v4 offset:34816
    v_mfma_f32_16x16x32_bf16 v[80:83], v[212:215], v[204:207], v[80:83]
    ds_read_b128 v[160:163], v4 offset:36864
    v_mfma_f32_16x16x32_bf16 v[108:111], v[216:219], v[204:207], v[108:111]
    ds_read_b128 v[164:167], v4 offset:38912
    v_mfma_f32_16x16x32_bf16 v[136:139], v[220:223], v[204:207], v[136:139]
    ds_read_b128 v[168:171], v4 offset:40960
    v_mfma_f32_16x16x32_bf16 v[84:87], v[212:215], v[208:211], v[84:87]
    v_mfma_f32_16x16x32_bf16 v[112:115], v[216:219], v[208:211], v[112:115]
    v_mfma_f32_16x16x32_bf16 v[140:143], v[220:223], v[208:211], v[140:143]
    s_waitcnt lgkmcnt(13)
    v_mfma_f32_16x16x32_bf16 v[48:51], v[14:17], v[14:17], v[48:51]
    v_mfma_f32_16x16x32_bf16 v[52:55], v[22:25], v[22:25], v[52:55]
    v_mfma_f32_16x16x32_bf16 v[48:51], v[18:21], v[18:21], v[48:51]
    v_mfma_f32_16x16x32_bf16 v[52:55], v[56:59], v[56:59], v[52:55]
    s_cmp_lg_u32 s40, 0
    s_cbranch_scc1 L_hs_8
    s_setprio 3
    s_mov_b64 exec, 1
    buffer_atomic_add v62, off, s[36:39], s83
    s_mov_b64 exec, -1
    s_setprio 0
L_hs_8:
    s_waitcnt lgkmcnt(0)
    v_mfma_f32_16x16x32_bf16 v[88:91], v[176:179], v[144:147], v[88:91]
    s_cmp_lg_u32 s75, 2
    s_cbranch_scc1 L_xr_9
    ds_read_b64 v[26:27], v0 offset:28672
    v_xor_b32 v0, 32, v0
    ds_read_b64 v[28:29], v0 offset:28672
    ds_read_b64 v[30:31], v9 offset:28672
    v_xor_b32_e64 v9, 32, v9
    ds_read_b64 v[32:33], v9 offset:28672
    ds_read_b64 v[34:35], v12 offset:28672
    v_xor_b32_e64 v12, 32, v12
    ds_read_b64 v[36:37], v12 offset:28672
L_xr_9:
    v_mfma_f32_16x16x32_bf16 v[116:119], v[180:183], v[144:147], v[116:119]
    ds_read_b64_tr_b16 v[212:213], v7 offset:4096
    v_mfma_f32_16x16x32_bf16 v[64:67], v[172:175], v[148:151], v[64:67]
    ds_read_b64_tr_b16 v[214:215], v7 offset:4608
    v_mfma_f32_16x16x32_bf16 v[92:95], v[176:179], v[148:151], v[92:95]
    ds_read_b64_tr_b16 v[216:217], v7 offset:12288
    v_mfma_f32_16x16x32_bf16 v[120:123], v[180:183], v[148:151], v[120:123]
    ds_read_b64_tr_b16 v[218:219], v7 offset:12800
    v_mfma_f32_16x16x32_bf16 v[68:71], v[172:175], v[152:155], v[68:71]
    ds_read_b64_tr_b16 v[220:221], v7 offset:20480
    v_mfma_f32_16x16x32_bf16 v[96:99], v[176:179], v[152:155], v[96:99]
    ds_read_b64_tr_b16 v[222:223], v7 offset:20992
    v_mfma_f32_16x16x32_bf16 v[124:127], v[180:183], v[152:155], v[124:127]
    ds_read_b128 v[184:187], v5 offset:28672
    v_mfma_f32_16x16x32_bf16 v[72:75], v[172:175], v[156:159], v[72:75]
    ds_read_b128 v[188:191], v5 offset:30720
    v_mfma_f32_16x16x32_bf16 v[100:103], v[176:179], v[156:159], v[100:103]
    ds_read_b128 v[192:195], v5 offset:32768
    v_mfma_f32_16x16x32_bf16 v[128:131], v[180:183], v[156:159], v[128:131]
    ds_read_b128 v[196:199], v5 offset:34816
    v_mfma_f32_16x16x32_bf16 v[76:79], v[172:175], v[160:163], v[76:79]
    ds_read_b128 v[200:203], v5 offset:36864
    v_mfma_f32_16x16x32_bf16 v[104:107], v[176:179], v[160:163], v[104:107]
    ds_read_b128 v[204:207], v5 offset:38912
    v_mfma_f32_16x16x32_bf16 v[132:135], v[180:183], v[160:163], v[132:135]
    ds_read_b128 v[208:211], v5 offset:40960
    v_mfma_f32_16x16x32_bf16 v[80:83], v[172:175], v[164:167], v[80:83]
    v_mfma_f32_16x16x32_bf16 v[108:111], v[176:179], v[164:167], v[108:111]
    v_mfma_f32_16x16x32_bf16 v[136:139], v[180:183], v[164:167], v[136:139]
    v_mfma_f32_16x16x32_bf16 v[84:87], v[172:175], v[168:171], v[84:87]
    v_mfma_f32_16x16x32_bf16 v[112:115], v[176:179], v[168:171], v[112:115]
    v_mfma_f32_16x16x32_bf16 v[140:143], v[180:183], v[168:171], v[140:143]
    s_waitcnt lgkmcnt(0)
    s_barrier
    v_mfma_f32_16x16x32_bf16 v[88:91], v[216:219], v[184:187], v[88:91]
L_pad0:
    s_cbranch_execz L_pad1
    ds_read_b128 v[14:17], v38 offset:43008
    v_mfma_f32_16x16x32_bf16 v[116:119], v[220:223], v[184:187], v[116:119]
    ds_read_b128 v[18:21], v39 offset:43008
    v_mfma_f32_16x16x32_bf16 v[64:67], v[212:215], v[188:191], v[64:67]
    ds_read_b128 v[22:25], v47 offset:43008
    v_mfma_f32_16x16x32_bf16 v[92:95], v[216:219], v[188:191], v[92:95]
    ds_read_b128 v[56:59], v60 offset:43008
    v_mfma_f32_16x16x32_bf16 v[120:123], v[220:223], v[188:191], v[120:123]
    ds_read_b64_tr_b16 v[172:173], v7 offset:24576
    v_mfma_f32_16x16x32_bf16 v[68:71], v[212:215], v[192:195], v[68:71]
    ds_read_b64_tr_b16 v[174:175], v7 offset:25088
    v_mfma_f32_16x16x32_bf16 v[96:99], v[216:219], v[192:195], v[96:99]
    ds_read_b64_tr_b16 v[176:177], v7 offset:32768
    v_mfma_f32_16x16x32_bf16 v[124:127], v[220:223], v[192:195], v[124:127]
    ds_read_b64_tr_b16 v[178:179], v7 offset:33280
    v_mfma_f32_16x16x32_bf16 v[72:75], v[212:215], v[196:199], v[72:75]
    ds_read_b64_tr_b16 v[180:181], v7 offset:40960
    v_mfma_f32_16x16x32_bf16 v[100:103], v[216:219], v[196:199], v[100:103]
    ds_read_b64_tr_b16 v[182:183], v7 offset:41472
    v_mfma_f32_16x16x32_bf16 v[128:131], v[220:223], v[196:199], v[128:131]
    ds_read_b128 v[144:147], v4 offset:43008
    v_mfma_f32_16x16x32_bf16 v[76:79], v[212:215], v[200:203], v[76:79]
    ds_read_b128 v[148:151], v4 offset:45056
    v_mfma_f32_16x16x32_bf16 v[104:107], v[216:219], v[200:203], v[104:107]
    ds_read_b128 v[152:155], v4 offset:47104
    v_mfma_f32_16x16x32_bf16 v[132:135], v[220:223], v[200:203], v[132:135]
    ds_read_b128 v[156:159], v4 offset:49152
    v_mfma_f32_16x16x32_bf16 v[80:83], v[212:215], v[204:207], v[80:83]
    ds_read_b128 v[160:163], v4 offset:51200
    v_mfma_f32_16x16x32_bf16 v[108:111], v[216:219], v[204:207], v[108:111]
    ds_read_b128 v[164:167], v4 offset:53248
    v_mfma_f32_16x16x32_bf16 v[136:139], v[220:223], v[204:207], v[136:139]
    ds_read_b128 v[168:171], v4 offset:55296
    v_mfma_f32_16x16x32_bf16 v[84:87], v[212:215], v[208:211], v[84:87]
    v_mfma_f32_16x16x32_bf16 v[112:115], v[216:219], v[208:211], v[112:115]
    v_mfma_f32_16x16x32_bf16 v[140:143], v[220:223], v[208:211], v[140:143]
    s_waitcnt lgkmcnt(13)
    v_mfma_f32_16x16x32_bf16 v[48:51], v[14:17], v[14:17], v[48:51]
    v_mfma_f32_16x16x32_bf16 v[52:55], v[22:25], v[22:25], v[52:55]
    v_mfma_f32_16x16x32_bf16 v[48:51], v[18:21], v[18:21], v[48:51]
    v_mfma_f32_16x16x32_bf16 v[52:55], v[56:59], v[56:59], v[52:55]
    s_waitcnt lgkmcnt(0)
    v_mfma_f32_16x16x32_bf16 v[88:91], v[176:179], v[144:147], v[88:91]
    s_cmp_lg_u32 s75, 3
    s_cbranch_scc1 L_xr_10
    ds_read_b64 v[26:27], v0 offset:43008
    v_xor_b32 v0, 32, v0
    ds_read_b64 v[28:29], v0 offset:43008
    ds_read_b64 v[30:31], v9 offset:43008
    v_xor_b32_e64 v9, 32, v9
    ds_read_b64 v[32:33], v9 offset:43008
    ds_read_b64 v[34:35], v12 offset:43008
    v_xor_b32_e64 v12, 32, v12
    ds_read_b64 v[36:37], v12 offset:43008
L_xr_10:
    v_mfma_f32_16x16x32_bf16 v[116:119], v[180:183], v[144:147], v[116:119]
    ds_read_b64_tr_b16 v[212:213], v7 offset:28672
    v_mfma_f32_16x16x32_bf16 v[64:67], v[172:175], v[148:151], v[64:67]
    ds_read_b64_tr_b16 v[214:215], v7 offset:29184
    v_mfma_f32_16x16x32_bf16 v[92:95], v[176:179], v[148:151], v[92:95]
    ds_read_b64_tr_b16 v[216:217], v7 offset:36864
    v_mfma_f32_16x16x32_bf16 v[120:123], v[180:183], v[148:151], v[120:123]
    ds_read_b64_tr_b16 v[218:219], v7 offset:37376
    v_mfma_f32_16x16x32_bf16 v[68:71], v[172:175], v[152:155], v[68:71]
    ds_read_b64_tr_b16 v[220:221], v7 offset:45056
    v_mfma_f32_16x16x32_bf16 v[96:99], v[176:179], v[152:155], v[96:99]
    ds_read_b64_tr_b16 v[222:223], v7 offset:45568
    v_mfma_f32_16x16x32_bf16 v[124:127], v[180:183], v[152:155], v[124:127]
    ds_read_b128 v[184:187], v5 offset:43008
    v_mfma_f32_16x16x32_bf16 v[72:75], v[172:175], v[156:159], v[72:75]
    ds_read_b128 v[188:191], v5 offset:45056
    v_mfma_f32_16x16x32_bf16 v[100:103], v[176:179], v[156:159], v[100:103]
    ds_read_b128 v[192:195], v5 offset:47104
    v_mfma_f32_16x16x32_bf16 v[128:131], v[180:183], v[156:159], v[128:131]
    ds_read_b128 v[196:199], v5 offset:49152
    v_mfma_f32_16x16x32_bf16 v[76:79], v[172:175], v[160:163], v[76:79]
    ds_read_b128 v[200:203], v5 offset:51200
    v_mfma_f32_16x16x32_bf16 v[104:107], v[176:179], v[160:163], v[104:107]
    ds_read_b128 v[204:207], v5 offset:53248
    v_mfma_f32_16x16x32_bf16 v[132:135], v[180:183], v[160:163], v[132:135]
    ds_read_b128 v[208:211], v5 offset:55296
    v_mfma_f32_16x16x32_bf16 v[80:83], v[172:175], v[164:167], v[80:83]
    v_mfma_f32_16x16x32_bf16 v[108:111], v[176:179], v[164:167], v[108:111]
    v_mfma_f32_16x16x32_bf16 v[136:139], v[180:183], v[164:167], v[136:139]
    v_mfma_f32_16x16x32_bf16 v[84:87], v[172:175], v[168:171], v[84:87]
    v_mfma_f32_16x16x32_bf16 v[112:115], v[176:179], v[168:171], v[112:115]
    v_mfma_f32_16x16x32_bf16 v[140:143], v[180:183], v[168:171], v[140:143]
    s_waitcnt lgkmcnt(0)
    s_barrier
    v_mfma_f32_16x16x32_bf16 v[88:91], v[216:219], v[184:187], v[88:91]
    ds_read_b128 v[14:17], v38 offset:0
    v_mfma_f32_16x16x32_bf16 v[116:119], v[220:223], v[184:187], v[116:119]
    ds_read_b128 v[18:21], v39 offset:0
    v_mfma_f32_16x16x32_bf16 v[64:67], v[212:215], v[188:191], v[64:67]
    ds_read_b128 v[22:25], v47 offset:0
    v_mfma_f32_16x16x32_bf16 v[92:95], v[216:219], v[188:191], v[92:95]
    ds_read_b128 v[56:59], v60 offset:0
    v_mfma_f32_16x16x32_bf16 v[120:123], v[220:223], v[188:191], v[120:123]
    ds_read_b64_tr_b16 v[172:173], v6 offset:0
    v_mfma_f32_16x16x32_bf16 v[68:71], v[212:215], v[192:195], v[68:71]
    ds_read_b64_tr_b16 v[174:175], v6 offset:512
    v_mfma_f32_16x16x32_bf16 v[96:99], v[216:219], v[192:195], v[96:99]
    ds_read_b64_tr_b16 v[176:177], v6 offset:8192
    v_mfma_f32_16x16x32_bf16 v[124:127], v[220:223], v[192:195], v[124:127]
    ds_read_b64_tr_b16 v[178:179], v6 offset:8704
    v_mfma_f32_16x16x32_bf16 v[72:75], v[212:215], v[196:199], v[72:75]
    ds_read_b64_tr_b16 v[180:181], v6 offset:16384
    v_mfma_f32_16x16x32_bf16 v[100:103], v[216:219], v[196:199], v[100:103]
    ds_read_b64_tr_b16 v[182:183], v6 offset:16896
    v_mfma_f32_16x16x32_bf16 v[128:131], v[220:223], v[196:199], v[128:131]
    ds_read_b128 v[144:147], v4 offset:0
    v_mfma_f32_16x16x32_bf16 v[76:79], v[212:215], v[200:203], v[76:79]
    ds_read_b128 v[148:151], v4 offset:2048
    v_mfma_f32_16x16x32_bf16 v[104:107], v[216:219], v[200:203], v[104:107]
    ds_read_b128 v[152:155], v4 offset:4096
    v_mfma_f32_16x16x32_bf16 v[132:135], v[220:223], v[200:203], v[132:135]
    ds_read_b128 v[156:159], v4 offset:6144
    v_mfma_f32_16x16x32_bf16 v[80:83], v[212:215], v[204:207], v[80:83]
    ds_read_b128 v[160:163], v4 offset:8192
    v_mfma_f32_16x16x32_bf16 v[108:111], v[216:219], v[204:207], v[108:111]
    ds_read_b128 v[164:167], v4 offset:10240
    v_mfma_f32_16x16x32_bf16 v[136:139], v[220:223], v[204:207], v[136:139]
    ds_read_b128 v[168:171], v4 offset:12288
    v_mfma_f32_16x16x32_bf16 v[84:87], v[212:215], v[208:211], v[84:87]
    v_mfma_f32_16x16x32_bf16 v[112:115], v[216:219], v[208:211], v[112:115]
    v_mfma_f32_16x16x32_bf16 v[140:143], v[220:223], v[208:211], v[140:143]
    s_waitcnt lgkmcnt(13)
    v_mfma_f32_16x16x32_bf16 v[48:51], v[14:17], v[14:17], v[48:51]
    v_mfma_f32_16x16x32_bf16 v[52:55], v[22:25], v[22:25], v[52:55]
    v_mfma_f32_16x16x32_bf16 v[48:51], v[18:21], v[18:21], v[48:51]
    v_mfma_f32_16x16x32_bf16 v[52:55], v[56:59], v[56:59], v[52:55]
    s_waitcnt lgkmcnt(0)
    v_mfma_f32_16x16x32_bf16 v[88:91], v[176:179], v[144:147], v[88:91]
    s_cmp_lg_u32 s75, 4
    s_cbranch_scc1 L_xr_11
    ds_read_b64 v[26:27], v0 offset:0
    v_xor_b32_e64 v0, 32, v0
    ds_read_b64 v[28:29], v0 offset:0
    ds_read_b64 v[30:31], v9 offset:0
    v_xor_b32_e64 v9, 32, v9
    ds_read_b64 v[32:33], v9 offset:0
    ds_read_b64 v[34:35], v12 offset:0
    v_xor_b32_e64 v12, 32, v12
    ds_read_b64 v[36:37], v12 offset:0
L_xr_11:
    v_mfma_f32_16x16x32_bf16 v[116:119], v[180:183], v[144:147], v[116:119]
    ds_read_b64_tr_b16 v[212:213], v6 offset:4096
    v_mfma_f32_16x16x32_bf16 v[64:67], v[172:175], v[148:151], v[64:67]
    ds_read_b64_tr_b16 v[214:215], v6 offset:4608
    v_mfma_f32_16x16x32_bf16 v[92:95], v[176:179], v[148:151], v[92:95]
    ds_read_b64_tr_b16 v[216:217], v6 offset:12288
    v_mfma_f32_16x16x32_bf16 v[120:123], v[180:183], v[148:151], v[120:123]
    ds_read_b64_tr_b16 v[218:219], v6 offset:12800
    v_mfma_f32_16x16x32_bf16 v[68:71], v[172:175], v[152:155], v[68:71]
    ds_read_b64_tr_b16 v[220:221], v6 offset:20480
    v_mfma_f32_16x16x32_bf16 v[96:99], v[176:179], v[152:155], v[96:99]
    ds_read_b64_tr_b16 v[222:223], v6 offset:20992
    v_mfma_f32_16x16x32_bf16 v[124:127], v[180:183], v[152:155], v[124:127]
    ds_read_b128 v[184:187], v5 offset:0
    v_mfma_f32_16x16x32_bf16 v[72:75], v[172:175], v[156:159], v[72:75]
    ds_read_b128 v[188:191], v5 offset:2048
    v_mfma_f32_16x16x32_bf16 v[100:103], v[176:179], v[156:159], v[100:103]
    ds_read_b128 v[192:195], v5 offset:4096
    v_mfma_f32_16x16x32_bf16 v[128:131], v[180:183], v[156:159], v[128:131]
    ds_read_b128 v[196:199], v5 offset:6144
    v_mfma_f32_16x16x32_bf16 v[76:79], v[172:175], v[160:163], v[76:79]
    ds_read_b128 v[200:203], v5 offset:8192
    v_mfma_f32_16x16x32_bf16 v[104:107], v[176:179], v[160:163], v[104:107]
    ds_read_b128 v[204:207], v5 offset:10240
    v_mfma_f32_16x16x32_bf16 v[132:135], v[180:183], v[160:163], v[132:135]
    ds_read_b128 v[208:211], v5 offset:12288
    v_mfma_f32_16x16x32_bf16 v[80:83], v[172:175], v[164:167], v[80:83]
    v_mfma_f32_16x16x32_bf16 v[108:111], v[176:179], v[164:167], v[108:111]
    v_mfma_f32_16x16x32_bf16 v[136:139], v[180:183], v[164:167], v[136:139]
    v_mfma_f32_16x16x32_bf16 v[84:87], v[172:175], v[168:171], v[84:87]
    v_mfma_f32_16x16x32_bf16 v[112:115], v[176:179], v[168:171], v[112:115]
    v_mfma_f32_16x16x32_bf16 v[140:143], v[180:183], v[168:171], v[140:143]
    s_waitcnt lgkmcnt(0)
    s_barrier
    v_mfma_f32_16x16x32_bf16 v[88:91], v[216:219], v[184:187], v[88:91]
    ds_read_b128 v[14:17], v38 offset:14336
    v_mfma_f32_16x16x32_bf16 v[116:119], v[220:223], v[184:187], v[116:119]
    ds_read_b128 v[18:21], v39 offset:14336
    v_mfma_f32_16x16x32_bf16 v[64:67], v[212:215], v[188:191], v[64:67]
    ds_read_b128 v[22:25], v47 offset:14336
    v_mfma_f32_16x16x32_bf16 v[92:95], v[216:219], v[188:191], v[92:95]
    ds_read_b128 v[56:59], v60 offset:14336
    v_mfma_f32_16x16x32_bf16 v[120:123], v[220:223], v[188:191], v[120:123]
    ds_read_b64_tr_b16 v[172:173], v6 offset:24576
    v_mfma_f32_16x16x32_bf16 v[68:71], v[212:215], v[192:195], v[68:71]
    ds_read_b64_tr_b16 v[174:175], v6 offset:25088
    v_mfma_f32_16x16x32_bf16 v[96:99], v[216:219], v[192:195], v[96:99]
    ds_read_b64_tr_b16 v[176:177], v6 offset:32768
    v_mfma_f32_16x16x32_bf16 v[124:127], v[220:223], v[192:195], v[124:127]
    ds_read_b64_tr_b16 v[178:179], v6 offset:33280
    v_mfma_f32_16x16x32_bf16 v[72:75], v[212:215], v[196:199], v[72:75]
    ds_read_b64_tr_b16 v[180:181], v6 offset:40960
    v_mfma_f32_16x16x32_bf16 v[100:103], v[216:219], v[196:199], v[100:103]
    ds_read_b64_tr_b16 v[182:183], v6 offset:41472
    v_mfma_f32_16x16x32_bf16 v[128:131], v[220:223], v[196:199], v[128:131]
    ds_read_b128 v[144:147], v4 offset:14336
    v_mfma_f32_16x16x32_bf16 v[76:79], v[212:215], v[200:203], v[76:79]
    ds_read_b128 v[148:151], v4 offset:16384
    v_mfma_f32_16x16x32_bf16 v[104:107], v[216:219], v[200:203], v[104:107]
    ds_read_b128 v[152:155], v4 offset:18432
    v_mfma_f32_16x16x32_bf16 v[132:135], v[220:223], v[200:203], v[132:135]
    ds_read_b128 v[156:159], v4 offset:20480
    v_mfma_f32_16x16x32_bf16 v[80:83], v[212:215], v[204:207], v[80:83]
    ds_read_b128 v[160:163], v4 offset:22528
    v_mfma_f32_16x16x32_bf16 v[108:111], v[216:219], v[204:207], v[108:111]
    ds_read_b128 v[164:167], v4 offset:24576
    v_mfma_f32_16x16x32_bf16 v[136:139], v[220:223], v[204:207], v[136:139]
    ds_read_b128 v[168:171], v4 offset:26624
    v_mfma_f32_16x16x32_bf16 v[84:87], v[212:215], v[208:211], v[84:87]
    v_mfma_f32_16x16x32_bf16 v[112:115], v[216:219], v[208:211], v[112:115]
    v_mfma_f32_16x16x32_bf16 v[140:143], v[220:223], v[208:211], v[140:143]
    s_waitcnt lgkmcnt(13)
    v_mfma_f32_16x16x32_bf16 v[48:51], v[14:17], v[14:17], v[48:51]
    v_mfma_f32_16x16x32_bf16 v[52:55], v[22:25], v[22:25], v[52:55]
    v_mfma_f32_16x16x32_bf16 v[48:51], v[18:21], v[18:21], v[48:51]
    v_mfma_f32_16x16x32_bf16 v[52:55], v[56:59], v[56:59], v[52:55]
    s_waitcnt lgkmcnt(0)
    v_mfma_f32_16x16x32_bf16 v[88:91], v[176:179], v[144:147], v[88:91]
    s_cmp_lg_u32 s75, 5
    s_cbranch_scc1 L_xr_12
    ds_read_b64 v[26:27], v0 offset:14336
    v_xor_b32_e64 v0, 32, v0
    ds_read_b64 v[28:29], v0 offset:14336
    ds_read_b64 v[30:31], v9 offset:14336
    v_xor_b32_e64 v9, 32, v9
    ds_read_b64 v[32:33], v9 offset:14336
    ds_read_b64 v[34:35], v12 offset:14336
    v_xor_b32_e64 v12, 32, v12
    ds_read_b64 v[36:37], v12 offset:14336
L_xr_12:
    v_mfma_f32_16x16x32_bf16 v[116:119], v[180:183], v[144:147], v[116:119]
    ds_read_b64_tr_b16 v[212:213], v6 offset:28672
    v_mfma_f32_16x16x32_bf16 v[64:67], v[172:175], v[148:151], v[64:67]
    ds_read_b64_tr_b16 v[214:215], v6 offset:29184
    v_mfma_f32_16x16x32_bf16 v[92:95], v[176:179], v[148:151], v[92:95]
    ds_read_b64_tr_b16 v[216:217], v6 offset:36864
    v_mfma_f32_16x16x32_bf16 v[120:123], v[180:183], v[148:151], v[120:123]
    ds_read_b64_tr_b16 v[218:219], v6 offset:37376
    v_mfma_f32_16x16x32_bf16 v[68:71], v[172:175], v[152:155], v[68:71]
    ds_read_b64_tr_b16 v[220:221], v6 offset:45056
    v_mfma_f32_16x16x32_bf16 v[96:99], v[176:179], v[152:155], v[96:99]
    ds_read_b64_tr_b16 v[222:223], v6 offset:45568
    v_mfma_f32_16x16x32_bf16 v[124:127], v[180:183], v[152:155], v[124:127]
    ds_read_b128 v[184:187], v5 offset:14336
    v_mfma_f32_16x16x32_bf16 v[72:75], v[172:175], v[156:159], v[72:75]
    ds_read_b128 v[188:191], v5 offset:16384
    v_mfma_f32_16x16x32_bf16 v[100:103], v[176:179], v[156:159], v[100:103]
    ds_read_b128 v[192:195], v5 offset:18432
    v_mfma_f32_16x16x32_bf16 v[128:131], v[180:183], v[156:159], v[128:131]
    ds_read_b128 v[196:199], v5 offset:20480
    v_mfma_f32_16x16x32_bf16 v[76:79], v[172:175], v[160:163], v[76:79]
    ds_read_b128 v[200:203], v5 offset:22528
    v_mfma_f32_16x16x32_bf16 v[104:107], v[176:179], v[160:163], v[104:107]
    ds_read_b128 v[204:207], v5 offset:24576
    v_mfma_f32_16x16x32_bf16 v[132:135], v[180:183], v[160:163], v[132:135]
    ds_read_b128 v[208:211], v5 offset:26624
    v_mfma_f32_16x16x32_bf16 v[80:83], v[172:175], v[164:167], v[80:83]
    v_mfma_f32_16x16x32_bf16 v[108:111], v[176:179], v[164:167], v[108:111]
    v_mfma_f32_16x16x32_bf16 v[136:139], v[180:183], v[164:167], v[136:139]
    v_mfma_f32_16x16x32_bf16 v[84:87], v[172:175], v[168:171], v[84:87]
    v_mfma_f32_16x16x32_bf16 v[112:115], v[176:179], v[168:171], v[112:115]
    v_mfma_f32_16x16x32_bf16 v[140:143], v[180:183], v[168:171], v[140:143]
    s_waitcnt lgkmcnt(0)
    s_barrier
    v_mfma_f32_16x16x32_bf16 v[88:91], v[216:219], v[184:187], v[88:91]
    ds_read_b128 v[14:17], v38 offset:28672
    v_mfma_f32_16x16x32_bf16 v[116:119], v[220:223], v[184:187], v[116:119]
    ds_read_b128 v[18:21], v39 offset:28672
    v_mfma_f32_16x16x32_bf16 v[64:67], v[212:215], v[188:191], v[64:67]
    ds_read_b128 v[22:25], v47 offset:28672
    v_mfma_f32_16x16x32_bf16 v[92:95], v[216:219], v[188:191], v[92:95]
    ds_read_b128 v[56:59], v60 offset:28672
    v_mfma_f32_16x16x32_bf16 v[120:123], v[220:223], v[188:191], v[120:123]
    ds_read_b64_tr_b16 v[172:173], v7 offset:0
    v_mfma_f32_16x16x32_bf16 v[68:71], v[212:215], v[192:195], v[68:71]
    ds_read_b64_tr_b16 v[174:175], v7 offset:512
    v_mfma_f32_16x16x32_bf16 v[96:99], v[216:219], v[192:195], v[96:99]
    ds_read_b64_tr_b16 v[176:177], v7 offset:8192
    v_mfma_f32_16x16x32_bf16 v[124:127], v[220:223], v[192:195], v[124:127]
    ds_read_b64_tr_b16 v[178:179], v7 offset:8704
    v_mfma_f32_16x16x32_bf16 v[72:75], v[212:215], v[196:199], v[72:75]
    ds_read_b64_tr_b16 v[180:181], v7 offset:16384
    v_mfma_f32_16x16x32_bf16 v[100:103], v[216:219], v[196:199], v[100:103]
    ds_read_b64_tr_b16 v[182:183], v7 offset:16896
    v_mfma_f32_16x16x32_bf16 v[128:131], v[220:223], v[196:199], v[128:131]
    ds_read_b128 v[144:147], v4 offset:28672
    v_mfma_f32_16x16x32_bf16 v[76:79], v[212:215], v[200:203], v[76:79]
    ds_read_b128 v[148:151], v4 offset:30720
    v_mfma_f32_16x16x32_bf16 v[104:107], v[216:219], v[200:203], v[104:107]
    ds_read_b128 v[152:155], v4 offset:32768
    v_mfma_f32_16x16x32_bf16 v[132:135], v[220:223], v[200:203], v[132:135]
    ds_read_b128 v[156:159], v4 offset:34816
    v_mfma_f32_16x16x32_bf16 v[80:83], v[212:215], v[204:207], v[80:83]
    ds_read_b128 v[160:163], v4 offset:36864
    v_mfma_f32_16x16x32_bf16 v[108:111], v[216:219], v[204:207], v[108:111]
    ds_read_b128 v[164:167], v4 offset:38912
    v_mfma_f32_16x16x32_bf16 v[136:139], v[220:223], v[204:207], v[136:139]
    ds_read_b128 v[168:171], v4 offset:40960
    v_mfma_f32_16x16x32_bf16 v[84:87], v[212:215], v[208:211], v[84:87]
    v_mfma_f32_16x16x32_bf16 v[112:115], v[216:219], v[208:211], v[112:115]
    v_mfma_f32_16x16x32_bf16 v[140:143], v[220:223], v[208:211], v[140:143]
    s_waitcnt lgkmcnt(13)
    v_mfma_f32_16x16x32_bf16 v[48:51], v[14:17], v[14:17], v[48:51]
    v_mfma_f32_16x16x32_bf16 v[52:55], v[22:25], v[22:25], v[52:55]
    v_mfma_f32_16x16x32_bf16 v[48:51], v[18:21], v[18:21], v[48:51]
    v_mfma_f32_16x16x32_bf16 v[52:55], v[56:59], v[56:59], v[52:55]
    s_waitcnt lgkmcnt(0)
    v_mfma_f32_16x16x32_bf16 v[88:91], v[176:179], v[144:147], v[88:91]
    ds_read_b64_tr_b16 v[212:213], v7 offset:4096
    v_mfma_f32_16x16x32_bf16 v[116:119], v[180:183], v[144:147], v[116:119]
    ds_read_b64_tr_b16 v[214:215], v7 offset:4608
    v_mfma_f32_16x16x32_bf16 v[64:67], v[172:175], v[148:151], v[64:67]
    ds_read_b64_tr_b16 v[216:217], v7 offset:12288
    v_mfma_f32_16x16x32_bf16 v[92:95], v[176:179], v[148:151], v[92:95]
    ds_read_b64_tr_b16 v[218:219], v7 offset:12800
    v_mfma_f32_16x16x32_bf16 v[120:123], v[180:183], v[148:151], v[120:123]
    ds_read_b64_tr_b16 v[220:221], v7 offset:20480
    v_mfma_f32_16x16x32_bf16 v[68:71], v[172:175], v[152:155], v[68:71]
    ds_read_b64_tr_b16 v[222:223], v7 offset:20992
    v_mfma_f32_16x16x32_bf16 v[96:99], v[176:179], v[152:155], v[96:99]
    ds_read_b128 v[184:187], v5 offset:28672
    v_mfma_f32_16x16x32_bf16 v[124:127], v[180:183], v[152:155], v[124:127]
    ds_read_b128 v[188:191], v5 offset:30720
    v_mfma_f32_16x16x32_bf16 v[72:75], v[172:175], v[156:159], v[72:75]
    ds_read_b128 v[192:195], v5 offset:32768
    v_mfma_f32_16x16x32_bf16 v[100:103], v[176:179], v[156:159], v[100:103]
    ds_read_b128 v[196:199], v5 offset:34816
    v_mfma_f32_16x16x32_bf16 v[128:131], v[180:183], v[156:159], v[128:131]
    ds_read_b128 v[200:203], v5 offset:36864
    v_mfma_f32_16x16x32_bf16 v[76:79], v[172:175], v[160:163], v[76:79]
    ds_read_b128 v[204:207], v5 offset:38912
    v_mfma_f32_16x16x32_bf16 v[104:107], v[176:179], v[160:163], v[104:107]
    ds_read_b128 v[208:211], v5 offset:40960
    v_mfma_f32_16x16x32_bf16 v[132:135], v[180:183], v[160:163], v[132:135]
    v_mfma_f32_16x16x32_bf16 v[80:83], v[172:175], v[164:167], v[80:83]
    v_mfma_f32_16x16x32_bf16 v[108:111], v[176:179], v[164:167], v[108:111]
    v_mfma_f32_16x16x32_bf16 v[136:139], v[180:183], v[164:167], v[136:139]
    v_mfma_f32_16x16x32_bf16 v[84:87], v[172:175], v[168:171], v[84:87]
    v_mfma_f32_16x16x32_bf16 v[112:115], v[176:179], v[168:171], v[112:115]
    v_mfma_f32_16x16x32_bf16 v[140:143], v[180:183], v[168:171], v[140:143]
    s_waitcnt lgkmcnt(0)
    s_barrier
    v_mfma_f32_16x16x32_bf16 v[88:91], v[216:219], v[184:187], v[88:91]
    ds_read_b128 v[14:17], v38 offset:43008
    v_mfma_f32_16x16x32_bf16 v[116:119], v[220:223], v[184:187], v[116:119]
    ds_read_b128 v[18:21], v39 offset:43008
    v_mfma_f32_16x16x32_bf16 v[64:67], v[212:215], v[188:191], v[64:67]
    ds_read_b128 v[22:25], v47 offset:43008
    v_mfma_f32_16x16x32_bf16 v[92:95], v[216:219], v[188:191], v[92:95]
    ds_read_b128 v[56:59], v60 offset:43008
    v_mfma_f32_16x16x32_bf16 v[120:123], v[220:223], v[188:191], v[120:123]
    ds_read_b64_tr_b16 v[172:173], v7 offset:24576
    v_mfma_f32_16x16x32_bf16 v[68:71], v[212:215], v[192:195], v[68:71]
    ds_read_b64_tr_b16 v[174:175], v7 offset:25088
    v_mfma_f32_16x16x32_bf16 v[96:99], v[216:219], v[192:195], v[96:99]
    ds_read_b64_tr_b16 v[176:177], v7 offset:32768
    v_mfma_f32_16x16x32_bf16 v[124:127], v[220:223], v[192:195], v[124:127]
    ds_read_b64_tr_b16 v[178:179], v7 offset:33280
    v_mfma_f32_16x16x32_bf16 v[72:75], v[212:215], v[196:199], v[72:75]
    ds_read_b64_tr_b16 v[180:181], v7 offset:40960
    v_mfma_f32_16x16x32_bf16 v[100:103], v[216:219], v[196:199], v[100:103]
    ds_read_b64_tr_b16 v[182:183], v7 offset:41472
    v_mfma_f32_16x16x32_bf16 v[128:131], v[220:223], v[196:199], v[128:131]
    ds_read_b128 v[144:147], v4 offset:43008
    v_mfma_f32_16x16x32_bf16 v[76:79], v[212:215], v[200:203], v[76:79]
    ds_read_b128 v[148:151], v4 offset:45056
    v_mfma_f32_16x16x32_bf16 v[104:107], v[216:219], v[200:203], v[104:107]
    ds_read_b128 v[152:155], v4 offset:47104
    v_mfma_f32_16x16x32_bf16 v[132:135], v[220:223], v[200:203], v[132:135]
    ds_read_b128 v[156:159], v4 offset:49152
    v_mfma_f32_16x16x32_bf16 v[80:83], v[212:215], v[204:207], v[80:83]
    ds_read_b128 v[160:163], v4 offset:51200
    v_mfma_f32_16x16x32_bf16 v[108:111], v[216:219], v[204:207], v[108:111]
    ds_read_b128 v[164:167], v4 offset:53248
    v_mfma_f32_16x16x32_bf16 v[136:139], v[220:223], v[204:207], v[136:139]
    ds_read_b128 v[168:171], v4 offset:55296
    v_mfma_f32_16x16x32_bf16 v[84:87], v[212:215], v[208:211], v[84:87]
    v_mfma_f32_16x16x32_bf16 v[112:115], v[216:219], v[208:211], v[112:115]
    v_mfma_f32_16x16x32_bf16 v[140:143], v[220:223], v[208:211], v[140:143]
    s_waitcnt lgkmcnt(13)
    v_mfma_f32_16x16x32_bf16 v[48:51], v[14:17], v[14:17], v[48:51]
    v_mfma_f32_16x16x32_bf16 v[52:55], v[22:25], v[22:25], v[52:55]
    v_mfma_f32_16x16x32_bf16 v[48:51], v[18:21], v[18:21], v[48:51]
    v_mfma_f32_16x16x32_bf16 v[52:55], v[56:59], v[56:59], v[52:55]
    s_waitcnt lgkmcnt(0)
    v_mfma_f32_16x16x32_bf16 v[88:91], v[176:179], v[144:147], v[88:91]
    s_cmp_lg_u32 s75, 7
    s_cbranch_scc1 L_xr_13
    ds_read_b64 v[26:27], v0 offset:43008
    v_xor_b32_e64 v0, 32, v0
    ds_read_b64 v[28:29], v0 offset:43008
    ds_read_b64 v[30:31], v9 offset:43008
    v_xor_b32_e64 v9, 32, v9
    ds_read_b64 v[32:33], v9 offset:43008
    ds_read_b64 v[34:35], v12 offset:43008
    v_xor_b32_e64 v12, 32, v12
    ds_read_b64 v[36:37], v12 offset:43008
L_xr_13:
    v_mfma_f32_16x16x32_bf16 v[116:119], v[180:183], v[144:147], v[116:119]
    ds_read_b64_tr_b16 v[212:213], v7 offset:28672
    v_mfma_f32_16x16x32_bf16 v[64:67], v[172:175], v[148:151], v[64:67]
    ds_read_b64_tr_b16 v[214:215], v7 offset:29184
    v_mfma_f32_16x16x32_bf16 v[92:95], v[176:179], v[148:151], v[92:95]
    ds_read_b64_tr_b16 v[216:217], v7 offset:36864
    v_mfma_f32_16x16x32_bf16 v[120:123], v[180:183], v[148:151], v[120:123]
    ds_read_b64_tr_b16 v[218:219], v7 offset:37376
    v_mfma_f32_16x16x32_bf16 v[68:71], v[172:175], v[152:155], v[68:71]
    ds_read_b64_tr_b16 v[220:221], v7 offset:45056
    v_mfma_f32_16x16x32_bf16 v[96:99], v[176:179], v[152:155], v[96:99]
    ds_read_b64_tr_b16 v[222:223], v7 offset:45568
    v_mfma_f32_16x16x32_bf16 v[124:127], v[180:183], v[152:155], v[124:127]
    ds_read_b128 v[184:187], v5 offset:43008
    v_mfma_f32_16x16x32_bf16 v[72:75], v[172:175], v[156:159], v[72:75]
    ds_read_b128 v[188:191], v5 offset:45056
    v_mfma_f32_16x16x32_bf16 v[100:103], v[176:179], v[156:159], v[100:103]
    ds_read_b128 v[192:195], v5 offset:47104
    v_mfma_f32_16x16x32_bf16 v[128:131], v[180:183], v[156:159], v[128:131]
    ds_read_b128 v[196:199], v5 offset:49152
    v_mfma_f32_16x16x32_bf16 v[76:79], v[172:175], v[160:163], v[76:79]
    ds_read_b128 v[200:203], v5 offset:51200
    v_mfma_f32_16x16x32_bf16 v[104:107], v[176:179], v[160:163], v[104:107]
    ds_read_b128 v[204:207], v5 offset:53248
    v_mfma_f32_16x16x32_bf16 v[132:135], v[180:183], v[160:163], v[132:135]
    ds_read_b128 v[208:211], v5 offset:55296
    v_mfma_f32_16x16x32_bf16 v[80:83], v[172:175], v[164:167], v[80:83]
    v_mfma_f32_16x16x32_bf16 v[108:111], v[176:179], v[164:167], v[108:111]
    v_mfma_f32_16x16x32_bf16 v[136:139], v[180:183], v[164:167], v[136:139]
    v_mfma_f32_16x16x32_bf16 v[84:87], v[172:175], v[168:171], v[84:87]
    v_mfma_f32_16x16x32_bf16 v[112:115], v[176:179], v[168:171], v[112:115]
    v_mfma_f32_16x16x32_bf16 v[140:143], v[180:183], v[168:171], v[140:143]
    s_waitcnt lgkmcnt(0)
    s_barrier
    v_mfma_f32_16x16x32_bf16 v[88:91], v[216:219], v[184:187], v[88:91]
    ds_read_b128 v[14:17], v38 offset:0
    v_mfma_f32_16x16x32_bf16 v[116:119], v[220:223], v[184:187], v[116:119]
    ds_read_b128 v[18:21], v39 offset:0
    v_mfma_f32_16x16x32_bf16 v[64:67], v[212:215], v[188:191], v[64:67]
    ds_read_b128 v[22:25], v47 offset:0
    v_mfma_f32_16x16x32_bf16 v[92:95], v[216:219], v[188:191], v[92:95]
    ds_read_b128 v[56:59], v60 offset:0
    v_mfma_f32_16x16x32_bf16 v[120:123], v[220:223], v[188:191], v[120:123]
    ds_read_b64_tr_b16 v[172:173], v6 offset:0
    v_mfma_f32_16x16x32_bf16 v[68:71], v[212:215], v[192:195], v[68:71]
    ds_read_b64_tr_b16 v[174:175], v6 offset:512
    v_mfma_f32_16x16x32_bf16 v[96:99], v[216:219], v[192:195], v[96:99]
    ds_read_b64_tr_b16 v[176:177], v6 offset:8192
    v_mfma_f32_16x16x32_bf16 v[124:127], v[220:223], v[192:195], v[124:127]
    ds_read_b64_tr_b16 v[178:179], v6 offset:8704
    v_mfma_f32_16x16x32_bf16 v[72:75], v[212:215], v[196:199], v[72:75]
    ds_read_b64_tr_b16 v[180:181], v6 offset:16384
    v_mfma_f32_16x16x32_bf16 v[100:103], v[216:219], v[196:199], v[100:103]
    ds_read_b64_tr_b16 v[182:183], v6 offset:16896
    v_mfma_f32_16x16x32_bf16 v[128:131], v[220:223], v[196:199], v[128:131]
    ds_read_b128 v[144:147], v4 offset:0
    v_mfma_f32_16x16x32_bf16 v[76:79], v[212:215], v[200:203], v[76:79]
    ds_read_b128 v[148:151], v4 offset:2048
    v_mfma_f32_16x16x32_bf16 v[104:107], v[216:219], v[200:203], v[104:107]
    ds_read_b128 v[152:155], v4 offset:4096
    v_mfma_f32_16x16x32_bf16 v[132:135], v[220:223], v[200:203], v[132:135]
    ds_read_b128 v[156:159], v4 offset:6144
    v_mfma_f32_16x16x32_bf16 v[80:83], v[212:215], v[204:207], v[80:83]
    ds_read_b128 v[160:163], v4 offset:8192
    v_mfma_f32_16x16x32_bf16 v[108:111], v[216:219], v[204:207], v[108:111]
    ds_read_b128 v[164:167], v4 offset:10240
    v_mfma_f32_16x16x32_bf16 v[136:139], v[220:223], v[204:207], v[136:139]
    ds_read_b128 v[168:171], v4 offset:12288
    v_mfma_f32_16x16x32_bf16 v[84:87], v[212:215], v[208:211], v[84:87]
    v_mfma_f32_16x16x32_bf16 v[112:115], v[216:219], v[208:211], v[112:115]
    v_mfma_f32_16x16x32_bf16 v[140:143], v[220:223], v[208:211], v[140:143]
    s_waitcnt lgkmcnt(13)
    v_mfma_f32_16x16x32_bf16 v[48:51], v[14:17], v[14:17], v[48:51]
    v_mfma_f32_16x16x32_bf16 v[52:55], v[22:25], v[22:25], v[52:55]
    v_mfma_f32_16x16x32_bf16 v[48:51], v[18:21], v[18:21], v[48:51]
    v_mfma_f32_16x16x32_bf16 v[52:55], v[56:59], v[56:59], v[52:55]
    s_waitcnt lgkmcnt(0)
    v_mfma_f32_16x16x32_bf16 v[88:91], v[176:179], v[144:147], v[88:91]
    s_cmp_lg_u32 s75, 8
    s_cbranch_scc1 L_xr_14
    ds_read_b64 v[26:27], v0 offset:0
    v_xor_b32_e64 v0, 32, v0
    ds_read_b64 v[28:29], v0 offset:0
    ds_read_b64 v[30:31], v9 offset:0
    v_xor_b32_e64 v9, 32, v9
    ds_read_b64 v[32:33], v9 offset:0
    ds_read_b64 v[34:35], v12 offset:0
    v_xor_b32_e64 v12, 32, v12
    ds_read_b64 v[36:37], v12 offset:0
L_xr_14:
    v_mfma_f32_16x16x32_bf16 v[116:119], v[180:183], v[144:147], v[116:119]
    ds_read_b64_tr_b16 v[212:213], v6 offset:4096
    v_mfma_f32_16x16x32_bf16 v[64:67], v[172:175], v[148:151], v[64:67]
    ds_read_b64_tr_b16 v[214:215], v6 offset:4608
    v_mfma_f32_16x16x32_bf16 v[92:95], v[176:179], v[148:151], v[92:95]
    ds_read_b64_tr_b16 v[216:217], v6 offset:12288
    v_mfma_f32_16x16x32_bf16 v[120:123], v[180:183], v[148:151], v[120:123]
    ds_read_b64_tr_b16 v[218:219], v6 offset:12800
    v_mfma_f32_16x16x32_bf16 v[68:71], v[172:175], v[152:155], v[68:71]
    ds_read_b64_tr_b16 v[220:221], v6 offset:20480
    v_mfma_f32_16x16x32_bf16 v[96:99], v[176:179], v[152:155], v[96:99]
    ds_read_b64_tr_b16 v[222:223], v6 offset:20992
    v_mfma_f32_16x16x32_bf16 v[124:127], v[180:183], v[152:155], v[124:127]
    ds_read_b128 v[184:187], v5 offset:0
    v_mfma_f32_16x16x32_bf16 v[72:75], v[172:175], v[156:159], v[72:75]
    ds_read_b128 v[188:191], v5 offset:2048
    v_mfma_f32_16x16x32_bf16 v[100:103], v[176:179], v[156:159], v[100:103]
    ds_read_b128 v[192:195], v5 offset:4096
    v_mfma_f32_16x16x32_bf16 v[128:131], v[180:183], v[156:159], v[128:131]
    ds_read_b128 v[196:199], v5 offset:6144
    v_mfma_f32_16x16x32_bf16 v[76:79], v[172:175], v[160:163], v[76:79]
    ds_read_b128 v[200:203], v5 offset:8192
    v_mfma_f32_16x16x32_bf16 v[104:107], v[176:179], v[160:163], v[104:107]
    ds_read_b128 v[204:207], v5 offset:10240
    v_mfma_f32_16x16x32_bf16 v[132:135], v[180:183], v[160:163], v[132:135]
    ds_read_b128 v[208:211], v5 offset:12288
    v_mfma_f32_16x16x32_bf16 v[80:83], v[172:175], v[164:167], v[80:83]
    v_mfma_f32_16x16x32_bf16 v[108:111], v[176:179], v[164:167], v[108:111]
    v_mfma_f32_16x16x32_bf16 v[136:139], v[180:183], v[164:167], v[136:139]
    v_mfma_f32_16x16x32_bf16 v[84:87], v[172:175], v[168:171], v[84:87]
    v_mfma_f32_16x16x32_bf16 v[112:115], v[176:179], v[168:171], v[112:115]
    v_mfma_f32_16x16x32_bf16 v[140:143], v[180:183], v[168:171], v[140:143]
    s_waitcnt lgkmcnt(0)
    s_barrier
    v_mfma_f32_16x16x32_bf16 v[88:91], v[216:219], v[184:187], v[88:91]
    ds_read_b128 v[14:17], v38 offset:14336
    v_mfma_f32_16x16x32_bf16 v[116:119], v[220:223], v[184:187], v[116:119]
    ds_read_b128 v[18:21], v39 offset:14336
    v_mfma_f32_16x16x32_bf16 v[64:67], v[212:215], v[188:191], v[64:67]
    ds_read_b128 v[22:25], v47 offset:14336
    v_mfma_f32_16x16x32_bf16 v[92:95], v[216:219], v[188:191], v[92:95]
L_pad1:
    s_cbranch_execz L_pad2
    ds_read_b128 v[56:59], v60 offset:14336
    v_mfma_f32_16x16x32_bf16 v[120:123], v[220:223], v[188:191], v[120:123]
    ds_read_b64_tr_b16 v[172:173], v6 offset:24576
    v_mfma_f32_16x16x32_bf16 v[68:71], v[212:215], v[192:195], v[68:71]
    ds_read_b64_tr_b16 v[174:175], v6 offset:25088
    v_mfma_f32_16x16x32_bf16 v[96:99], v[216:219], v[192:195], v[96:99]
    ds_read_b64_tr_b16 v[176:177], v6 offset:32768
    v_mfma_f32_16x16x32_bf16 v[124:127], v[220:223], v[192:195], v[124:127]
    ds_read_b64_tr_b16 v[178:179], v6 offset:33280
    v_mfma_f32_16x16x32_bf16 v[72:75], v[212:215], v[196:199], v[72:75]
    ds_read_b64_tr_b16 v[180:181], v6 offset:40960
    v_mfma_f32_16x16x32_bf16 v[100:103], v[216:219], v[196:199], v[100:103]
    ds_read_b64_tr_b16 v[182:183], v6 offset:41472
    v_mfma_f32_16x16x32_bf16 v[128:131], v[220:223], v[196:199], v[128:131]
    ds_read_b128 v[144:147], v4 offset:14336
    v_mfma_f32_16x16x32_bf16 v[76:79], v[212:215], v[200:203], v[76:79]
    ds_read_b128 v[148:151], v4 offset:16384
    v_mfma_f32_16x16x32_bf16 v[104:107], v[216:219], v[200:203], v[104:107]
    ds_read_b128 v[152:155], v4 offset:18432
    v_mfma_f32_16x16x32_bf16 v[132:135], v[220:223], v[200:203], v[132:135]
    ds_read_b128 v[156:159], v4 offset:20480
    v_mfma_f32_16x16x32_bf16 v[80:83], v[212:215], v[204:207], v[80:83]
    ds_read_b128 v[160:163], v4 offset:22528
    v_mfma_f32_16x16x32_bf16 v[108:111], v[216:219], v[204:207], v[108:111]
    ds_read_b128 v[164:167], v4 offset:24576
    v_mfma_f32_16x16x32_bf16 v[136:139], v[220:223], v[204:207], v[136:139]
    ds_read_b128 v[168:171], v4 offset:26624
    v_mfma_f32_16x16x32_bf16 v[84:87], v[212:215], v[208:211], v[84:87]
    v_mfma_f32_16x16x32_bf16 v[112:115], v[216:219], v[208:211], v[112:115]
    v_mfma_f32_16x16x32_bf16 v[140:143], v[220:223], v[208:211], v[140:143]
    s_waitcnt lgkmcnt(13)
    v_mfma_f32_16x16x32_bf16 v[48:51], v[14:17], v[14:17], v[48:51]
    v_mfma_f32_16x16x32_bf16 v[52:55], v[22:25], v[22:25], v[52:55]
    v_mfma_f32_16x16x32_bf16 v[48:51], v[18:21], v[18:21], v[48:51]
    v_mfma_f32_16x16x32_bf16 v[52:55], v[56:59], v[56:59], v[52:55]
    s_waitcnt lgkmcnt(0)
    v_mfma_f32_16x16x32_bf16 v[88:91], v[176:179], v[144:147], v[88:91]
    s_cmp_lg_u32 s75, 9
    s_cbranch_scc1 L_xr_15
    ds_read_b64 v[26:27], v0 offset:14336
    v_xor_b32 v0, 32, v0
    ds_read_b64 v[28:29], v0 offset:14336
    ds_read_b64 v[30:31], v9 offset:14336
    v_xor_b32_e64 v9, 32, v9
    ds_read_b64 v[32:33], v9 offset:14336
    ds_read_b64 v[34:35], v12 offset:14336
    v_xor_b32_e64 v12, 32, v12
    ds_read_b64 v[36:37], v12 offset:14336
L_xr_15:
    v_mfma_f32_16x16x32_bf16 v[116:119], v[180:183], v[144:147], v[116:119]
    ds_read_b64_tr_b16 v[212:213], v6 offset:28672
    v_mfma_f32_16x16x32_bf16 v[64:67], v[172:175], v[148:151], v[64:67]
    ds_read_b64_tr_b16 v[214:215], v6 offset:29184
    v_mfma_f32_16x16x32_bf16 v[92:95], v[176:179], v[148:151], v[92:95]
    ds_read_b64_tr_b16 v[216:217], v6 offset:36864
    v_mfma_f32_16x16x32_bf16 v[120:123], v[180:183], v[148:151], v[120:123]
    ds_read_b64_tr_b16 v[218:219], v6 offset:37376
    v_mov_b32_e64 v14, v51
    v_mfma_f32_16x16x32_bf16 v[68:71], v[172:175], v[152:155], v[68:71]
    ds_read_b64_tr_b16 v[220:221], v6 offset:45056
    v_mov_b32_e64 v16, v55
    v_mfma_f32_16x16x32_bf16 v[96:99], v[176:179], v[152:155], v[96:99]
    ds_read_b64_tr_b16 v[222:223], v6 offset:45568
    v_mov_b32_e64 v15, v51
    v_mfma_f32_16x16x32_bf16 v[124:127], v[180:183], v[152:155], v[124:127]
    ds_read_b128 v[184:187], v5 offset:14336
    v_mov_b32_e64 v17, v55
    v_mfma_f32_16x16x32_bf16 v[72:75], v[172:175], v[156:159], v[72:75]
    ds_read_b128 v[188:191], v5 offset:16384
    v_cndmask_b32 v48, v48, v49, s[56:57]
    v_mfma_f32_16x16x32_bf16 v[100:103], v[176:179], v[156:159], v[100:103]
    ds_read_b128 v[192:195], v5 offset:18432
    v_cndmask_b32 v52, v52, v53, s[56:57]
    v_mfma_f32_16x16x32_bf16 v[128:131], v[180:183], v[156:159], v[128:131]
    ds_read_b128 v[196:199], v5 offset:20480
    v_permlane32_swap_b32 v14, v15
    v_mfma_f32_16x16x32_bf16 v[76:79], v[172:175], v[160:163], v[76:79]
    ds_read_b128 v[200:203], v5 offset:22528
    v_permlane32_swap_b32 v16, v17
    v_mfma_f32_16x16x32_bf16 v[104:107], v[176:179], v[160:163], v[104:107]
    ds_read_b128 v[204:207], v5 offset:24576
    v_cndmask_b32 v48, v48, v50, s[58:59]
    v_mfma_f32_16x16x32_bf16 v[132:135], v[180:183], v[160:163], v[132:135]
    ds_read_b128 v[208:211], v5 offset:26624
    v_cndmask_b32 v52, v52, v54, s[58:59]
    v_mfma_f32_16x16x32_bf16 v[80:83], v[172:175], v[164:167], v[80:83]
    v_mov_b32_e64 v14, v15
    v_mfma_f32_16x16x32_bf16 v[108:111], v[176:179], v[164:167], v[108:111]
    v_mov_b32_e64 v16, v17
    v_mfma_f32_16x16x32_bf16 v[136:139], v[180:183], v[164:167], v[136:139]
    v_cndmask_b32 v48, v48, v51, s[60:61]
    v_mfma_f32_16x16x32_bf16 v[84:87], v[172:175], v[168:171], v[84:87]
    v_cndmask_b32 v52, v52, v55, s[60:61]
    v_mfma_f32_16x16x32_bf16 v[112:115], v[176:179], v[168:171], v[112:115]
    v_permlane16_swap_b32 v14, v15
    v_mfma_f32_16x16x32_bf16 v[140:143], v[180:183], v[168:171], v[140:143]
    v_permlane16_swap_b32 v16, v17
    s_waitcnt lgkmcnt(0)
    v_mfma_f32_16x16x32_bf16 v[84:87], v[212:215], v[208:211], v[84:87]
    v_mul_f32 v48, s48, v48
    v_mul_f32_e64 v52, s48, v52
    v_mfma_f32_16x16x32_bf16 v[112:115], v[216:219], v[208:211], v[112:115]
    v_mul_f32 v15, s48, -v15
    v_mul_f32 v17, s48, -v17
    v_mfma_f32_16x16x32_bf16 v[140:143], v[220:223], v[208:211], v[140:143]
    v_fma_f32 v48, -v15, v15, v48
    v_fma_f32 v52, -v17, v17, v52
    v_mfma_f32_16x16x32_bf16 v[88:91], v[216:219], v[184:187], v[88:91]
    v_max_f32 v48, 0, v48
    v_max_f32 v52, 0, v52
    v_mfma_f32_16x16x32_bf16 v[116:119], v[220:223], v[184:187], v[116:119]
    v_add_f32 v48, s49, v48
    v_add_f32 v52, s49, v52
    v_mfma_f32_16x16x32_bf16 v[64:67], v[212:215], v[188:191], v[64:67]
    v_rsq_f32 v14, v48
    v_rsq_f32 v16, v52
    s_mov_b64 exec, s[50:51]
    ds_write2_b64 v61, v[14:15], v[16:17] offset0:0 offset1:13
    s_mov_b64 exec, -1
    v_mfma_f32_16x16x32_bf16 v[92:95], v[216:219], v[188:191], v[92:95]
    v_mov_b32_dpp v160, v84 row_newbcast:15 row_mask:0xf bank_mask:0xf
    v_mov_b32_dpp v161, v85 row_newbcast:15 row_mask:0xf bank_mask:0xf
    v_mfma_f32_16x16x32_bf16 v[120:123], v[220:223], v[188:191], v[120:123]
    v_mov_b32_dpp v162, v86 row_newbcast:15 row_mask:0xf bank_mask:0xf
    v_mov_b32_dpp v163, v87 row_newbcast:15 row_mask:0xf bank_mask:0xf
    v_mfma_f32_16x16x32_bf16 v[68:71], v[212:215], v[192:195], v[68:71]
    v_mov_b32_dpp v164, v112 row_newbcast:15 row_mask:0xf bank_mask:0xf
    v_mov_b32_dpp v165, v113 row_newbcast:15 row_mask:0xf bank_mask:0xf
    v_mfma_f32_16x16x32_bf16 v[96:99], v[216:219], v[192:195], v[96:99]
    v_mov_b32_dpp v166, v114 row_newbcast:15 row_mask:0xf bank_mask:0xf
    v_mov_b32_dpp v167, v115 row_newbcast:15 row_mask:0xf bank_mask:0xf
    s_waitcnt lgkmcnt(0)
    s_barrier
    v_mfma_f32_16x16x32_bf16 v[124:127], v[220:223], v[192:195], v[124:127]
    ds_read_b64 v[156:157], v8 offset:768
    ds_read_b64 v[144:145], v8 offset:0
    v_mfma_f32_16x16x32_bf16 v[72:75], v[212:215], v[196:199], v[72:75]
    ds_read_b64 v[146:147], v8 offset:128
    ds_read_b64 v[148:149], v8 offset:256
    v_mfma_f32_16x16x32_bf16 v[100:103], v[216:219], v[196:199], v[100:103]
    ds_read_b64 v[150:151], v8 offset:384
    ds_read_b64 v[152:153], v8 offset:512
    v_mfma_f32_16x16x32_bf16 v[128:131], v[220:223], v[196:199], v[128:131]
    ds_read_b64 v[154:155], v8 offset:640
    ds_read_b32 v11, v11
    v_mfma_f32_16x16x32_bf16 v[76:79], v[212:215], v[200:203], v[76:79]
    v_mov_b32_dpp v168, v140 row_newbcast:15 row_mask:0xf bank_mask:0xf
    v_mov_b32_dpp v169, v141 row_newbcast:15 row_mask:0xf bank_mask:0xf
    v_mfma_f32_16x16x32_bf16 v[104:107], v[216:219], v[200:203], v[104:107]
    v_mov_b32_dpp v170, v142 row_newbcast:15 row_mask:0xf bank_mask:0xf
    v_mov_b32_dpp v171, v143 row_newbcast:15 row_mask:0xf bank_mask:0xf
    v_mfma_f32_16x16x32_bf16 v[132:135], v[220:223], v[200:203], v[132:135]
    v_mfma_f32_16x16x32_bf16 v[80:83], v[212:215], v[204:207], v[80:83]
    v_mfma_f32_16x16x32_bf16 v[108:111], v[216:219], v[204:207], v[108:111]
    v_mfma_f32_16x16x32_bf16 v[136:139], v[220:223], v[204:207], v[136:139]
    s_waitcnt lgkmcnt(0) vmcnt(0)
    v_readfirstlane_b32 s47, v11
    s_cmp_eq_u32 s82, 1
    s_cbranch_scc1 L_exp_16
    v_pk_fma_f32 v[112:113], v[164:165], v[156:157], v[112:113] op_sel:[0,1,0] op_sel_hi:[1,1,1]
    v_pk_fma_f32 v[114:115], v[166:167], v[156:157], v[114:115] op_sel:[0,1,0] op_sel_hi:[1,1,1]
    v_pk_mul_f32 v[112:113], v[112:113], v[156:157] op_sel_hi:[1,0]
    v_pk_mul_f32 v[114:115], v[114:115], v[156:157] op_sel_hi:[1,0]
    v_cvt_pk_bf16_f32 v112, v112, v113
    v_cvt_pk_bf16_f32 v113, v114, v115
    v_pk_fma_f32 v[140:141], v[168:169], v[156:157], v[140:141] op_sel:[0,1,0] op_sel_hi:[1,1,1]
    v_pk_fma_f32 v[142:143], v[170:171], v[156:157], v[142:143] op_sel:[0,1,0] op_sel_hi:[1,1,1]
    v_pk_mul_f32 v[140:141], v[140:141], v[156:157] op_sel_hi:[1,0]
    v_pk_mul_f32 v[142:143], v[142:143], v[156:157] op_sel_hi:[1,0]
    v_cvt_pk_bf16_f32 v114, v140, v141
    v_cvt_pk_bf16_f32 v115, v142, v143
    ds_write2_b64 v46, v[112:113], v[114:115] offset0:20 offset1:40
    v_pk_fma_f32 v[88:89], v[164:165], v[144:145], v[88:89] op_sel:[0,1,0] op_sel_hi:[1,1,1]
    v_pk_fma_f32 v[90:91], v[166:167], v[144:145], v[90:91] op_sel:[0,1,0] op_sel_hi:[1,1,1]
    v_pk_mul_f32 v[88:89], v[88:89], v[144:145] op_sel_hi:[1,0]
    v_pk_mul_f32 v[90:91], v[90:91], v[144:145] op_sel_hi:[1,0]
    v_cvt_pk_bf16_f32 v88, v88, v89
    v_cvt_pk_bf16_f32 v89, v90, v91
    v_pk_fma_f32 v[116:117], v[168:169], v[144:145], v[116:117] op_sel:[0,1,0] op_sel_hi:[1,1,1]
    v_pk_fma_f32 v[118:119], v[170:171], v[144:145], v[118:119] op_sel:[0,1,0] op_sel_hi:[1,1,1]
    v_pk_mul_f32 v[116:117], v[116:117], v[144:145] op_sel_hi:[1,0]
    v_pk_mul_f32 v[118:119], v[118:119], v[144:145] op_sel_hi:[1,0]
    v_cvt_pk_bf16_f32 v90, v116, v117
    v_cvt_pk_bf16_f32 v91, v118, v119
    ds_write2_b64 v40, v[88:89], v[90:91] offset0:20 offset1:40
    v_pk_fma_f32 v[92:93], v[164:165], v[146:147], v[92:93] op_sel:[0,1,0] op_sel_hi:[1,1,1]
    v_pk_fma_f32 v[94:95], v[166:167], v[146:147], v[94:95] op_sel:[0,1,0] op_sel_hi:[1,1,1]
    v_pk_mul_f32 v[92:93], v[92:93], v[146:147] op_sel_hi:[1,0]
    v_pk_mul_f32 v[94:95], v[94:95], v[146:147] op_sel_hi:[1,0]
    v_cvt_pk_bf16_f32 v92, v92, v93
    v_cvt_pk_bf16_f32 v93, v94, v95
    v_pk_fma_f32 v[120:121], v[168:169], v[146:147], v[120:121] op_sel:[0,1,0] op_sel_hi:[1,1,1]
    v_pk_fma_f32 v[122:123], v[170:171], v[146:147], v[122:123] op_sel:[0,1,0] op_sel_hi:[1,1,1]
    v_pk_mul_f32 v[120:121], v[120:121], v[146:147] op_sel_hi:[1,0]
    v_pk_mul_f32 v[122:123], v[122:123], v[146:147] op_sel_hi:[1,0]
    v_cvt_pk_bf16_f32 v94, v120, v121
    v_cvt_pk_bf16_f32 v95, v122, v123
    ds_write2_b64 v41, v[92:93], v[94:95] offset0:20 offset1:40
    v_pk_fma_f32 v[96:97], v[164:165], v[148:149], v[96:97] op_sel:[0,1,0] op_sel_hi:[1,1,1]
    v_pk_fma_f32 v[98:99], v[166:167], v[148:149], v[98:99] op_sel:[0,1,0] op_sel_hi:[1,1,1]
    v_pk_mul_f32 v[96:97], v[96:97], v[148:149] op_sel_hi:[1,0]
    v_pk_mul_f32 v[98:99], v[98:99], v[148:149] op_sel_hi:[1,0]
    v_cvt_pk_bf16_f32 v96, v96, v97
    v_cvt_pk_bf16_f32 v97, v98, v99
    v_pk_fma_f32 v[124:125], v[168:169], v[148:149], v[124:125] op_sel:[0,1,0] op_sel_hi:[1,1,1]
    v_pk_fma_f32 v[126:127], v[170:171], v[148:149], v[126:127] op_sel:[0,1,0] op_sel_hi:[1,1,1]
    v_pk_mul_f32 v[124:125], v[124:125], v[148:149] op_sel_hi:[1,0]
    v_pk_mul_f32 v[126:127], v[126:127], v[148:149] op_sel_hi:[1,0]
    v_cvt_pk_bf16_f32 v98, v124, v125
    v_cvt_pk_bf16_f32 v99, v126, v127
    ds_write2_b64 v42, v[96:97], v[98:99] offset0:20 offset1:40
    v_pk_fma_f32 v[64:65], v[160:161], v[146:147], v[64:65] op_sel:[0,1,0] op_sel_hi:[1,1,1]
    v_pk_fma_f32 v[66:67], v[162:163], v[146:147], v[66:67] op_sel:[0,1,0] op_sel_hi:[1,1,1]
    v_cvt_pk_bf16_f32 v64, v64, v65
    v_cvt_pk_bf16_f32 v65, v66, v67
    v_pk_fma_f32 v[68:69], v[160:161], v[148:149], v[68:69] op_sel:[0,1,0] op_sel_hi:[1,1,1]
    v_pk_fma_f32 v[70:71], v[162:163], v[148:149], v[70:71] op_sel:[0,1,0] op_sel_hi:[1,1,1]
    v_cvt_pk_bf16_f32 v66, v68, v69
    v_cvt_pk_bf16_f32 v67, v70, v71
    ds_write_b64 v41, v[64:65]
    ds_write_b64 v42, v[66:67]
    v_pk_fma_f32 v[100:101], v[164:165], v[150:151], v[100:101] op_sel:[0,1,0] op_sel_hi:[1,1,1]
    v_pk_fma_f32 v[102:103], v[166:167], v[150:151], v[102:103] op_sel:[0,1,0] op_sel_hi:[1,1,1]
    v_pk_mul_f32 v[100:101], v[100:101], v[150:151] op_sel_hi:[1,0]
    v_pk_mul_f32 v[102:103], v[102:103], v[150:151] op_sel_hi:[1,0]
    v_cvt_pk_bf16_f32 v100, v100, v101
    v_cvt_pk_bf16_f32 v101, v102, v103
    v_pk_fma_f32 v[128:129], v[168:169], v[150:151], v[128:129] op_sel:[0,1,0] op_sel_hi:[1,1,1]
    v_pk_fma_f32 v[130:131], v[170:171], v[150:151], v[130:131] op_sel:[0,1,0] op_sel_hi:[1,1,1]
    v_pk_mul_f32 v[128:129], v[128:129], v[150:151] op_sel_hi:[1,0]
    v_pk_mul_f32 v[130:131], v[130:131], v[150:151] op_sel_hi:[1,0]
    v_cvt_pk_bf16_f32 v102, v128, v129
    v_cvt_pk_bf16_f32 v103, v130, v131
    ds_write2_b64 v43, v[100:101], v[102:103] offset0:20 offset1:40
    v_pk_fma_f32 v[104:105], v[164:165], v[152:153], v[104:105] op_sel:[0,1,0] op_sel_hi:[1,1,1]
    v_pk_fma_f32 v[106:107], v[166:167], v[152:153], v[106:107] op_sel:[0,1,0] op_sel_hi:[1,1,1]
    v_pk_mul_f32 v[104:105], v[104:105], v[152:153] op_sel_hi:[1,0]
    v_pk_mul_f32 v[106:107], v[106:107], v[152:153] op_sel_hi:[1,0]
    v_cvt_pk_bf16_f32 v104, v104, v105
    v_cvt_pk_bf16_f32 v105, v106, v107
    v_pk_fma_f32 v[132:133], v[168:169], v[152:153], v[132:133] op_sel:[0,1,0] op_sel_hi:[1,1,1]
    v_pk_fma_f32 v[134:135], v[170:171], v[152:153], v[134:135] op_sel:[0,1,0] op_sel_hi:[1,1,1]
    v_pk_mul_f32 v[132:133], v[132:133], v[152:153] op_sel_hi:[1,0]
    v_pk_mul_f32 v[134:135], v[134:135], v[152:153] op_sel_hi:[1,0]
    v_cvt_pk_bf16_f32 v106, v132, v133
    v_cvt_pk_bf16_f32 v107, v134, v135
    ds_write2_b64 v44, v[104:105], v[106:107] offset0:20 offset1:40
    v_pk_fma_f32 v[72:73], v[160:161], v[150:151], v[72:73] op_sel:[0,1,0] op_sel_hi:[1,1,1]
    v_pk_fma_f32 v[74:75], v[162:163], v[150:151], v[74:75] op_sel:[0,1,0] op_sel_hi:[1,1,1]
    v_cvt_pk_bf16_f32 v72, v72, v73
    v_cvt_pk_bf16_f32 v73, v74, v75
    v_pk_fma_f32 v[76:77], v[160:161], v[152:153], v[76:77] op_sel:[0,1,0] op_sel_hi:[1,1,1]
    v_pk_fma_f32 v[78:79], v[162:163], v[152:153], v[78:79] op_sel:[0,1,0] op_sel_hi:[1,1,1]
    v_cvt_pk_bf16_f32 v74, v76, v77
    v_cvt_pk_bf16_f32 v75, v78, v79
    ds_write_b64 v43, v[72:73]
    ds_write_b64 v44, v[74:75]
    v_pk_fma_f32 v[108:109], v[164:165], v[154:155], v[108:109] op_sel:[0,1,0] op_sel_hi:[1,1,1]
    v_pk_fma_f32 v[110:111], v[166:167], v[154:155], v[110:111] op_sel:[0,1,0] op_sel_hi:[1,1,1]
    v_pk_mul_f32 v[108:109], v[108:109], v[154:155] op_sel_hi:[1,0]
    v_pk_mul_f32 v[110:111], v[110:111], v[154:155] op_sel_hi:[1,0]
    v_cvt_pk_bf16_f32 v108, v108, v109
    v_cvt_pk_bf16_f32 v109, v110, v111
    v_pk_fma_f32 v[136:137], v[168:169], v[154:155], v[136:137] op_sel:[0,1,0] op_sel_hi:[1,1,1]
    v_pk_fma_f32 v[138:139], v[170:171], v[154:155], v[138:139] op_sel:[0,1,0] op_sel_hi:[1,1,1]
    v_pk_mul_f32 v[136:137], v[136:137], v[154:155] op_sel_hi:[1,0]
    v_pk_mul_f32 v[138:139], v[138:139], v[154:155] op_sel_hi:[1,0]
    v_cvt_pk_bf16_f32 v110, v136, v137
    v_cvt_pk_bf16_f32 v111, v138, v139
    ds_write2_b64 v45, v[108:109], v[110:111] offset0:20 offset1:40
    v_pk_fma_f32 v[80:81], v[160:161], v[154:155], v[80:81] op_sel:[0,1,0] op_sel_hi:[1,1,1]
    v_pk_fma_f32 v[82:83], v[162:163], v[154:155], v[82:83] op_sel:[0,1,0] op_sel_hi:[1,1,1]
    v_cvt_pk_bf16_f32 v80, v80, v81
    v_cvt_pk_bf16_f32 v81, v82, v83
    v_pk_fma_f32 v[84:85], v[160:161], v[156:157], v[84:85] op_sel:[0,1,0] op_sel_hi:[1,1,1]
    v_pk_fma_f32 v[86:87], v[162:163], v[156:157], v[86:87] op_sel:[0,1,0] op_sel_hi:[1,1,1]
    v_cvt_pk_bf16_f32 v82, v84, v85
    v_cvt_pk_bf16_f32 v83, v86, v87
    ds_write_b64 v45, v[80:81]
    ds_write_b64 v46, v[82:83]
    s_branch L_attn
L_exp_16:
L_pad2:
    s_cbranch_execz L_back
    v_pk_fma_f32 v[112:113], v[164:165], v[156:157], v[112:113] op_sel:[0,1,0] op_sel_hi:[1,1,1]
    v_pk_fma_f32 v[114:115], v[166:167], v[156:157], v[114:115] op_sel:[0,1,0] op_sel_hi:[1,1,1]
    v_pk_mul_f32 v[112:113], v[112:113], v[156:157] op_sel_hi:[1,0]
    v_pk_mul_f32 v[114:115], v[114:115], v[156:157] op_sel_hi:[1,0]
    v_cvt_pk_bf16_f32 v112, v112, v113
    v_cvt_pk_bf16_f32 v113, v114, v115
    v_pk_fma_f32 v[140:141], v[168:169], v[156:157], v[140:141] op_sel:[0,1,0] op_sel_hi:[1,1,1]
    v_pk_fma_f32 v[142:143], v[170:171], v[156:157], v[142:143] op_sel:[0,1,0] op_sel_hi:[1,1,1]
    v_pk_mul_f32 v[140:141], v[140:141], v[156:157] op_sel_hi:[1,0]
    v_pk_mul_f32 v[142:143], v[142:143], v[156:157] op_sel_hi:[1,0]
    v_cvt_pk_bf16_f32 v114, v140, v141
    v_cvt_pk_bf16_f32 v115, v142, v143
    buffer_store_dwordx4 v[112:115], v10, s[32:35], s73 offen offset:1536
    v_pk_fma_f32 v[88:89], v[164:165], v[144:145], v[88:89] op_sel:[0,1,0] op_sel_hi:[1,1,1]
    v_pk_fma_f32 v[90:91], v[166:167], v[144:145], v[90:91] op_sel:[0,1,0] op_sel_hi:[1,1,1]
    v_pk_mul_f32 v[88:89], v[88:89], v[144:145] op_sel_hi:[1,0]
    v_pk_mul_f32 v[90:91], v[90:91], v[144:145] op_sel_hi:[1,0]
    v_cvt_pk_bf16_f32 v88, v88, v89
    v_cvt_pk_bf16_f32 v89, v90, v91
    v_pk_fma_f32 v[116:117], v[168:169], v[144:145], v[116:117] op_sel:[0,1,0] op_sel_hi:[1,1,1]
    v_pk_fma_f32 v[118:119], v[170:171], v[144:145], v[118:119] op_sel:[0,1,0] op_sel_hi:[1,1,1]
    v_pk_mul_f32 v[116:117], v[116:117], v[144:145] op_sel_hi:[1,0]
    v_pk_mul_f32 v[118:119], v[118:119], v[144:145] op_sel_hi:[1,0]
    v_cvt_pk_bf16_f32 v90, v116, v117
    v_cvt_pk_bf16_f32 v91, v118, v119
    buffer_store_dwordx4 v[88:91], v10, s[32:35], s73 offen offset:0
    v_pk_fma_f32 v[92:93], v[164:165], v[146:147], v[92:93] op_sel:[0,1,0] op_sel_hi:[1,1,1]
    v_pk_fma_f32 v[94:95], v[166:167], v[146:147], v[94:95] op_sel:[0,1,0] op_sel_hi:[1,1,1]
    v_pk_mul_f32 v[92:93], v[92:93], v[146:147] op_sel_hi:[1,0]
    v_pk_mul_f32 v[94:95], v[94:95], v[146:147] op_sel_hi:[1,0]
    v_cvt_pk_bf16_f32 v92, v92, v93
    v_cvt_pk_bf16_f32 v93, v94, v95
    v_pk_fma_f32 v[120:121], v[168:169], v[146:147], v[120:121] op_sel:[0,1,0] op_sel_hi:[1,1,1]
    v_pk_fma_f32 v[122:123], v[170:171], v[146:147], v[122:123] op_sel:[0,1,0] op_sel_hi:[1,1,1]
    v_pk_mul_f32 v[120:121], v[120:121], v[146:147] op_sel_hi:[1,0]
    v_pk_mul_f32 v[122:123], v[122:123], v[146:147] op_sel_hi:[1,0]
    v_cvt_pk_bf16_f32 v94, v120, v121
    v_cvt_pk_bf16_f32 v95, v122, v123
    buffer_store_dwordx4 v[92:95], v10, s[32:35], s73 offen offset:256
    v_pk_fma_f32 v[96:97], v[164:165], v[148:149], v[96:97] op_sel:[0,1,0] op_sel_hi:[1,1,1]
    v_pk_fma_f32 v[98:99], v[166:167], v[148:149], v[98:99] op_sel:[0,1,0] op_sel_hi:[1,1,1]
    v_pk_mul_f32 v[96:97], v[96:97], v[148:149] op_sel_hi:[1,0]
    v_pk_mul_f32 v[98:99], v[98:99], v[148:149] op_sel_hi:[1,0]
    v_cvt_pk_bf16_f32 v96, v96, v97
    v_cvt_pk_bf16_f32 v97, v98, v99
    v_pk_fma_f32 v[124:125], v[168:169], v[148:149], v[124:125] op_sel:[0,1,0] op_sel_hi:[1,1,1]
    v_pk_fma_f32 v[126:127], v[170:171], v[148:149], v[126:127] op_sel:[0,1,0] op_sel_hi:[1,1,1]
    v_pk_mul_f32 v[124:125], v[124:125], v[148:149] op_sel_hi:[1,0]
    v_pk_mul_f32 v[126:127], v[126:127], v[148:149] op_sel_hi:[1,0]
    v_cvt_pk_bf16_f32 v98, v124, v125
    v_cvt_pk_bf16_f32 v99, v126, v127
    buffer_store_dwordx4 v[96:99], v10, s[32:35], s73 offen offset:512
    v_pk_fma_f32 v[64:65], v[160:161], v[146:147], v[64:65] op_sel:[0,1,0] op_sel_hi:[1,1,1]
    v_pk_fma_f32 v[66:67], v[162:163], v[146:147], v[66:67] op_sel:[0,1,0] op_sel_hi:[1,1,1]
    v_cvt_pk_bf16_f32 v64, v64, v65
    v_cvt_pk_bf16_f32 v65, v66, v67
    v_pk_fma_f32 v[68:69], v[160:161], v[148:149], v[68:69] op_sel:[0,1,0] op_sel_hi:[1,1,1]
    v_pk_fma_f32 v[70:71], v[162:163], v[148:149], v[70:71] op_sel:[0,1,0] op_sel_hi:[1,1,1]
    v_cvt_pk_bf16_f32 v66, v68, v69
    v_cvt_pk_bf16_f32 v67, v70, v71
    buffer_store_dwordx4 v[64:67], v13, s[32:35], s74 offen offset:0
    v_pk_fma_f32 v[100:101], v[164:165], v[150:151], v[100:101] op_sel:[0,1,0] op_sel_hi:[1,1,1]
    v_pk_fma_f32 v[102:103], v[166:167], v[150:151], v[102:103] op_sel:[0,1,0] op_sel_hi:[1,1,1]
    v_pk_mul_f32 v[100:101], v[100:101], v[150:151] op_sel_hi:[1,0]
    v_pk_mul_f32 v[102:103], v[102:103], v[150:151] op_sel_hi:[1,0]
    v_cvt_pk_bf16_f32 v100, v100, v101
    v_cvt_pk_bf16_f32 v101, v102, v103
    v_pk_fma_f32 v[128:129], v[168:169], v[150:151], v[128:129] op_sel:[0,1,0] op_sel_hi:[1,1,1]
    v_pk_fma_f32 v[130:131], v[170:171], v[150:151], v[130:131] op_sel:[0,1,0] op_sel_hi:[1,1,1]
    v_pk_mul_f32 v[128:129], v[128:129], v[150:151] op_sel_hi:[1,0]
    v_pk_mul_f32 v[130:131], v[130:131], v[150:151] op_sel_hi:[1,0]
    v_cvt_pk_bf16_f32 v102, v128, v129
    v_cvt_pk_bf16_f32 v103, v130, v131
    buffer_store_dwordx4 v[100:103], v10, s[32:35], s73 offen offset:768
    v_pk_fma_f32 v[104:105], v[164:165], v[152:153], v[104:105] op_sel:[0,1,0] op_sel_hi:[1,1,1]
    v_pk_fma_f32 v[106:107], v[166:167], v[152:153], v[106:107] op_sel:[0,1,0] op_sel_hi:[1,1,1]
    v_pk_mul_f32 v[104:105], v[104:105], v[152:153] op_sel_hi:[1,0]
    v_pk_mul_f32 v[106:107], v[106:107], v[152:153] op_sel_hi:[1,0]
    v_cvt_pk_bf16_f32 v104, v104, v105
    v_cvt_pk_bf16_f32 v105, v106, v107
    v_pk_fma_f32 v[132:133], v[168:169], v[152:153], v[132:133] op_sel:[0,1,0] op_sel_hi:[1,1,1]
    v_pk_fma_f32 v[134:135], v[170:171], v[152:153], v[134:135] op_sel:[0,1,0] op_sel_hi:[1,1,1]
    v_pk_mul_f32 v[132:133], v[132:133], v[152:153] op_sel_hi:[1,0]
    v_pk_mul_f32 v[134:135], v[134:135], v[152:153] op_sel_hi:[1,0]
    v_cvt_pk_bf16_f32 v106, v132, v133
    v_cvt_pk_bf16_f32 v107, v134, v135
    buffer_store_dwordx4 v[104:107], v10, s[32:35], s73 offen offset:1024
    v_pk_fma_f32 v[72:73], v[160:161], v[150:151], v[72:73] op_sel:[0,1,0] op_sel_hi:[1,1,1]
    v_pk_fma_f32 v[74:75], v[162:163], v[150:151], v[74:75] op_sel:[0,1,0] op_sel_hi:[1,1,1]
    v_cvt_pk_bf16_f32 v72, v72, v73
    v_cvt_pk_bf16_f32 v73, v74, v75
    v_pk_fma_f32 v[76:77], v[160:161], v[152:153], v[76:77] op_sel:[0,1,0] op_sel_hi:[1,1,1]
    v_pk_fma_f32 v[78:79], v[162:163], v[152:153], v[78:79] op_sel:[0,1,0] op_sel_hi:[1,1,1]
    v_cvt_pk_bf16_f32 v74, v76, v77
    v_cvt_pk_bf16_f32 v75, v78, v79
    buffer_store_dwordx4 v[72:75], v13, s[32:35], s74 offen offset:256
    v_pk_fma_f32 v[108:109], v[164:165], v[154:155], v[108:109] op_sel:[0,1,0] op_sel_hi:[1,1,1]
    v_pk_fma_f32 v[110:111], v[166:167], v[154:155], v[110:111] op_sel:[0,1,0] op_sel_hi:[1,1,1]
    v_pk_mul_f32 v[108:109], v[108:109], v[154:155] op_sel_hi:[1,0]
    v_pk_mul_f32 v[110:111], v[110:111], v[154:155] op_sel_hi:[1,0]
    v_cvt_pk_bf16_f32 v108, v108, v109
    v_cvt_pk_bf16_f32 v109, v110, v111
    v_pk_fma_f32 v[136:137], v[168:169], v[154:155], v[136:137] op_sel:[0,1,0] op_sel_hi:[1,1,1]
    v_pk_fma_f32 v[138:139], v[170:171], v[154:155], v[138:139] op_sel:[0,1,0] op_sel_hi:[1,1,1]
    v_pk_mul_f32 v[136:137], v[136:137], v[154:155] op_sel_hi:[1,0]
    v_pk_mul_f32 v[138:139], v[138:139], v[154:155] op_sel_hi:[1,0]
    v_cvt_pk_bf16_f32 v110, v136, v137
    v_cvt_pk_bf16_f32 v111, v138, v139
    buffer_store_dwordx4 v[108:111], v10, s[32:35], s73 offen offset:1280
    v_pk_fma_f32 v[80:81], v[160:161], v[154:155], v[80:81] op_sel:[0,1,0] op_sel_hi:[1,1,1]
    v_pk_fma_f32 v[82:83], v[162:163], v[154:155], v[82:83] op_sel:[0,1,0] op_sel_hi:[1,1,1]
    v_cvt_pk_bf16_f32 v80, v80, v81
    v_cvt_pk_bf16_f32 v81, v82, v83
    v_pk_fma_f32 v[84:85], v[160:161], v[156:157], v[84:85] op_sel:[0,1,0] op_sel_hi:[1,1,1]
    v_pk_fma_f32 v[86:87], v[162:163], v[156:157], v[86:87] op_sel:[0,1,0] op_sel_hi:[1,1,1]
    v_cvt_pk_bf16_f32 v82, v84, v85
    v_cvt_pk_bf16_f32 v83, v86, v87
    buffer_store_dwordx4 v[80:83], v13, s[32:35], s74 offen offset:512
    ds_write2_b64 v46, v[112:113], v[114:115] offset0:20 offset1:40
    ds_write2_b64 v40, v[88:89], v[90:91] offset0:20 offset1:40
    ds_write2_b64 v41, v[92:93], v[94:95] offset0:20 offset1:40
    ds_write2_b64 v42, v[96:97], v[98:99] offset0:20 offset1:40
    ds_write_b64 v41, v[64:65]
    ds_write_b64 v42, v[66:67]
    ds_write2_b64 v43, v[100:101], v[102:103] offset0:20 offset1:40
    ds_write2_b64 v44, v[104:105], v[106:107] offset0:20 offset1:40
    ds_write_b64 v43, v[72:73]
    ds_write_b64 v44, v[74:75]
    ds_write2_b64 v45, v[108:109], v[110:111] offset0:20 offset1:40
    ds_write_b64 v45, v[80:81]
    ds_write_b64 v46, v[82:83]
    s_cmp_eq_u32 s47, 0
    s_cbranch_scc1 L_attn
    s_waitcnt vmcnt(0)
    buffer_wbl2 sc1
L_attn:
    s_waitcnt lgkmcnt(0)
    s_barrier
    s_cmp_eq_u32 s3, 0
    s_cbranch_scc1 L_nomid_19
    s_add_u32 s56, s73, 716800
    s_add_u32 m0, s46, 8192
    s_nop 0
    buffer_load_dwordx4 v12, s[12:15], s56 offen lds
    s_add_u32 s56, s73, 768000
    s_add_u32 m0, s46, 12288
    s_nop 0
    buffer_load_dwordx4 v12, s[12:15], s56 offen lds
    s_add_u32 s56, s74, 0
    s_add_u32 m0, s46, 16384
    s_nop 0
    buffer_load_dwordx4 v55, s[12:15], s56 offen lds
    s_add_u32 s56, s74, 204800
    s_add_u32 m0, s46, 20480
    s_nop 0
    buffer_load_dwordx4 v55, s[12:15], s56 offen lds
    s_add_u32 s56, s74, 409600
    s_add_u32 m0, s46, 24576
    s_nop 0
    buffer_load_dwordx4 v55, s[12:15], s56 offen lds
    s_add_u32 s56, s74, 614400
    s_add_u32 m0, s46, 28672
    s_nop 0
    buffer_load_dwordx4 v55, s[12:15], s56 offen lds
L_nomid_19:
    s_cmp_eq_u32 s68, 0
    s_cbranch_scc1 L_asig_17
    ds_read_b64 v[72:73], v240 offset:160
    ds_read_b64 v[74:75], v241 offset:160
    ds_read_b64 v[64:65], v232 offset:3968
    ds_read_b64 v[66:67], v233 offset:3968
    ds_read_b64 v[76:77], v242 offset:160
    ds_read_b64 v[78:79], v243 offset:160
    ds_read_b64 v[68:69], v234 offset:3968
    ds_read_b64 v[70:71], v235 offset:3968
    ds_read_b64 v[88:89], v240 offset:8096
    ds_read_b64 v[90:91], v241 offset:8096
    ds_read_b64 v[80:81], v232 offset:11904
    ds_read_b64 v[82:83], v233 offset:11904
    ds_read_b64 v[92:93], v242 offset:8096
    ds_read_b64 v[94:95], v243 offset:8096
    ds_read_b64 v[84:85], v234 offset:11904
    ds_read_b64 v[86:87], v235 offset:11904
    v_mov_b32 v192, 0
    v_mov_b32 v193, 0
    v_mov_b32 v194, 0
    v_mov_b32 v195, 0
    v_mov_b32 v196, 0
    v_mov_b32 v197, 0
    v_mov_b32 v198, 0
    v_mov_b32 v199, 0
    v_mov_b32 v200, 0
    v_mov_b32 v201, 0
    v_mov_b32 v202, 0
    v_mov_b32 v203, 0
    s_waitcnt lgkmcnt(8)
    v_mfma_f32_16x16x32_bf16 v[132:135], v[72:75], v[64:67], v[228:231]
    v_mfma_f32_16x16x32_bf16 v[132:135], v[76:79], v[68:71], v[132:135]
    s_nop 0
    ds_read_b64 v[104:105], v240 offset:16032
    ds_read_b64 v[106:107], v241 offset:16032
    ds_read_b64 v[96:97], v232 offset:19840
    ds_read_b64 v[98:99], v233 offset:19840
    ds_read_b64 v[108:109], v244 offset:16032
    ds_read_b64 v[110:111], v245 offset:16032
    ds_read_b64 v[100:101], v234 offset:19840
    ds_read_b64 v[102:103], v235 offset:19840
    s_waitcnt lgkmcnt(8)
    v_mfma_f32_16x16x32_bf16 v[136:139], v[88:91], v[80:83], v[224:227]
    v_mfma_f32_16x16x32_bf16 v[136:139], v[92:95], v[84:87], v[136:139]
    s_nop 0
    ds_read_b32 v176, v255 offset:0
    ds_read_b32 v177, v255 offset:256
    ds_read_b32 v178, v255 offset:512
    ds_read_b64_tr_b16 v[112:113], v252 offset:320
    ds_read_b64_tr_b16 v[114:115], v252 offset:8256
    ds_read_b64_tr_b16 v[116:117], v252 offset:16192
    ds_read_b64_tr_b16 v[118:119], v253 offset:24128
    s_waitcnt lgkmcnt(7)
    v_mfma_f32_16x16x32_bf16 v[140:143], v[104:107], v[96:99], v[224:227]
    v_mfma_f32_16x16x32_bf16 v[140:143], v[108:111], v[100:103], v[140:143]
    s_nop 0
    ds_read_b64_tr_b16 v[120:121], v249 offset:352
    ds_read_b64_tr_b16 v[122:123], v249 offset:8288
    ds_read_b64_tr_b16 v[124:125], v250 offset:8288
    ds_read_b64_tr_b16 v[126:127], v250 offset:16224
    ds_read_b64_tr_b16 v[128:129], v251 offset:16224
    ds_read_b64_tr_b16 v[130:131], v254 offset:24160
    s_mov_b32 s48, 0x3ea52b5c
    s_mov_b32 s50, 0xff00ff00
    s_mov_b32 s51, 0
    s_not_b64 s[52:53], s[50:51]
    v_max3_f32 v172, v132, v133, v134
    v_max3_f32 v173, v136, v137, v138
    v_max_f32 v172, v172, v135
    v_max_f32 v173, v173, v139
    s_waitcnt lgkmcnt(10)
    v_mul_f32 v176, s48, v176
    v_mul_f32 v177, s48, v177
    v_mul_f32 v178, s48, v178
    v_max3_f32 v174, v140, v141, v142
    v_permlane32_swap_b32 v172, v173
    v_max_f32 v174, v174, v143
    v_max_f32 v172, v172, v173
    v_mov_b32 v175, v174
    s_nop 1
    v_permlane32_swap_b32 v174, v175
    v_max_f32 v174, v174, v175
    s_nop 1
    v_permlane16_swap_b32 v172, v174
    v_max_f32 v172, v172, v174
    v_mov_b32 v174, v172
    s_nop 1
    v_permlane16_swap_b32 v172, v174
    v_mov_b32 v173, v172
    v_mul_f32 v174, v178, v174
    s_nop 0
    v_permlane32_swap_b32 v172, v173
    v_fma_f32 v140, v140, v178, -v174
    v_fma_f32 v141, v141, v178, -v174
    v_fma_f32 v142, v142, v178, -v174
    v_fma_f32 v143, v143, v178, -v174
    v_mul_f32 v172, v176, v172
    v_mul_f32_e64 v173, v177, v173
    v_fma_f32 v132, v132, v176, -v172
    v_fma_f32 v133, v133, v176, -v172
    v_fma_f32 v134, v134, v176, -v172
    v_fma_f32 v135, v135, v176, -v172
    v_fma_f32 v136, v136, v177, -v173
    v_fma_f32 v137, v137, v177, -v173
    v_fma_f32 v138, v138, v177, -v173
    v_fma_f32 v139, v139, v177, -v173
    v_exp_f32 v132, v132
    v_exp_f32 v133, v133
    v_exp_f32 v134, v134
    v_exp_f32 v135, v135
    v_exp_f32 v136, v136
    v_exp_f32 v137, v137
    v_exp_f32 v138, v138
    v_exp_f32 v139, v139
L_pad3:
    s_cbranch_execz L_pad4
    v_exp_f32 v140, v140
    v_exp_f32 v141, v141
    v_exp_f32 v142, v142
    v_exp_f32 v143, v143
    s_mov_b64 exec, s[52:53]
    v_cvt_pk_bf16_f32 v192, v132, v133
    v_cvt_pk_bf16_f32 v193, v134, v135
    v_cvt_pk_bf16_f32 v196, v136, v137
    v_cvt_pk_bf16_f32 v197, v138, v139
    v_cvt_pk_bf16_f32 v200, v140, v141
    v_cvt_pk_bf16_f32 v201, v142, v143
    s_mov_b64 exec, s[50:51]
    s_nop 0
    v_cvt_pk_bf16_f32 v194, v132, v133
    v_cvt_pk_bf16_f32 v195, v134, v135
    v_cvt_pk_bf16_f32 v198, v136, v137
    v_cvt_pk_bf16_f32 v199, v138, v139
    v_cvt_pk_bf16_f32 v202, v140, v141
    v_cvt_pk_bf16_f32 v203, v142, v143
    s_mov_b64 exec, -1
    s_waitcnt lgkmcnt(0)
    v_mfma_f32_16x16x32_bf16 v[160:163], v[236:239], v[192:195], 0
    v_mfma_f32_16x16x32_bf16 v[164:167], v[236:239], v[196:199], 0
    v_mfma_f32_16x16x32_bf16 v[168:171], v[236:239], v[200:203], 0
    v_mfma_f32_16x16x32_bf16 v[144:147], v[112:115], v[192:195], 0
    v_mfma_f32_16x16x32_bf16 v[148:151], v[114:117], v[196:199], 0
    v_mfma_f32_16x16x32_bf16 v[152:155], v[116:119], v[200:203], 0
    v_cmp_eq_u32 s[50:51], 1, v3
    v_cmp_lt_u32 s[52:53], 1, v3
    v_mfma_f32_16x16x32_bf16 v[156:159], v[120:123], v[192:195], 0
    v_rcp_f32_e64 v160, v160
    v_mfma_f32_16x16x32_bf16 v[156:159], v[124:127], v[196:199], v[156:159]
    v_rcp_f32_e64 v164, v164
    v_mfma_f32_16x16x32_bf16 v[156:159], v[128:131], v[200:203], v[156:159]
    v_rcp_f32 v168, v168
    v_mul_f32 v144, v144, v160
    v_mul_f32 v145, v145, v160
    v_mul_f32 v146, v146, v160
    v_mul_f32_e64 v147, v147, v160
    v_cvt_pk_bf16_f32 v180, v144, v145
    v_cvt_pk_bf16_f32 v181, v146, v147
    v_mul_f32 v148, v148, v164
    v_mul_f32 v149, v149, v164
    v_mul_f32 v150, v150, v164
    v_mul_f32 v151, v151, v164
    v_cndmask_b32 v161, v160, v164, s[50:51]
    v_cvt_pk_bf16_f32 v182, v148, v149
    v_cvt_pk_bf16_f32 v183, v150, v151
    v_mul_f32 v152, v152, v168
    v_mul_f32 v153, v153, v168
    v_mul_f32 v154, v154, v168
    v_mul_f32 v155, v155, v168
    v_cndmask_b32 v161, v161, v168, s[52:53]
    v_cvt_pk_bf16_f32 v184, v152, v153
    v_cvt_pk_bf16_f32 v185, v154, v155
    v_permlane16_swap_b32 v180, v182
    v_permlane16_swap_b32 v181, v183
    v_mov_b32 v186, v184
    v_mov_b32 v187, v185
    buffer_store_dwordx4 v[180:183], v246, s[32:35], 0 offen sc1
    v_mul_f32 v156, v156, v161
    v_permlane16_swap_b32 v184, v186
    v_permlane16_swap_b32 v185, v187
    buffer_store_dwordx4 v[184:187], v247, s[32:35], 0 offen offset:512 sc1
    v_mul_f32 v157, v157, v161
    v_mul_f32 v158, v158, v161
    v_mul_f32 v159, v159, v161
    v_cvt_pk_bf16_f32 v156, v156, v157
    v_cvt_pk_bf16_f32 v157, v158, v159
    buffer_store_dwordx2 v[156:157], v248, s[32:35], 0 offen sc1
L_asig_17:
    s_cmp_eq_u32 s3, 0
    s_cbranch_scc1 L_csig_18
    v_mov_b32 v60, 1
    s_add_u32 s48, s55, s40
    s_cmp_eq_u32 s47, 0
    s_mov_b64 exec, 1
    s_waitcnt vmcnt(0)
    s_cbranch_scc1 L_sigf_20
    buffer_wbl2 sc1
    s_waitcnt vmcnt(0)
    buffer_store_byte v60, off, s[32:35], s48 offset:256 sc1
    s_branch L_sigd_21
L_sigf_20:
    buffer_store_byte v60, off, s[32:35], s48 offset:256
L_sigd_21:
    s_mov_b64 exec, -1
    s_branch L_ld_p2
L_csig_18:
    v_mov_b32 v60, 1
    s_add_u32 s48, s55, s40
    s_cmp_eq_u32 s47, 0
    s_mov_b64 exec, 1
    s_waitcnt vmcnt(0)
    s_cbranch_scc1 L_sigf_22
    buffer_wbl2 sc1
    s_waitcnt vmcnt(0)
    buffer_store_byte v60, off, s[32:35], s48 offset:256 sc1
    s_branch L_sigd_23
L_sigf_22:
    buffer_store_byte v60, off, s[32:35], s48 offset:256
L_sigd_23:
    s_mov_b64 exec, -1
    s_and_b32 s64, s40, 1
    s_lshr_b32 s65, s40, 1
    s_and_b32 s72, s40, 1
    s_lshl_b32 s48, s72, 1
    v_lshrrev_b32 v57, 3, v1
    v_and_b32 v57, 3, v57
    v_xor_b32 v57, s48, v57
    v_lshlrev_b32 v57, 5, v57
    v_and_b32 v58, 3, v1
    v_lshl_add_u32 v57, v58, 3, v57
    v_lshrrev_b32_e64 v58, 2, v2
    v_lshl_add_u32 v58, v3, 3, v58
    v_lshl_add_u32 v57, v58, 7, v57
    v_mov_b32 v40, v57
    v_xor_b32 v41, 32, v57
    v_add_u32 v42, 98304, v40
    v_add_u32 v43, 98304, v41
    s_mul_i32 s66, s65, 48
    v_add_u32 v45, s66, v2
    s_movk_i32 s48, 176
    v_mad_u32_u24 v57, v3, s48, v45
    v_lshlrev_b32 v57, 4, v57
    v_add_u32 v44, 32768, v57
    s_lshl_b32 s48, s44, 1
    s_add_u32 s48, s48, s64
    s_mul_i32 s50, s43, 88
    s_lshl_b32 s49, s48, 14
    s_lshl_b32 s51, s50, 4
    s_add_u32 s49, s49, s51
    s_add_u32 s49, s49, 786432
    v_lshlrev_b32 v57, 4, v45
    v_lshl_add_u32 v57, v3, 12, v57
    v_add_u32 v48, s49, v57
    s_lshl_b32 s67, s54, 1
    s_sub_u32 s51, s67, 32
    v_cmp_gt_u32 vcc, s51, v45
    v_mov_b32 v58, 0x80000000
    s_nop 0
    v_cndmask_b32 v49, v58, v48, vcc
    s_mul_i32 s49, s40, 384
    s_add_u32 s49, s49, 158720
    v_lshl_add_u32 v50, v2, 3, s49
    v_lshl_add_u32 v51, v1, 3, s49
    s_lshl_b32 s49, s44, 8
    s_add_u32 s49, s49, s50
    s_add_u32 s49, s49, s66
    s_lshl_b32 s49, s49, 3
    s_add_u32 s49, s49, 1114112
    v_lshl_add_u32 v57, v1, 3, s49
    s_sub_u32 s49, s67, s66
    s_min_u32 s49, s49, 48
    v_cmp_gt_u32 vcc, s49, v1
    s_nop 1
    v_cndmask_b32_e64 v55, v58, v57, vcc
    s_mov_b32 s52, 0x00f0000f
    s_mov_b32 s53, 0xf0000f00
    s_movk_i32 s48, 384
    v_mul_u32_u24 v56, s48, v3
    v_add_u32 v56, 32768, v56
    s_sub_u32 s48, 768, s54
    v_add_u32 v57, 0, v45
    v_add_u32 v59, s48, v57
    v_cmp_gt_u32 vcc, s54, v57
    s_nop 1
    v_cndmask_b32_e64 v57, v59, v57, vcc
    v_lshl_add_u32 v52, v57, 3, v56
    v_add_u32 v57, 16, v45
    v_add_u32 v59, s48, v57
    v_cmp_gt_u32 vcc, s54, v57
    s_nop 1
    v_cndmask_b32_e64 v57, v59, v57, vcc
    v_lshl_add_u32 v53, v57, 3, v56
    v_add_u32 v57, 32, v45
    v_add_u32 v59, s48, v57
    v_cmp_gt_u32 vcc, s54, v57
    s_nop 1
    v_cndmask_b32_e64 v57, v59, v57, vcc
    v_lshl_add_u32 v54, v57, 3, v56
    s_mov_b32 s56, 0x22222222
    s_mov_b32 s57, 0x22222222
    s_mov_b32 s58, 0x44444444
    s_mov_b32 s59, 0x44444444
    s_mov_b32 s60, 0x88888888
    s_mov_b32 s61, 0x88888888
    v_lshlrev_b32_e64 v64, 16, v26
    v_and_b32 v65, 0xffff0000, v26
    v_lshlrev_b32_e64 v66, 16, v27
    v_and_b32 v67, 0xffff0000, v27
    v_lshlrev_b32_e64 v68, 16, v28
    v_and_b32 v69, 0xffff0000, v28
    v_lshlrev_b32_e64 v70, 16, v29
    v_and_b32 v71, 0xffff0000, v29
    v_lshlrev_b32_e64 v72, 16, v30
    v_and_b32 v73, 0xffff0000, v30
    v_lshlrev_b32_e64 v74, 16, v31
    v_and_b32 v75, 0xffff0000, v31
    v_lshlrev_b32_e64 v76, 16, v32
    v_and_b32 v77, 0xffff0000, v32
    v_lshlrev_b32_e64 v78, 16, v33
    v_and_b32 v79, 0xffff0000, v33
    v_lshlrev_b32_e64 v80, 16, v34
    v_and_b32 v81, 0xffff0000, v34
    v_lshlrev_b32_e64 v82, 16, v35
    v_and_b32 v83, 0xffff0000, v35
    v_lshlrev_b32_e64 v84, 16, v36
    v_and_b32 v85, 0xffff0000, v36
    v_lshlrev_b32_e64 v86, 16, v37
    v_and_b32 v87, 0xffff0000, v37
    s_barrier
    s_barrier
    ds_read_b64_tr_b16 v[100:101], v42 offset:8192
    ds_read_b64_tr_b16 v[102:103], v42 offset:8704
    ds_read_b64_tr_b16 v[104:105], v43 offset:8192
    ds_read_b64_tr_b16 v[106:107], v43 offset:8704
    ds_read_b128 v[88:91], v44 offset:0
    ds_read_b128 v[92:95], v44 offset:256
    ds_read_b128 v[96:99], v44 offset:512
    ds_read_b64_tr_b16 v[120:121], v42 offset:12288
    ds_read_b64_tr_b16 v[122:123], v42 offset:12800
    ds_read_b64_tr_b16 v[124:125], v43 offset:12288
    ds_read_b64_tr_b16 v[126:127], v43 offset:12800
    ds_read_b128 v[108:111], v44 offset:1408
    ds_read_b128 v[112:115], v44 offset:1664
    ds_read_b128 v[116:119], v44 offset:1920
    s_barrier
    s_waitcnt lgkmcnt(7)
    v_mfma_f32_16x16x32_bf16 v[64:67], v[100:103], v[88:91], v[64:67]
    ds_read_b64_tr_b16 v[140:141], v42 offset:16384
    ds_read_b64_tr_b16 v[142:143], v42 offset:16896
    v_mfma_f32_16x16x32_bf16 v[68:71], v[104:107], v[88:91], v[68:71]
    ds_read_b64_tr_b16 v[144:145], v43 offset:16384
    v_mfma_f32_16x16x32_bf16 v[72:75], v[100:103], v[92:95], v[72:75]
    ds_read_b64_tr_b16 v[146:147], v43 offset:16896
    v_mfma_f32_16x16x32_bf16 v[76:79], v[104:107], v[92:95], v[76:79]
    ds_read_b128 v[128:131], v44 offset:12288
    v_mfma_f32_16x16x32_bf16 v[80:83], v[100:103], v[96:99], v[80:83]
    ds_read_b128 v[132:135], v44 offset:12544
    v_mfma_f32_16x16x32_bf16 v[84:87], v[104:107], v[96:99], v[84:87]
    ds_read_b128 v[136:139], v44 offset:12800
    s_waitcnt lgkmcnt(7)
    s_nop 0
    v_mfma_f32_16x16x32_bf16 v[64:67], v[120:123], v[108:111], v[64:67]
    ds_read_b64_tr_b16 v[160:161], v42 offset:20480
    ds_read_b64_tr_b16 v[162:163], v42 offset:20992
    v_mfma_f32_16x16x32_bf16 v[68:71], v[124:127], v[108:111], v[68:71]
    ds_read_b64_tr_b16 v[164:165], v43 offset:20480
    v_mfma_f32_16x16x32_bf16 v[72:75], v[120:123], v[112:115], v[72:75]
    ds_read_b64_tr_b16 v[166:167], v43 offset:20992
    v_mfma_f32_16x16x32_bf16 v[76:79], v[124:127], v[112:115], v[76:79]
    ds_read_b128 v[148:151], v44 offset:13696
    v_mfma_f32_16x16x32_bf16 v[80:83], v[120:123], v[116:119], v[80:83]
    ds_read_b128 v[152:155], v44 offset:13952
    v_mfma_f32_16x16x32_bf16 v[84:87], v[124:127], v[116:119], v[84:87]
    ds_read_b128 v[156:159], v44 offset:14208
    s_barrier
    s_waitcnt lgkmcnt(7)
    v_mfma_f32_16x16x32_bf16 v[64:67], v[140:143], v[128:131], v[64:67]
    ds_read_b64_tr_b16 v[100:101], v42 offset:24576
    ds_read_b64_tr_b16 v[102:103], v42 offset:25088
    v_mfma_f32_16x16x32_bf16 v[68:71], v[144:147], v[128:131], v[68:71]
    ds_read_b64_tr_b16 v[104:105], v43 offset:24576
    v_mfma_f32_16x16x32_bf16 v[72:75], v[140:143], v[132:135], v[72:75]
    ds_read_b64_tr_b16 v[106:107], v43 offset:25088
    v_mfma_f32_16x16x32_bf16 v[76:79], v[144:147], v[132:135], v[76:79]
    ds_read_b128 v[88:91], v44 offset:24576
    v_mfma_f32_16x16x32_bf16 v[80:83], v[140:143], v[136:139], v[80:83]
    ds_read_b128 v[92:95], v44 offset:24832
    v_mfma_f32_16x16x32_bf16 v[84:87], v[144:147], v[136:139], v[84:87]
    ds_read_b128 v[96:99], v44 offset:25088
    s_waitcnt lgkmcnt(7)
    s_nop 0
    v_mfma_f32_16x16x32_bf16 v[64:67], v[160:163], v[148:151], v[64:67]
    ds_read_b64_tr_b16 v[120:121], v42 offset:28672
    ds_read_b64_tr_b16 v[122:123], v42 offset:29184
    v_mfma_f32_16x16x32_bf16 v[68:71], v[164:167], v[148:151], v[68:71]
    ds_read_b64_tr_b16 v[124:125], v43 offset:28672
    v_mfma_f32_16x16x32_bf16 v[72:75], v[160:163], v[152:155], v[72:75]
    ds_read_b64_tr_b16 v[126:127], v43 offset:29184
    v_mfma_f32_16x16x32_bf16 v[76:79], v[164:167], v[152:155], v[76:79]
    ds_read_b128 v[108:111], v44 offset:25984
    v_mfma_f32_16x16x32_bf16 v[80:83], v[160:163], v[156:159], v[80:83]
    ds_read_b128 v[112:115], v44 offset:26240
    v_mfma_f32_16x16x32_bf16 v[84:87], v[164:167], v[156:159], v[84:87]
    ds_read_b128 v[116:119], v44 offset:26496
    s_barrier
    s_waitcnt lgkmcnt(7)
    v_mfma_f32_16x16x32_bf16 v[64:67], v[100:103], v[88:91], v[64:67]
    ds_read_b64_tr_b16 v[140:141], v42 offset:32768
    ds_read_b64_tr_b16 v[142:143], v42 offset:33280
    v_mfma_f32_16x16x32_bf16 v[68:71], v[104:107], v[88:91], v[68:71]
    ds_read_b64_tr_b16 v[144:145], v43 offset:32768
    v_mfma_f32_16x16x32_bf16 v[72:75], v[100:103], v[92:95], v[72:75]
    ds_read_b64_tr_b16 v[146:147], v43 offset:33280
    v_mfma_f32_16x16x32_bf16 v[76:79], v[104:107], v[92:95], v[76:79]
    ds_read_b128 v[128:131], v44 offset:36864
    v_mfma_f32_16x16x32_bf16 v[80:83], v[100:103], v[96:99], v[80:83]
    ds_read_b128 v[132:135], v44 offset:37120
    v_mfma_f32_16x16x32_bf16 v[84:87], v[104:107], v[96:99], v[84:87]
    ds_read_b128 v[136:139], v44 offset:37376
    s_waitcnt lgkmcnt(7)
    s_nop 0
    v_mfma_f32_16x16x32_bf16 v[64:67], v[120:123], v[108:111], v[64:67]
    ds_read_b64_tr_b16 v[160:161], v42 offset:36864
    ds_read_b64_tr_b16 v[162:163], v42 offset:37376
    v_mfma_f32_16x16x32_bf16 v[68:71], v[124:127], v[108:111], v[68:71]
    ds_read_b64_tr_b16 v[164:165], v43 offset:36864
    v_mfma_f32_16x16x32_bf16 v[72:75], v[120:123], v[112:115], v[72:75]
    ds_read_b64_tr_b16 v[166:167], v43 offset:37376
    v_mfma_f32_16x16x32_bf16 v[76:79], v[124:127], v[112:115], v[76:79]
    ds_read_b128 v[148:151], v44 offset:38272
    v_mfma_f32_16x16x32_bf16 v[80:83], v[120:123], v[116:119], v[80:83]
    ds_read_b128 v[152:155], v44 offset:38528
    v_mfma_f32_16x16x32_bf16 v[84:87], v[124:127], v[116:119], v[84:87]
    ds_read_b128 v[156:159], v44 offset:38784
    s_barrier
    s_waitcnt lgkmcnt(7)
    v_mfma_f32_16x16x32_bf16 v[64:67], v[140:143], v[128:131], v[64:67]
    ds_read_b64_tr_b16 v[100:101], v42 offset:40960
    ds_read_b64_tr_b16 v[102:103], v42 offset:41472
    v_mfma_f32_16x16x32_bf16 v[68:71], v[144:147], v[128:131], v[68:71]
    ds_read_b64_tr_b16 v[104:105], v43 offset:40960
    v_mfma_f32_16x16x32_bf16 v[72:75], v[140:143], v[132:135], v[72:75]
    ds_read_b64_tr_b16 v[106:107], v43 offset:41472
    v_mfma_f32_16x16x32_bf16 v[76:79], v[144:147], v[132:135], v[76:79]
    ds_read_b128 v[88:91], v44 offset:49152
    v_mfma_f32_16x16x32_bf16 v[80:83], v[140:143], v[136:139], v[80:83]
    ds_read_b128 v[92:95], v44 offset:49408
    v_mfma_f32_16x16x32_bf16 v[84:87], v[144:147], v[136:139], v[84:87]
    ds_read_b128 v[96:99], v44 offset:49664
    s_waitcnt lgkmcnt(7)
    s_nop 0
    v_mfma_f32_16x16x32_bf16 v[64:67], v[160:163], v[148:151], v[64:67]
    ds_read_b64_tr_b16 v[120:121], v42 offset:45056
    ds_read_b64_tr_b16 v[122:123], v42 offset:45568
    v_mfma_f32_16x16x32_bf16 v[68:71], v[164:167], v[148:151], v[68:71]
    ds_read_b64_tr_b16 v[124:125], v43 offset:45056
    v_mfma_f32_16x16x32_bf16 v[72:75], v[160:163], v[152:155], v[72:75]
    ds_read_b64_tr_b16 v[126:127], v43 offset:45568
    v_mfma_f32_16x16x32_bf16 v[76:79], v[164:167], v[152:155], v[76:79]
    ds_read_b128 v[108:111], v44 offset:50560
    v_mfma_f32_16x16x32_bf16 v[80:83], v[160:163], v[156:159], v[80:83]
    ds_read_b128 v[112:115], v44 offset:50816
    v_mfma_f32_16x16x32_bf16 v[84:87], v[164:167], v[156:159], v[84:87]
    ds_read_b128 v[116:119], v44 offset:51072
    s_barrier
    s_waitcnt lgkmcnt(7)
    v_mfma_f32_16x16x32_bf16 v[64:67], v[100:103], v[88:91], v[64:67]
    ds_read_b64_tr_b16 v[140:141], v42 offset:49152
    ds_read_b64_tr_b16 v[142:143], v42 offset:49664
    v_mfma_f32_16x16x32_bf16 v[68:71], v[104:107], v[88:91], v[68:71]
    ds_read_b64_tr_b16 v[144:145], v43 offset:49152
    v_mfma_f32_16x16x32_bf16 v[72:75], v[100:103], v[92:95], v[72:75]
    ds_read_b64_tr_b16 v[146:147], v43 offset:49664
    v_mfma_f32_16x16x32_bf16 v[76:79], v[104:107], v[92:95], v[76:79]
    ds_read_b128 v[128:131], v44 offset:61440
    v_mfma_f32_16x16x32_bf16 v[80:83], v[100:103], v[96:99], v[80:83]
    ds_read_b128 v[132:135], v44 offset:61696
    v_mfma_f32_16x16x32_bf16 v[84:87], v[104:107], v[96:99], v[84:87]
    ds_read_b128 v[136:139], v44 offset:61952
    s_waitcnt lgkmcnt(7)
    s_nop 0
    v_mfma_f32_16x16x32_bf16 v[64:67], v[120:123], v[108:111], v[64:67]
    ds_read_b64_tr_b16 v[160:161], v42 offset:53248
    ds_read_b64_tr_b16 v[162:163], v42 offset:53760
    v_mfma_f32_16x16x32_bf16 v[68:71], v[124:127], v[108:111], v[68:71]
    ds_read_b64_tr_b16 v[164:165], v43 offset:53248
    v_mfma_f32_16x16x32_bf16 v[72:75], v[120:123], v[112:115], v[72:75]
    ds_read_b64_tr_b16 v[166:167], v43 offset:53760
    v_mfma_f32_16x16x32_bf16 v[76:79], v[124:127], v[112:115], v[76:79]
    ds_read_b128 v[148:151], v44 offset:62848
    v_mfma_f32_16x16x32_bf16 v[80:83], v[120:123], v[116:119], v[80:83]
    ds_read_b128 v[152:155], v44 offset:63104
    v_mfma_f32_16x16x32_bf16 v[84:87], v[124:127], v[116:119], v[84:87]
    ds_read_b128 v[156:159], v44 offset:63360
    s_barrier
    s_waitcnt lgkmcnt(7)
    v_mfma_f32_16x16x32_bf16 v[64:67], v[140:143], v[128:131], v[64:67]
    ds_read_b64_tr_b16 v[100:101], v40 offset:0
    ds_read_b64_tr_b16 v[102:103], v40 offset:512
    v_mfma_f32_16x16x32_bf16 v[68:71], v[144:147], v[128:131], v[68:71]
    ds_read_b64_tr_b16 v[104:105], v41 offset:0
    v_mfma_f32_16x16x32_bf16 v[72:75], v[140:143], v[132:135], v[72:75]
    ds_read_b64_tr_b16 v[106:107], v41 offset:512
    v_mfma_f32_16x16x32_bf16 v[76:79], v[144:147], v[132:135], v[76:79]
    ds_read_b128 v[88:91], v44 offset:0
    v_mfma_f32_16x16x32_bf16 v[80:83], v[140:143], v[136:139], v[80:83]
    ds_read_b128 v[92:95], v44 offset:256
    v_mfma_f32_16x16x32_bf16 v[84:87], v[144:147], v[136:139], v[84:87]
    ds_read_b128 v[96:99], v44 offset:512
    s_waitcnt lgkmcnt(7)
    s_nop 0
    v_mfma_f32_16x16x32_bf16 v[64:67], v[160:163], v[148:151], v[64:67]
    ds_read_b64_tr_b16 v[120:121], v40 offset:4096
    ds_read_b64_tr_b16 v[122:123], v40 offset:4608
    v_mfma_f32_16x16x32_bf16 v[68:71], v[164:167], v[148:151], v[68:71]
    ds_read_b64_tr_b16 v[124:125], v41 offset:4096
    v_mfma_f32_16x16x32_bf16 v[72:75], v[160:163], v[152:155], v[72:75]
    ds_read_b64_tr_b16 v[126:127], v41 offset:4608
    v_mfma_f32_16x16x32_bf16 v[76:79], v[164:167], v[152:155], v[76:79]
    ds_read_b128 v[108:111], v44 offset:1408
    v_mfma_f32_16x16x32_bf16 v[80:83], v[160:163], v[156:159], v[80:83]
    ds_read_b128 v[112:115], v44 offset:1664
    v_mfma_f32_16x16x32_bf16 v[84:87], v[164:167], v[156:159], v[84:87]
    ds_read_b128 v[116:119], v44 offset:1920
    s_barrier
    s_waitcnt lgkmcnt(7)
    v_mfma_f32_16x16x32_bf16 v[64:67], v[100:103], v[88:91], v[64:67]
    ds_read_b64_tr_b16 v[140:141], v40 offset:8192
    ds_read_b64_tr_b16 v[142:143], v40 offset:8704
    v_mfma_f32_16x16x32_bf16 v[68:71], v[104:107], v[88:91], v[68:71]
    ds_read_b64_tr_b16 v[144:145], v41 offset:8192
    v_mfma_f32_16x16x32_bf16 v[72:75], v[100:103], v[92:95], v[72:75]
    ds_read_b64_tr_b16 v[146:147], v41 offset:8704
    v_mfma_f32_16x16x32_bf16 v[76:79], v[104:107], v[92:95], v[76:79]
    ds_read_b128 v[128:131], v44 offset:12288
    v_mfma_f32_16x16x32_bf16 v[80:83], v[100:103], v[96:99], v[80:83]
    ds_read_b128 v[132:135], v44 offset:12544
    v_mfma_f32_16x16x32_bf16 v[84:87], v[104:107], v[96:99], v[84:87]
    ds_read_b128 v[136:139], v44 offset:12800
    s_waitcnt lgkmcnt(7)
    s_nop 0
    v_mfma_f32_16x16x32_bf16 v[64:67], v[120:123], v[108:111], v[64:67]
    ds_read_b64_tr_b16 v[160:161], v40 offset:12288
    ds_read_b64_tr_b16 v[162:163], v40 offset:12800
    v_mfma_f32_16x16x32_bf16 v[68:71], v[124:127], v[108:111], v[68:71]
    ds_read_b64_tr_b16 v[164:165], v41 offset:12288
    v_mfma_f32_16x16x32_bf16 v[72:75], v[120:123], v[112:115], v[72:75]
    ds_read_b64_tr_b16 v[166:167], v41 offset:12800
    v_mfma_f32_16x16x32_bf16 v[76:79], v[124:127], v[112:115], v[76:79]
    ds_read_b128 v[148:151], v44 offset:13696
    v_mfma_f32_16x16x32_bf16 v[80:83], v[120:123], v[116:119], v[80:83]
    ds_read_b128 v[152:155], v44 offset:13952
    v_mfma_f32_16x16x32_bf16 v[84:87], v[124:127], v[116:119], v[84:87]
    ds_read_b128 v[156:159], v44 offset:14208
    s_barrier
    s_waitcnt lgkmcnt(7)
    v_mfma_f32_16x16x32_bf16 v[64:67], v[140:143], v[128:131], v[64:67]
    ds_read_b64_tr_b16 v[100:101], v40 offset:16384
    ds_read_b64_tr_b16 v[102:103], v40 offset:16896
    v_mfma_f32_16x16x32_bf16 v[68:71], v[144:147], v[128:131], v[68:71]
    ds_read_b64_tr_b16 v[104:105], v41 offset:16384
    ds_read_b64_tr_b16 v[106:107], v41 offset:16896
    v_mfma_f32_16x16x32_bf16 v[72:75], v[140:143], v[132:135], v[72:75]
    ds_read_b64 v[88:89], v52 offset:24576
    ds_read_b64 v[90:91], v52 offset:26112
    v_mfma_f32_16x16x32_bf16 v[76:79], v[144:147], v[132:135], v[76:79]
    ds_read_b64 v[92:93], v53 offset:24576
    ds_read_b64 v[94:95], v53 offset:26112
    v_mfma_f32_16x16x32_bf16 v[80:83], v[140:143], v[136:139], v[80:83]
    ds_read_b64 v[96:97], v54 offset:24576
    v_mfma_f32_16x16x32_bf16 v[84:87], v[144:147], v[136:139], v[84:87]
    ds_read_b64 v[98:99], v54 offset:26112
    s_waitcnt lgkmcnt(10)
    s_nop 0
    v_mfma_f32_16x16x32_bf16 v[64:67], v[160:163], v[148:151], v[64:67]
    ds_read_b64_tr_b16 v[120:121], v40 offset:20480
    ds_read_b64_tr_b16 v[122:123], v40 offset:20992
    v_mfma_f32_16x16x32_bf16 v[68:71], v[164:167], v[148:151], v[68:71]
    ds_read_b64_tr_b16 v[124:125], v41 offset:20480
    ds_read_b64_tr_b16 v[126:127], v41 offset:20992
    v_mfma_f32_16x16x32_bf16 v[72:75], v[160:163], v[152:155], v[72:75]
    ds_read_b64 v[108:109], v52 offset:27648
    ds_read_b64 v[110:111], v52 offset:29184
    v_mfma_f32_16x16x32_bf16 v[76:79], v[164:167], v[152:155], v[76:79]
    ds_read_b64 v[112:113], v53 offset:27648
    ds_read_b64 v[114:115], v53 offset:29184
    v_mfma_f32_16x16x32_bf16 v[80:83], v[160:163], v[156:159], v[80:83]
    ds_read_b64 v[116:117], v54 offset:27648
    v_mfma_f32_16x16x32_bf16 v[84:87], v[164:167], v[156:159], v[84:87]
    ds_read_b64 v[118:119], v54 offset:29184
    s_waitcnt lgkmcnt(10)
    v_mfma_f32_16x16x32_bf16 v[64:67], v[100:103], v[88:91], v[64:67]
    v_mfma_f32_16x16x32_bf16 v[68:71], v[104:107], v[88:91], v[68:71]
    v_mfma_f32_16x16x32_bf16 v[72:75], v[100:103], v[92:95], v[72:75]
    v_mfma_f32_16x16x32_bf16 v[76:79], v[104:107], v[92:95], v[76:79]
    v_mfma_f32_16x16x32_bf16 v[80:83], v[100:103], v[96:99], v[80:83]
    v_mfma_f32_16x16x32_bf16 v[84:87], v[104:107], v[96:99], v[84:87]
    s_waitcnt lgkmcnt(0)
    v_mfma_f32_16x16x32_bf16 v[64:67], v[120:123], v[108:111], v[64:67]
    v_mfma_f32_16x16x32_bf16 v[68:71], v[124:127], v[108:111], v[68:71]
    v_mfma_f32_16x16x32_bf16 v[72:75], v[120:123], v[112:115], v[72:75]
    v_mfma_f32_16x16x32_bf16 v[76:79], v[124:127], v[112:115], v[76:79]
    v_mfma_f32_16x16x32_bf16 v[80:83], v[120:123], v[116:119], v[80:83]
    v_mfma_f32_16x16x32_bf16 v[84:87], v[124:127], v[116:119], v[84:87]
    s_barrier
    s_nop 0
    ds_read_b64_tr_b16 v[140:141], v40 offset:24576
    ds_read_b64_tr_b16 v[142:143], v40 offset:25088
    ds_read_b64_tr_b16 v[144:145], v41 offset:24576
    ds_read_b64_tr_b16 v[146:147], v41 offset:25088
    ds_read_b64 v[128:129], v52 offset:36864
    ds_read_b64 v[130:131], v52 offset:38400
    ds_read_b64 v[132:133], v53 offset:36864
    ds_read_b64 v[134:135], v53 offset:38400
    ds_read_b64 v[136:137], v54 offset:36864
    ds_read_b64 v[138:139], v54 offset:38400
    ds_read_b64_tr_b16 v[160:161], v40 offset:28672
    ds_read_b64_tr_b16 v[162:163], v40 offset:29184
    ds_read_b64_tr_b16 v[164:165], v41 offset:28672
    ds_read_b64_tr_b16 v[166:167], v41 offset:29184
    ds_read_b64 v[148:149], v52 offset:39936
    ds_read_b64 v[150:151], v52 offset:41472
    ds_read_b64 v[152:153], v53 offset:39936
    ds_read_b64 v[154:155], v53 offset:41472
    ds_read_b64 v[156:157], v54 offset:39936
    ds_read_b64 v[158:159], v54 offset:41472
    s_waitcnt lgkmcnt(10)
    v_mfma_f32_16x16x32_bf16 v[64:67], v[140:143], v[128:131], v[64:67]
    v_mfma_f32_16x16x32_bf16 v[68:71], v[144:147], v[128:131], v[68:71]
    v_mfma_f32_16x16x32_bf16 v[72:75], v[140:143], v[132:135], v[72:75]
    v_mfma_f32_16x16x32_bf16 v[76:79], v[144:147], v[132:135], v[76:79]
    v_mfma_f32_16x16x32_bf16 v[80:83], v[140:143], v[136:139], v[80:83]
    v_mfma_f32_16x16x32_bf16 v[84:87], v[144:147], v[136:139], v[84:87]
    s_waitcnt lgkmcnt(0)
    v_mfma_f32_16x16x32_bf16 v[64:67], v[160:163], v[148:151], v[64:67]
    v_mfma_f32_16x16x32_bf16 v[68:71], v[164:167], v[148:151], v[68:71]
    v_mfma_f32_16x16x32_bf16 v[72:75], v[160:163], v[152:155], v[72:75]
    v_mfma_f32_16x16x32_bf16 v[76:79], v[164:167], v[152:155], v[76:79]
    v_mfma_f32_16x16x32_bf16 v[80:83], v[160:163], v[156:159], v[80:83]
    v_mfma_f32_16x16x32_bf16 v[84:87], v[164:167], v[156:159], v[84:87]
    s_nop 2
    v_cvt_pk_bf16_f32 v240, v64, v65
    v_cvt_pk_bf16_f32 v241, v66, v67
    v_cvt_pk_bf16_f32 v242, v68, v69
    v_cvt_pk_bf16_f32 v243, v70, v71
    s_barrier
    buffer_store_dwordx4 v[240:243], v48, s[32:35], 0 offen offset:0
    v_cvt_pk_bf16_f32 v244, v72, v73
    v_cvt_pk_bf16_f32 v245, v74, v75
    v_cvt_pk_bf16_f32 v246, v76, v77
    v_cvt_pk_bf16_f32 v247, v78, v79
    buffer_store_dwordx4 v[244:247], v48, s[32:35], 0 offen offset:256
    v_cvt_pk_bf16_f32 v248, v80, v81
    v_cvt_pk_bf16_f32 v249, v82, v83
    v_cvt_pk_bf16_f32 v250, v84, v85
    v_cvt_pk_bf16_f32 v251, v86, v87
    buffer_store_dwordx4 v[248:251], v49, s[32:35], 0 offen offset:512
    v_mfma_f32_16x16x32_bf16 v[88:91], v[236:239], v[240:243], 0
    v_mfma_f32_16x16x32_bf16 v[92:95], v[240:243], v[240:243], 0
    v_mfma_f32_16x16x32_bf16 v[96:99], v[236:239], v[244:247], 0
    v_mfma_f32_16x16x32_bf16 v[100:103], v[244:247], v[244:247], 0
    v_mfma_f32_16x16x32_bf16 v[104:107], v[236:239], v[248:251], 0
    v_mfma_f32_16x16x32_bf16 v[108:111], v[248:251], v[248:251], 0
    s_nop 3
    s_nop 0
    v_cndmask_b32 v92, v92, v93, s[56:57]
    v_cndmask_b32 v92, v92, v94, s[58:59]
    v_cndmask_b32 v89, v92, v95, s[60:61]
    v_cndmask_b32 v100, v100, v101, s[56:57]
    v_cndmask_b32 v100, v100, v102, s[58:59]
    v_cndmask_b32 v97, v100, v103, s[60:61]
    v_cndmask_b32 v108, v108, v109, s[56:57]
    v_cndmask_b32 v108, v108, v110, s[58:59]
    v_cndmask_b32 v105, v108, v111, s[60:61]
    s_mov_b64 exec, s[52:53]
    ds_write2_b64 v50, v[88:89], v[96:97] offset0:0 offset1:16
    ds_write_b64 v50, v[104:105] offset:256
    s_mov_b64 exec, -1
    v_mov_b32 v60, 1
    s_add_u32 s48, s55, s40
    s_cmp_eq_u32 s47, 0
    s_mov_b64 exec, 1
    s_waitcnt vmcnt(0)
    s_cbranch_scc1 L_sigf_24
    buffer_wbl2 sc1
    s_waitcnt vmcnt(0)
    buffer_store_byte v60, off, s[32:35], s48 offset:512 sc1
    s_branch L_sigd_25
L_sigf_24:
    buffer_store_byte v60, off, s[32:35], s48 offset:512
L_sigd_25:
    s_mov_b64 exec, -1
    s_waitcnt lgkmcnt(0)
    s_barrier
    s_cmp_lg_u32 s64, 0
    s_cbranch_scc1 L_nost_26
    ds_read2_b64 v[88:91], v51 offset0:0 offset1:48
    s_waitcnt lgkmcnt(0)
    v_add_f32 v88, v88, v90
    v_add_f32 v89, v89, v91
    buffer_store_dwordx2 v[88:89], v55, s[32:35], 0 offen
L_nost_26:
    s_mov_b32 s82, 1
L_comp_p3:
    s_and_b32 s64, s40, 1
    s_lshr_b32 s65, s40, 1
    s_mul_i32 s48, s64, 96
    v_xor_b32 v4, s48, v40
    v_xor_b32_e64 v5, 64, v4
    v_add_u32 v6, 98304, v4
    v_add_u32 v7, 98304, v5
    s_and_b32 s51, s42, 1
    s_add_u32 s48, s51, s64
    s_lshl_b32 s48, s48, 7
    s_add_u32 s48, s48, 155648
    v_lshl_add_u32 v36, v3, 4, s48
    v_add_u32 v37, 64, v36
    s_xor_b32 s48, s51, 1
    s_lshl_b32 s48, s48, 2
    s_add_u32 s48, s48, s64
    s_lshl_b32 s48, s48, 6
    s_add_u32 s48, s48, 155648
    v_lshl_add_u32 v38, v3, 4, s48
    s_lshl_b32 s48, s65, 6
    v_add_u32 v57, s48, v2
    v_lshl_add_u32 v58, v3, 7, v57
    v_lshlrev_b32_e64 v58, 4, v58
    v_add_u32 v10, 49152, v58
L_pad4:
    s_cbranch_execz L_pad5
    v_lshlrev_b32 v11, 4, v57
    v_add_u32 v11, 156672, v11
    s_and_b32 s48, s42, 15
    s_mul_i32 s48, s48, 3
    s_lshr_b32 s49, s42, 4
    s_lshl_b32 s49, s49, 11
    v_lshlrev_b32_e64 v57, 4, v57
    v_lshl_add_u32 v57, v3, 12, v57
    v_add_u32 v57, s49, v57
    s_add_u32 s49, s64, s51
    s_add_u32 s49, s49, s48
    s_lshl_b32 s49, s49, 14
    v_add_u32 v52, s49, v57
    s_xor_b32 s49, s51, 1
    s_lshl_b32 s49, s49, 1
    s_add_u32 s49, s49, s48
    s_lshl_b32 s49, s49, 14
    s_lshl_b32 s50, s64, 13
    s_add_u32 s49, s49, s50
    v_lshrrev_b32 v58, 1, v3
    v_sub_u32_e64 v58, v58, v3
    v_lshl_add_u32 v58, v58, 12, v57
    v_and_b32_e64 v59, 1, v3
    v_lshl_add_u32 v58, v59, 8, v58
    v_add_u32 v53, s49, v58
    s_barrier
    s_andn2_b32 s48, s82, s64
    s_cbranch_scc0 L_nss_27
    v_mov_b32 v60, 1
    s_add_u32 s48, s55, s40
    s_cmp_eq_u32 s47, 0
    s_mov_b64 exec, 1
    s_waitcnt vmcnt(0)
    s_cbranch_scc1 L_sigf_28
    buffer_wbl2 sc1
    s_waitcnt vmcnt(0)
    buffer_store_byte v60, off, s[32:35], s48 offset:516 sc1
    s_branch L_sigd_29
L_sigf_28:
    buffer_store_byte v60, off, s[32:35], s48 offset:516
L_sigd_29:
    s_mov_b64 exec, -1
L_nss_27:
    s_barrier
    ds_read_b128 v[160:163], v10 offset:0
    ds_read_b64_tr_b16 v[176:177], v42 offset:8192
    ds_read_b64_tr_b16 v[178:179], v42 offset:8704
    ds_read_b64_tr_b16 v[180:181], v43 offset:8192
    ds_read_b64_tr_b16 v[182:183], v43 offset:8704
    ds_read_b64_tr_b16 v[184:185], v6 offset:24576
    ds_read_b64_tr_b16 v[186:187], v6 offset:25088
    ds_read_b128 v[164:167], v10 offset:256
    ds_read_b128 v[168:171], v10 offset:512
    ds_read_b128 v[172:175], v10 offset:768
    ds_read_b64_tr_b16 v[188:189], v42 offset:16384
    ds_read_b64_tr_b16 v[190:191], v42 offset:16896
    ds_read_b64_tr_b16 v[192:193], v43 offset:16384
    ds_read_b64_tr_b16 v[194:195], v43 offset:16896
    ds_read_b64_tr_b16 v[196:197], v7 offset:24576
    ds_read_b64_tr_b16 v[198:199], v7 offset:25088
    s_waitcnt lgkmcnt(0)
    v_mfma_f32_16x16x32_bf16 v[64:67], v[176:179], v[160:163], 0
    ds_read_b128 v[200:203], v10 offset:8192
    v_mfma_f32_16x16x32_bf16 v[68:71], v[180:183], v[160:163], 0
    ds_read_b64_tr_b16 v[216:217], v42 offset:12288
    v_mfma_f32_16x16x32_bf16 v[72:75], v[184:187], v[160:163], 0
    ds_read_b64_tr_b16 v[218:219], v42 offset:12800
    v_mfma_f32_16x16x32_bf16 v[88:91], v[176:179], v[164:167], 0
    ds_read_b64_tr_b16 v[220:221], v43 offset:12288
    v_mfma_f32_16x16x32_bf16 v[92:95], v[180:183], v[164:167], 0
    ds_read_b64_tr_b16 v[222:223], v43 offset:12800
    v_mfma_f32_16x16x32_bf16 v[96:99], v[184:187], v[164:167], 0
    ds_read_b64_tr_b16 v[224:225], v6 offset:28672
    v_mfma_f32_16x16x32_bf16 v[112:115], v[176:179], v[168:171], 0
    ds_read_b64_tr_b16 v[226:227], v6 offset:29184
    v_mfma_f32_16x16x32_bf16 v[116:119], v[180:183], v[168:171], 0
    ds_read_b128 v[204:207], v10 offset:8448
    v_mfma_f32_16x16x32_bf16 v[120:123], v[184:187], v[168:171], 0
    ds_read_b128 v[208:211], v10 offset:8704
    v_mfma_f32_16x16x32_bf16 v[136:139], v[176:179], v[172:175], 0
    ds_read_b128 v[212:215], v10 offset:8960
    v_mfma_f32_16x16x32_bf16 v[140:143], v[180:183], v[172:175], 0
    ds_read_b64_tr_b16 v[228:229], v42 offset:20480
    v_mfma_f32_16x16x32_bf16 v[144:147], v[184:187], v[172:175], 0
    ds_read_b64_tr_b16 v[230:231], v42 offset:20992
    v_mfma_f32_16x16x32_bf16 v[76:79], v[188:191], v[160:163], 0
    ds_read_b64_tr_b16 v[232:233], v43 offset:20480
    v_mfma_f32_16x16x32_bf16 v[80:83], v[192:195], v[160:163], 0
    ds_read_b64_tr_b16 v[234:235], v43 offset:20992
    v_mfma_f32_16x16x32_bf16 v[84:87], v[196:199], v[160:163], 0
    ds_read_b64_tr_b16 v[236:237], v7 offset:28672
    v_mfma_f32_16x16x32_bf16 v[100:103], v[188:191], v[164:167], 0
    ds_read_b64_tr_b16 v[238:239], v7 offset:29184
    v_mfma_f32_16x16x32_bf16 v[104:107], v[192:195], v[164:167], 0
    v_mfma_f32_16x16x32_bf16 v[108:111], v[196:199], v[164:167], 0
    v_mfma_f32_16x16x32_bf16 v[124:127], v[188:191], v[168:171], 0
    v_mfma_f32_16x16x32_bf16 v[128:131], v[192:195], v[168:171], 0
    v_mfma_f32_16x16x32_bf16 v[132:135], v[196:199], v[168:171], 0
    v_mfma_f32_16x16x32_bf16 v[148:151], v[188:191], v[172:175], 0
    v_mfma_f32_16x16x32_bf16 v[152:155], v[192:195], v[172:175], 0
    v_mfma_f32_16x16x32_bf16 v[156:159], v[196:199], v[172:175], 0
    s_waitcnt lgkmcnt(0)
    s_barrier
    v_mfma_f32_16x16x32_bf16 v[64:67], v[216:219], v[200:203], v[64:67]
    ds_read_b128 v[160:163], v10 offset:16384
    v_mfma_f32_16x16x32_bf16 v[68:71], v[220:223], v[200:203], v[68:71]
    ds_read_b64_tr_b16 v[176:177], v42 offset:32768
    v_mfma_f32_16x16x32_bf16 v[72:75], v[224:227], v[200:203], v[72:75]
    ds_read_b64_tr_b16 v[178:179], v42 offset:33280
    v_mfma_f32_16x16x32_bf16 v[88:91], v[216:219], v[204:207], v[88:91]
    ds_read_b64_tr_b16 v[180:181], v43 offset:32768
    v_mfma_f32_16x16x32_bf16 v[92:95], v[220:223], v[204:207], v[92:95]
    ds_read_b64_tr_b16 v[182:183], v43 offset:33280
    v_mfma_f32_16x16x32_bf16 v[96:99], v[224:227], v[204:207], v[96:99]
    ds_read_b64_tr_b16 v[184:185], v6 offset:49152
    v_mfma_f32_16x16x32_bf16 v[112:115], v[216:219], v[208:211], v[112:115]
    ds_read_b64_tr_b16 v[186:187], v6 offset:49664
    v_mfma_f32_16x16x32_bf16 v[116:119], v[220:223], v[208:211], v[116:119]
    ds_read_b128 v[164:167], v10 offset:16640
    v_mfma_f32_16x16x32_bf16 v[120:123], v[224:227], v[208:211], v[120:123]
    ds_read_b128 v[168:171], v10 offset:16896
    v_mfma_f32_16x16x32_bf16 v[136:139], v[216:219], v[212:215], v[136:139]
    ds_read_b128 v[172:175], v10 offset:17152
    v_mfma_f32_16x16x32_bf16 v[140:143], v[220:223], v[212:215], v[140:143]
    ds_read_b64_tr_b16 v[188:189], v42 offset:40960
    v_mfma_f32_16x16x32_bf16 v[144:147], v[224:227], v[212:215], v[144:147]
    ds_read_b64_tr_b16 v[190:191], v42 offset:41472
    v_mfma_f32_16x16x32_bf16 v[76:79], v[228:231], v[200:203], v[76:79]
    ds_read_b64_tr_b16 v[192:193], v43 offset:40960
    v_mfma_f32_16x16x32_bf16 v[80:83], v[232:235], v[200:203], v[80:83]
    ds_read_b64_tr_b16 v[194:195], v43 offset:41472
    v_mfma_f32_16x16x32_bf16 v[84:87], v[236:239], v[200:203], v[84:87]
    ds_read_b64_tr_b16 v[196:197], v7 offset:49152
    v_mfma_f32_16x16x32_bf16 v[100:103], v[228:231], v[204:207], v[100:103]
    ds_read_b64_tr_b16 v[198:199], v7 offset:49664
    v_mfma_f32_16x16x32_bf16 v[104:107], v[232:235], v[204:207], v[104:107]
    v_mfma_f32_16x16x32_bf16 v[108:111], v[236:239], v[204:207], v[108:111]
    v_mfma_f32_16x16x32_bf16 v[124:127], v[228:231], v[208:211], v[124:127]
    v_mfma_f32_16x16x32_bf16 v[128:131], v[232:235], v[208:211], v[128:131]
    v_mfma_f32_16x16x32_bf16 v[132:135], v[236:239], v[208:211], v[132:135]
    v_mfma_f32_16x16x32_bf16 v[148:151], v[228:231], v[212:215], v[148:151]
    v_mfma_f32_16x16x32_bf16 v[152:155], v[232:235], v[212:215], v[152:155]
    v_mfma_f32_16x16x32_bf16 v[156:159], v[236:239], v[212:215], v[156:159]
    s_waitcnt lgkmcnt(0)
    v_mfma_f32_16x16x32_bf16 v[64:67], v[176:179], v[160:163], v[64:67]
    ds_read_b128 v[200:203], v10 offset:24576
    v_mfma_f32_16x16x32_bf16 v[68:71], v[180:183], v[160:163], v[68:71]
    ds_read_b64_tr_b16 v[216:217], v42 offset:36864
    v_mfma_f32_16x16x32_bf16 v[72:75], v[184:187], v[160:163], v[72:75]
    ds_read_b64_tr_b16 v[218:219], v42 offset:37376
    v_mfma_f32_16x16x32_bf16 v[88:91], v[176:179], v[164:167], v[88:91]
    ds_read_b64_tr_b16 v[220:221], v43 offset:36864
    v_mfma_f32_16x16x32_bf16 v[92:95], v[180:183], v[164:167], v[92:95]
    ds_read_b64_tr_b16 v[222:223], v43 offset:37376
    v_mfma_f32_16x16x32_bf16 v[96:99], v[184:187], v[164:167], v[96:99]
    ds_read_b64_tr_b16 v[224:225], v6 offset:53248
    v_mfma_f32_16x16x32_bf16 v[112:115], v[176:179], v[168:171], v[112:115]
    ds_read_b64_tr_b16 v[226:227], v6 offset:53760
    v_mfma_f32_16x16x32_bf16 v[116:119], v[180:183], v[168:171], v[116:119]
    ds_read_b128 v[204:207], v10 offset:24832
    v_mfma_f32_16x16x32_bf16 v[120:123], v[184:187], v[168:171], v[120:123]
    ds_read_b128 v[208:211], v10 offset:25088
    v_mfma_f32_16x16x32_bf16 v[136:139], v[176:179], v[172:175], v[136:139]
    ds_read_b128 v[212:215], v10 offset:25344
    v_mfma_f32_16x16x32_bf16 v[140:143], v[180:183], v[172:175], v[140:143]
    ds_read_b64_tr_b16 v[228:229], v42 offset:45056
    v_mfma_f32_16x16x32_bf16 v[144:147], v[184:187], v[172:175], v[144:147]
    ds_read_b64_tr_b16 v[230:231], v42 offset:45568
    v_mfma_f32_16x16x32_bf16 v[76:79], v[188:191], v[160:163], v[76:79]
    ds_read_b64_tr_b16 v[232:233], v43 offset:45056
    v_mfma_f32_16x16x32_bf16 v[80:83], v[192:195], v[160:163], v[80:83]
    ds_read_b64_tr_b16 v[234:235], v43 offset:45568
    v_mfma_f32_16x16x32_bf16 v[84:87], v[196:199], v[160:163], v[84:87]
    ds_read_b64_tr_b16 v[236:237], v7 offset:53248
    v_mfma_f32_16x16x32_bf16 v[100:103], v[188:191], v[164:167], v[100:103]
    ds_read_b64_tr_b16 v[238:239], v7 offset:53760
    v_mfma_f32_16x16x32_bf16 v[104:107], v[192:195], v[164:167], v[104:107]
    v_mfma_f32_16x16x32_bf16 v[108:111], v[196:199], v[164:167], v[108:111]
    v_mfma_f32_16x16x32_bf16 v[124:127], v[188:191], v[168:171], v[124:127]
    v_mfma_f32_16x16x32_bf16 v[128:131], v[192:195], v[168:171], v[128:131]
    v_mfma_f32_16x16x32_bf16 v[132:135], v[196:199], v[168:171], v[132:135]
    v_mfma_f32_16x16x32_bf16 v[148:151], v[188:191], v[172:175], v[148:151]
    v_mfma_f32_16x16x32_bf16 v[152:155], v[192:195], v[172:175], v[152:155]
    v_mfma_f32_16x16x32_bf16 v[156:159], v[196:199], v[172:175], v[156:159]
    s_waitcnt lgkmcnt(0)
    s_barrier
    v_mfma_f32_16x16x32_bf16 v[64:67], v[216:219], v[200:203], v[64:67]
    ds_read_b128 v[160:163], v10 offset:32768
    v_mfma_f32_16x16x32_bf16 v[68:71], v[220:223], v[200:203], v[68:71]
    ds_read_b64_tr_b16 v[176:177], v40 offset:0
    v_mfma_f32_16x16x32_bf16 v[72:75], v[224:227], v[200:203], v[72:75]
    ds_read_b64_tr_b16 v[178:179], v40 offset:512
    v_mfma_f32_16x16x32_bf16 v[88:91], v[216:219], v[204:207], v[88:91]
    ds_read_b64_tr_b16 v[180:181], v41 offset:0
    v_mfma_f32_16x16x32_bf16 v[92:95], v[220:223], v[204:207], v[92:95]
    ds_read_b64_tr_b16 v[182:183], v41 offset:512
    v_mfma_f32_16x16x32_bf16 v[96:99], v[224:227], v[204:207], v[96:99]
    ds_read_b64_tr_b16 v[184:185], v4 offset:16384
    v_mfma_f32_16x16x32_bf16 v[112:115], v[216:219], v[208:211], v[112:115]
    ds_read_b64_tr_b16 v[186:187], v4 offset:16896
    v_mfma_f32_16x16x32_bf16 v[116:119], v[220:223], v[208:211], v[116:119]
    ds_read_b128 v[164:167], v10 offset:33024
    v_mfma_f32_16x16x32_bf16 v[120:123], v[224:227], v[208:211], v[120:123]
    ds_read_b128 v[168:171], v10 offset:33280
    v_mfma_f32_16x16x32_bf16 v[136:139], v[216:219], v[212:215], v[136:139]
    ds_read_b128 v[172:175], v10 offset:33536
    v_mfma_f32_16x16x32_bf16 v[140:143], v[220:223], v[212:215], v[140:143]
    ds_read_b64_tr_b16 v[188:189], v40 offset:8192
    v_mfma_f32_16x16x32_bf16 v[144:147], v[224:227], v[212:215], v[144:147]
    ds_read_b64_tr_b16 v[190:191], v40 offset:8704
    v_mfma_f32_16x16x32_bf16 v[76:79], v[228:231], v[200:203], v[76:79]
    ds_read_b64_tr_b16 v[192:193], v41 offset:8192
    v_mfma_f32_16x16x32_bf16 v[80:83], v[232:235], v[200:203], v[80:83]
    ds_read_b64_tr_b16 v[194:195], v41 offset:8704
    v_mfma_f32_16x16x32_bf16 v[84:87], v[236:239], v[200:203], v[84:87]
    ds_read_b64_tr_b16 v[196:197], v5 offset:16384
    v_mfma_f32_16x16x32_bf16 v[100:103], v[228:231], v[204:207], v[100:103]
    ds_read_b64_tr_b16 v[198:199], v5 offset:16896
    v_mfma_f32_16x16x32_bf16 v[104:107], v[232:235], v[204:207], v[104:107]
    v_mfma_f32_16x16x32_bf16 v[108:111], v[236:239], v[204:207], v[108:111]
    v_mfma_f32_16x16x32_bf16 v[124:127], v[228:231], v[208:211], v[124:127]
    v_mfma_f32_16x16x32_bf16 v[128:131], v[232:235], v[208:211], v[128:131]
    v_mfma_f32_16x16x32_bf16 v[132:135], v[236:239], v[208:211], v[132:135]
    v_mfma_f32_16x16x32_bf16 v[148:151], v[228:231], v[212:215], v[148:151]
    v_mfma_f32_16x16x32_bf16 v[152:155], v[232:235], v[212:215], v[152:155]
    v_mfma_f32_16x16x32_bf16 v[156:159], v[236:239], v[212:215], v[156:159]
    s_waitcnt lgkmcnt(0)
    v_mfma_f32_16x16x32_bf16 v[64:67], v[176:179], v[160:163], v[64:67]
    ds_read_b128 v[200:203], v10 offset:40960
    v_mfma_f32_16x16x32_bf16 v[68:71], v[180:183], v[160:163], v[68:71]
    ds_read_b64_tr_b16 v[216:217], v40 offset:4096
    v_mfma_f32_16x16x32_bf16 v[72:75], v[184:187], v[160:163], v[72:75]
    ds_read_b64_tr_b16 v[218:219], v40 offset:4608
    v_mfma_f32_16x16x32_bf16 v[88:91], v[176:179], v[164:167], v[88:91]
    ds_read_b64_tr_b16 v[220:221], v41 offset:4096
    v_mfma_f32_16x16x32_bf16 v[92:95], v[180:183], v[164:167], v[92:95]
    ds_read_b64_tr_b16 v[222:223], v41 offset:4608
    v_mfma_f32_16x16x32_bf16 v[96:99], v[184:187], v[164:167], v[96:99]
    ds_read_b64_tr_b16 v[224:225], v4 offset:20480
    v_mfma_f32_16x16x32_bf16 v[112:115], v[176:179], v[168:171], v[112:115]
    ds_read_b64_tr_b16 v[226:227], v4 offset:20992
    v_mfma_f32_16x16x32_bf16 v[116:119], v[180:183], v[168:171], v[116:119]
    ds_read_b128 v[204:207], v10 offset:41216
    v_mfma_f32_16x16x32_bf16 v[120:123], v[184:187], v[168:171], v[120:123]
    ds_read_b128 v[208:211], v10 offset:41472
    v_mfma_f32_16x16x32_bf16 v[136:139], v[176:179], v[172:175], v[136:139]
    ds_read_b128 v[212:215], v10 offset:41728
    v_mfma_f32_16x16x32_bf16 v[140:143], v[180:183], v[172:175], v[140:143]
    ds_read_b64_tr_b16 v[228:229], v40 offset:12288
    v_mfma_f32_16x16x32_bf16 v[144:147], v[184:187], v[172:175], v[144:147]
    ds_read_b64_tr_b16 v[230:231], v40 offset:12800
    v_mfma_f32_16x16x32_bf16 v[76:79], v[188:191], v[160:163], v[76:79]
    ds_read_b64_tr_b16 v[232:233], v41 offset:12288
    v_mfma_f32_16x16x32_bf16 v[80:83], v[192:195], v[160:163], v[80:83]
    ds_read_b64_tr_b16 v[234:235], v41 offset:12800
    v_mfma_f32_16x16x32_bf16 v[84:87], v[196:199], v[160:163], v[84:87]
    ds_read_b64_tr_b16 v[236:237], v5 offset:20480
    v_mfma_f32_16x16x32_bf16 v[100:103], v[188:191], v[164:167], v[100:103]
    ds_read_b64_tr_b16 v[238:239], v5 offset:20992
    v_mfma_f32_16x16x32_bf16 v[104:107], v[192:195], v[164:167], v[104:107]
    v_mfma_f32_16x16x32_bf16 v[108:111], v[196:199], v[164:167], v[108:111]
    v_mfma_f32_16x16x32_bf16 v[124:127], v[188:191], v[168:171], v[124:127]
    v_mfma_f32_16x16x32_bf16 v[128:131], v[192:195], v[168:171], v[128:131]
    v_mfma_f32_16x16x32_bf16 v[132:135], v[196:199], v[168:171], v[132:135]
    v_mfma_f32_16x16x32_bf16 v[148:151], v[188:191], v[172:175], v[148:151]
    v_mfma_f32_16x16x32_bf16 v[152:155], v[192:195], v[172:175], v[152:155]
    v_mfma_f32_16x16x32_bf16 v[156:159], v[196:199], v[172:175], v[156:159]
    s_waitcnt lgkmcnt(0)
    s_barrier
    v_mfma_f32_16x16x32_bf16 v[64:67], v[216:219], v[200:203], v[64:67]
    ds_read_b128 v[160:163], v10 offset:0
    v_mfma_f32_16x16x32_bf16 v[68:71], v[220:223], v[200:203], v[68:71]
    ds_read_b64_tr_b16 v[176:177], v40 offset:24576
    v_mfma_f32_16x16x32_bf16 v[72:75], v[224:227], v[200:203], v[72:75]
    ds_read_b64_tr_b16 v[178:179], v40 offset:25088
    v_mfma_f32_16x16x32_bf16 v[88:91], v[216:219], v[204:207], v[88:91]
    ds_read_b64_tr_b16 v[180:181], v41 offset:24576
    v_mfma_f32_16x16x32_bf16 v[92:95], v[220:223], v[204:207], v[92:95]
    ds_read_b64_tr_b16 v[182:183], v41 offset:25088
    v_mfma_f32_16x16x32_bf16 v[96:99], v[224:227], v[204:207], v[96:99]
    ds_read_b64_tr_b16 v[184:185], v4 offset:40960
    v_mfma_f32_16x16x32_bf16 v[112:115], v[216:219], v[208:211], v[112:115]
    ds_read_b64_tr_b16 v[186:187], v4 offset:41472
    v_mfma_f32_16x16x32_bf16 v[116:119], v[220:223], v[208:211], v[116:119]
    ds_read_b128 v[164:167], v10 offset:256
    v_mfma_f32_16x16x32_bf16 v[120:123], v[224:227], v[208:211], v[120:123]
    ds_read_b128 v[168:171], v10 offset:512
    v_mfma_f32_16x16x32_bf16 v[136:139], v[216:219], v[212:215], v[136:139]
    ds_read_b128 v[172:175], v10 offset:768
    v_mfma_f32_16x16x32_bf16 v[140:143], v[220:223], v[212:215], v[140:143]
    ds_read_b64_tr_b16 v[188:189], v40 offset:32768
    v_mfma_f32_16x16x32_bf16 v[144:147], v[224:227], v[212:215], v[144:147]
    ds_read_b64_tr_b16 v[190:191], v40 offset:33280
    v_mfma_f32_16x16x32_bf16 v[76:79], v[228:231], v[200:203], v[76:79]
    ds_read_b64_tr_b16 v[192:193], v41 offset:32768
    v_mfma_f32_16x16x32_bf16 v[80:83], v[232:235], v[200:203], v[80:83]
    ds_read_b64_tr_b16 v[194:195], v41 offset:33280
    v_mfma_f32_16x16x32_bf16 v[84:87], v[236:239], v[200:203], v[84:87]
    ds_read_b64_tr_b16 v[196:197], v5 offset:40960
    v_mfma_f32_16x16x32_bf16 v[100:103], v[228:231], v[204:207], v[100:103]
    ds_read_b64_tr_b16 v[198:199], v5 offset:41472
    v_mfma_f32_16x16x32_bf16 v[104:107], v[232:235], v[204:207], v[104:107]
    v_mfma_f32_16x16x32_bf16 v[108:111], v[236:239], v[204:207], v[108:111]
    v_mfma_f32_16x16x32_bf16 v[124:127], v[228:231], v[208:211], v[124:127]
    v_mfma_f32_16x16x32_bf16 v[128:131], v[232:235], v[208:211], v[128:131]
    v_mfma_f32_16x16x32_bf16 v[132:135], v[236:239], v[208:211], v[132:135]
    v_mfma_f32_16x16x32_bf16 v[148:151], v[228:231], v[212:215], v[148:151]
    v_mfma_f32_16x16x32_bf16 v[152:155], v[232:235], v[212:215], v[152:155]
    v_mfma_f32_16x16x32_bf16 v[156:159], v[236:239], v[212:215], v[156:159]
    s_waitcnt lgkmcnt(0)
    v_mfma_f32_16x16x32_bf16 v[64:67], v[176:179], v[160:163], v[64:67]
    ds_read_b128 v[200:203], v10 offset:8192
    v_mfma_f32_16x16x32_bf16 v[68:71], v[180:183], v[160:163], v[68:71]
    ds_read_b64_tr_b16 v[216:217], v40 offset:28672
    v_mfma_f32_16x16x32_bf16 v[72:75], v[184:187], v[160:163], v[72:75]
    ds_read_b64_tr_b16 v[218:219], v40 offset:29184
    v_mfma_f32_16x16x32_bf16 v[88:91], v[176:179], v[164:167], v[88:91]
    ds_read_b64_tr_b16 v[220:221], v41 offset:28672
    v_mfma_f32_16x16x32_bf16 v[92:95], v[180:183], v[164:167], v[92:95]
    ds_read_b64_tr_b16 v[222:223], v41 offset:29184
    v_mfma_f32_16x16x32_bf16 v[96:99], v[184:187], v[164:167], v[96:99]
    ds_read_b64_tr_b16 v[224:225], v4 offset:45056
    v_mfma_f32_16x16x32_bf16 v[112:115], v[176:179], v[168:171], v[112:115]
    ds_read_b64_tr_b16 v[226:227], v4 offset:45568
    v_mfma_f32_16x16x32_bf16 v[116:119], v[180:183], v[168:171], v[116:119]
    ds_read_b128 v[204:207], v10 offset:8448
    v_mfma_f32_16x16x32_bf16 v[120:123], v[184:187], v[168:171], v[120:123]
    ds_read_b128 v[208:211], v10 offset:8704
    v_mfma_f32_16x16x32_bf16 v[136:139], v[176:179], v[172:175], v[136:139]
    ds_read_b128 v[212:215], v10 offset:8960
    v_mfma_f32_16x16x32_bf16 v[140:143], v[180:183], v[172:175], v[140:143]
    ds_read_b64_tr_b16 v[228:229], v40 offset:36864
    v_mfma_f32_16x16x32_bf16 v[144:147], v[184:187], v[172:175], v[144:147]
    ds_read_b64_tr_b16 v[230:231], v40 offset:37376
    v_mfma_f32_16x16x32_bf16 v[76:79], v[188:191], v[160:163], v[76:79]
    ds_read_b64_tr_b16 v[232:233], v41 offset:36864
    v_mfma_f32_16x16x32_bf16 v[80:83], v[192:195], v[160:163], v[80:83]
    ds_read_b64_tr_b16 v[234:235], v41 offset:37376
    v_mfma_f32_16x16x32_bf16 v[84:87], v[196:199], v[160:163], v[84:87]
    ds_read_b64_tr_b16 v[236:237], v5 offset:45056
    v_mfma_f32_16x16x32_bf16 v[100:103], v[188:191], v[164:167], v[100:103]
    ds_read_b64_tr_b16 v[238:239], v5 offset:45568
    v_mfma_f32_16x16x32_bf16 v[104:107], v[192:195], v[164:167], v[104:107]
    v_mfma_f32_16x16x32_bf16 v[108:111], v[196:199], v[164:167], v[108:111]
    v_mfma_f32_16x16x32_bf16 v[124:127], v[188:191], v[168:171], v[124:127]
    v_mfma_f32_16x16x32_bf16 v[128:131], v[192:195], v[168:171], v[128:131]
    v_mfma_f32_16x16x32_bf16 v[132:135], v[196:199], v[168:171], v[132:135]
    v_mfma_f32_16x16x32_bf16 v[148:151], v[188:191], v[172:175], v[148:151]
    v_mfma_f32_16x16x32_bf16 v[152:155], v[192:195], v[172:175], v[152:155]
    v_mfma_f32_16x16x32_bf16 v[156:159], v[196:199], v[172:175], v[156:159]
    s_waitcnt lgkmcnt(0)
    s_barrier
    v_mfma_f32_16x16x32_bf16 v[64:67], v[216:219], v[200:203], v[64:67]
    ds_read_b128 v[160:163], v10 offset:16384
    v_mfma_f32_16x16x32_bf16 v[68:71], v[220:223], v[200:203], v[68:71]
    ds_read_b64_tr_b16 v[176:177], v42 offset:8192
    v_mfma_f32_16x16x32_bf16 v[72:75], v[224:227], v[200:203], v[72:75]
    ds_read_b64_tr_b16 v[178:179], v42 offset:8704
    v_mfma_f32_16x16x32_bf16 v[88:91], v[216:219], v[204:207], v[88:91]
    ds_read_b64_tr_b16 v[180:181], v43 offset:8192
    v_mfma_f32_16x16x32_bf16 v[92:95], v[220:223], v[204:207], v[92:95]
    ds_read_b64_tr_b16 v[182:183], v43 offset:8704
    v_mfma_f32_16x16x32_bf16 v[96:99], v[224:227], v[204:207], v[96:99]
    ds_read_b64_tr_b16 v[184:185], v6 offset:24576
    v_mfma_f32_16x16x32_bf16 v[112:115], v[216:219], v[208:211], v[112:115]
    ds_read_b64_tr_b16 v[186:187], v6 offset:25088
    v_mfma_f32_16x16x32_bf16 v[116:119], v[220:223], v[208:211], v[116:119]
    ds_read_b128 v[164:167], v10 offset:16640
    v_mfma_f32_16x16x32_bf16 v[120:123], v[224:227], v[208:211], v[120:123]
    ds_read_b128 v[168:171], v10 offset:16896
    v_mfma_f32_16x16x32_bf16 v[136:139], v[216:219], v[212:215], v[136:139]
    ds_read_b128 v[172:175], v10 offset:17152
    v_mfma_f32_16x16x32_bf16 v[140:143], v[220:223], v[212:215], v[140:143]
    ds_read_b64_tr_b16 v[188:189], v42 offset:16384
    v_mfma_f32_16x16x32_bf16 v[144:147], v[224:227], v[212:215], v[144:147]
    ds_read_b64_tr_b16 v[190:191], v42 offset:16896
    v_mfma_f32_16x16x32_bf16 v[76:79], v[228:231], v[200:203], v[76:79]
    ds_read_b64_tr_b16 v[192:193], v43 offset:16384
    v_mfma_f32_16x16x32_bf16 v[80:83], v[232:235], v[200:203], v[80:83]
    ds_read_b64_tr_b16 v[194:195], v43 offset:16896
    v_mfma_f32_16x16x32_bf16 v[84:87], v[236:239], v[200:203], v[84:87]
    ds_read_b64_tr_b16 v[196:197], v7 offset:24576
    v_mfma_f32_16x16x32_bf16 v[100:103], v[228:231], v[204:207], v[100:103]
    ds_read_b64_tr_b16 v[198:199], v7 offset:25088
    v_mfma_f32_16x16x32_bf16 v[104:107], v[232:235], v[204:207], v[104:107]
    v_mfma_f32_16x16x32_bf16 v[108:111], v[236:239], v[204:207], v[108:111]
    v_mfma_f32_16x16x32_bf16 v[124:127], v[228:231], v[208:211], v[124:127]
    v_mfma_f32_16x16x32_bf16 v[128:131], v[232:235], v[208:211], v[128:131]
    v_mfma_f32_16x16x32_bf16 v[132:135], v[236:239], v[208:211], v[132:135]
    v_mfma_f32_16x16x32_bf16 v[148:151], v[228:231], v[212:215], v[148:151]
    v_mfma_f32_16x16x32_bf16 v[152:155], v[232:235], v[212:215], v[152:155]
    v_mfma_f32_16x16x32_bf16 v[156:159], v[236:239], v[212:215], v[156:159]
    s_waitcnt lgkmcnt(0)
    v_mfma_f32_16x16x32_bf16 v[64:67], v[176:179], v[160:163], v[64:67]
    ds_read_b128 v[200:203], v10 offset:24576
    v_mfma_f32_16x16x32_bf16 v[68:71], v[180:183], v[160:163], v[68:71]
    ds_read_b64_tr_b16 v[216:217], v42 offset:12288
    v_mfma_f32_16x16x32_bf16 v[72:75], v[184:187], v[160:163], v[72:75]
    ds_read_b64_tr_b16 v[218:219], v42 offset:12800
    v_mfma_f32_16x16x32_bf16 v[88:91], v[176:179], v[164:167], v[88:91]
    ds_read_b64_tr_b16 v[220:221], v43 offset:12288
    v_mfma_f32_16x16x32_bf16 v[92:95], v[180:183], v[164:167], v[92:95]
    ds_read_b64_tr_b16 v[222:223], v43 offset:12800
    v_mfma_f32_16x16x32_bf16 v[96:99], v[184:187], v[164:167], v[96:99]
    ds_read_b64_tr_b16 v[224:225], v6 offset:28672
    v_mfma_f32_16x16x32_bf16 v[112:115], v[176:179], v[168:171], v[112:115]
    ds_read_b64_tr_b16 v[226:227], v6 offset:29184
    v_mfma_f32_16x16x32_bf16 v[116:119], v[180:183], v[168:171], v[116:119]
    ds_read_b128 v[204:207], v10 offset:24832
    v_mfma_f32_16x16x32_bf16 v[120:123], v[184:187], v[168:171], v[120:123]
    ds_read_b128 v[208:211], v10 offset:25088
    v_mfma_f32_16x16x32_bf16 v[136:139], v[176:179], v[172:175], v[136:139]
    ds_read_b128 v[212:215], v10 offset:25344
    v_mfma_f32_16x16x32_bf16 v[140:143], v[180:183], v[172:175], v[140:143]
    ds_read_b64_tr_b16 v[228:229], v42 offset:20480
    v_mfma_f32_16x16x32_bf16 v[144:147], v[184:187], v[172:175], v[144:147]
    ds_read_b64_tr_b16 v[230:231], v42 offset:20992
    v_mfma_f32_16x16x32_bf16 v[76:79], v[188:191], v[160:163], v[76:79]
    ds_read_b64_tr_b16 v[232:233], v43 offset:20480
    v_mfma_f32_16x16x32_bf16 v[80:83], v[192:195], v[160:163], v[80:83]
    ds_read_b64_tr_b16 v[234:235], v43 offset:20992
    v_mfma_f32_16x16x32_bf16 v[84:87], v[196:199], v[160:163], v[84:87]
    ds_read_b64_tr_b16 v[236:237], v7 offset:28672
    v_mfma_f32_16x16x32_bf16 v[100:103], v[188:191], v[164:167], v[100:103]
    ds_read_b64_tr_b16 v[238:239], v7 offset:29184
    v_mfma_f32_16x16x32_bf16 v[104:107], v[192:195], v[164:167], v[104:107]
    v_mfma_f32_16x16x32_bf16 v[108:111], v[196:199], v[164:167], v[108:111]
    v_mfma_f32_16x16x32_bf16 v[124:127], v[188:191], v[168:171], v[124:127]
    v_mfma_f32_16x16x32_bf16 v[128:131], v[192:195], v[168:171], v[128:131]
    v_mfma_f32_16x16x32_bf16 v[132:135], v[196:199], v[168:171], v[132:135]
    v_mfma_f32_16x16x32_bf16 v[148:151], v[188:191], v[172:175], v[148:151]
    v_mfma_f32_16x16x32_bf16 v[152:155], v[192:195], v[172:175], v[152:155]
    v_mfma_f32_16x16x32_bf16 v[156:159], v[196:199], v[172:175], v[156:159]
    s_waitcnt lgkmcnt(0)
    s_barrier
    v_mfma_f32_16x16x32_bf16 v[64:67], v[216:219], v[200:203], v[64:67]
    ds_read_b128 v[160:163], v10 offset:32768
    v_mfma_f32_16x16x32_bf16 v[68:71], v[220:223], v[200:203], v[68:71]
    ds_read_b64_tr_b16 v[176:177], v42 offset:32768
    v_mfma_f32_16x16x32_bf16 v[72:75], v[224:227], v[200:203], v[72:75]
    ds_read_b64_tr_b16 v[178:179], v42 offset:33280
    v_mfma_f32_16x16x32_bf16 v[88:91], v[216:219], v[204:207], v[88:91]
    ds_read_b64_tr_b16 v[180:181], v43 offset:32768
    v_mfma_f32_16x16x32_bf16 v[92:95], v[220:223], v[204:207], v[92:95]
    ds_read_b64_tr_b16 v[182:183], v43 offset:33280
    v_mfma_f32_16x16x32_bf16 v[96:99], v[224:227], v[204:207], v[96:99]
    ds_read_b64_tr_b16 v[184:185], v6 offset:49152
    v_mfma_f32_16x16x32_bf16 v[112:115], v[216:219], v[208:211], v[112:115]
    ds_read_b64_tr_b16 v[186:187], v6 offset:49664
    v_mfma_f32_16x16x32_bf16 v[116:119], v[220:223], v[208:211], v[116:119]
    ds_read_b128 v[164:167], v10 offset:33024
    v_mfma_f32_16x16x32_bf16 v[120:123], v[224:227], v[208:211], v[120:123]
    ds_read_b128 v[168:171], v10 offset:33280
    v_mfma_f32_16x16x32_bf16 v[136:139], v[216:219], v[212:215], v[136:139]
    ds_read_b128 v[172:175], v10 offset:33536
    v_mfma_f32_16x16x32_bf16 v[140:143], v[220:223], v[212:215], v[140:143]
    ds_read_b64_tr_b16 v[188:189], v42 offset:40960
    v_mfma_f32_16x16x32_bf16 v[144:147], v[224:227], v[212:215], v[144:147]
    ds_read_b64_tr_b16 v[190:191], v42 offset:41472
    v_mfma_f32_16x16x32_bf16 v[76:79], v[228:231], v[200:203], v[76:79]
    ds_read_b64_tr_b16 v[192:193], v43 offset:40960
    v_mfma_f32_16x16x32_bf16 v[80:83], v[232:235], v[200:203], v[80:83]
    ds_read_b64_tr_b16 v[194:195], v43 offset:41472
    v_mfma_f32_16x16x32_bf16 v[84:87], v[236:239], v[200:203], v[84:87]
    ds_read_b64_tr_b16 v[196:197], v7 offset:49152
    v_mfma_f32_16x16x32_bf16 v[100:103], v[228:231], v[204:207], v[100:103]
    ds_read_b64_tr_b16 v[198:199], v7 offset:49664
    v_mfma_f32_16x16x32_bf16 v[104:107], v[232:235], v[204:207], v[104:107]
    v_mfma_f32_16x16x32_bf16 v[108:111], v[236:239], v[204:207], v[108:111]
    v_mfma_f32_16x16x32_bf16 v[124:127], v[228:231], v[208:211], v[124:127]
    v_mfma_f32_16x16x32_bf16 v[128:131], v[232:235], v[208:211], v[128:131]
    v_mfma_f32_16x16x32_bf16 v[132:135], v[236:239], v[208:211], v[132:135]
    v_mfma_f32_16x16x32_bf16 v[148:151], v[228:231], v[212:215], v[148:151]
    v_mfma_f32_16x16x32_bf16 v[152:155], v[232:235], v[212:215], v[152:155]
    v_mfma_f32_16x16x32_bf16 v[156:159], v[236:239], v[212:215], v[156:159]
    s_waitcnt lgkmcnt(0)
    v_mfma_f32_16x16x32_bf16 v[64:67], v[176:179], v[160:163], v[64:67]
    ds_read_b128 v[200:203], v10 offset:40960
    v_mfma_f32_16x16x32_bf16 v[68:71], v[180:183], v[160:163], v[68:71]
    ds_read_b64_tr_b16 v[216:217], v42 offset:36864
    v_mfma_f32_16x16x32_bf16 v[72:75], v[184:187], v[160:163], v[72:75]
    ds_read_b64_tr_b16 v[218:219], v42 offset:37376
    v_mfma_f32_16x16x32_bf16 v[88:91], v[176:179], v[164:167], v[88:91]
    ds_read_b64_tr_b16 v[220:221], v43 offset:36864
    v_mfma_f32_16x16x32_bf16 v[92:95], v[180:183], v[164:167], v[92:95]
    ds_read_b64_tr_b16 v[222:223], v43 offset:37376
    v_mfma_f32_16x16x32_bf16 v[96:99], v[184:187], v[164:167], v[96:99]
    ds_read_b64_tr_b16 v[224:225], v6 offset:53248
    v_mfma_f32_16x16x32_bf16 v[112:115], v[176:179], v[168:171], v[112:115]
    ds_read_b64_tr_b16 v[226:227], v6 offset:53760
    v_mfma_f32_16x16x32_bf16 v[116:119], v[180:183], v[168:171], v[116:119]
    ds_read_b128 v[204:207], v10 offset:41216
    v_mfma_f32_16x16x32_bf16 v[120:123], v[184:187], v[168:171], v[120:123]
    ds_read_b128 v[208:211], v10 offset:41472
    v_mfma_f32_16x16x32_bf16 v[136:139], v[176:179], v[172:175], v[136:139]
    ds_read_b128 v[212:215], v10 offset:41728
    v_mfma_f32_16x16x32_bf16 v[140:143], v[180:183], v[172:175], v[140:143]
    ds_read_b64_tr_b16 v[228:229], v42 offset:45056
    v_mfma_f32_16x16x32_bf16 v[144:147], v[184:187], v[172:175], v[144:147]
    ds_read_b64_tr_b16 v[230:231], v42 offset:45568
    v_mfma_f32_16x16x32_bf16 v[76:79], v[188:191], v[160:163], v[76:79]
    ds_read_b64_tr_b16 v[232:233], v43 offset:45056
    v_mfma_f32_16x16x32_bf16 v[80:83], v[192:195], v[160:163], v[80:83]
    ds_read_b64_tr_b16 v[234:235], v43 offset:45568
    v_mfma_f32_16x16x32_bf16 v[84:87], v[196:199], v[160:163], v[84:87]
    ds_read_b64_tr_b16 v[236:237], v7 offset:53248
    v_mfma_f32_16x16x32_bf16 v[100:103], v[188:191], v[164:167], v[100:103]
    ds_read_b64_tr_b16 v[238:239], v7 offset:53760
    v_mfma_f32_16x16x32_bf16 v[104:107], v[192:195], v[164:167], v[104:107]
    v_mfma_f32_16x16x32_bf16 v[108:111], v[196:199], v[164:167], v[108:111]
    v_mfma_f32_16x16x32_bf16 v[124:127], v[188:191], v[168:171], v[124:127]
    v_mfma_f32_16x16x32_bf16 v[128:131], v[192:195], v[168:171], v[128:131]
    v_mfma_f32_16x16x32_bf16 v[132:135], v[196:199], v[168:171], v[132:135]
    v_mfma_f32_16x16x32_bf16 v[148:151], v[188:191], v[172:175], v[148:151]
    v_mfma_f32_16x16x32_bf16 v[152:155], v[192:195], v[172:175], v[152:155]
    v_mfma_f32_16x16x32_bf16 v[156:159], v[196:199], v[172:175], v[156:159]
    s_waitcnt lgkmcnt(0)
    s_barrier
    v_mfma_f32_16x16x32_bf16 v[64:67], v[216:219], v[200:203], v[64:67]
    ds_read_b128 v[160:163], v10 offset:0
    v_mfma_f32_16x16x32_bf16 v[68:71], v[220:223], v[200:203], v[68:71]
    ds_read_b64_tr_b16 v[176:177], v40 offset:0
    v_mfma_f32_16x16x32_bf16 v[72:75], v[224:227], v[200:203], v[72:75]
    ds_read_b64_tr_b16 v[178:179], v40 offset:512
    v_mfma_f32_16x16x32_bf16 v[88:91], v[216:219], v[204:207], v[88:91]
    ds_read_b64_tr_b16 v[180:181], v41 offset:0
    v_mfma_f32_16x16x32_bf16 v[92:95], v[220:223], v[204:207], v[92:95]
    ds_read_b64_tr_b16 v[182:183], v41 offset:512
    v_mfma_f32_16x16x32_bf16 v[96:99], v[224:227], v[204:207], v[96:99]
    ds_read_b64_tr_b16 v[184:185], v4 offset:16384
    v_mfma_f32_16x16x32_bf16 v[112:115], v[216:219], v[208:211], v[112:115]
    ds_read_b64_tr_b16 v[186:187], v4 offset:16896
    v_mfma_f32_16x16x32_bf16 v[116:119], v[220:223], v[208:211], v[116:119]
    ds_read_b128 v[164:167], v10 offset:256
    v_mfma_f32_16x16x32_bf16 v[120:123], v[224:227], v[208:211], v[120:123]
    ds_read_b128 v[168:171], v10 offset:512
    v_mfma_f32_16x16x32_bf16 v[136:139], v[216:219], v[212:215], v[136:139]
    ds_read_b128 v[172:175], v10 offset:768
L_pad5:
    s_cbranch_execz L_pad6
    v_mfma_f32_16x16x32_bf16 v[140:143], v[220:223], v[212:215], v[140:143]
    ds_read_b64_tr_b16 v[188:189], v40 offset:8192
    v_mfma_f32_16x16x32_bf16 v[144:147], v[224:227], v[212:215], v[144:147]
    ds_read_b64_tr_b16 v[190:191], v40 offset:8704
    v_mfma_f32_16x16x32_bf16 v[76:79], v[228:231], v[200:203], v[76:79]
    ds_read_b64_tr_b16 v[192:193], v41 offset:8192
    v_mfma_f32_16x16x32_bf16 v[80:83], v[232:235], v[200:203], v[80:83]
    ds_read_b64_tr_b16 v[194:195], v41 offset:8704
    v_mfma_f32_16x16x32_bf16 v[84:87], v[236:239], v[200:203], v[84:87]
    ds_read_b64_tr_b16 v[196:197], v5 offset:16384
    v_mfma_f32_16x16x32_bf16 v[100:103], v[228:231], v[204:207], v[100:103]
    ds_read_b64_tr_b16 v[198:199], v5 offset:16896
    v_mfma_f32_16x16x32_bf16 v[104:107], v[232:235], v[204:207], v[104:107]
    v_mfma_f32_16x16x32_bf16 v[108:111], v[236:239], v[204:207], v[108:111]
    v_mfma_f32_16x16x32_bf16 v[124:127], v[228:231], v[208:211], v[124:127]
    v_mfma_f32_16x16x32_bf16 v[128:131], v[232:235], v[208:211], v[128:131]
    v_mfma_f32_16x16x32_bf16 v[132:135], v[236:239], v[208:211], v[132:135]
    v_mfma_f32_16x16x32_bf16 v[148:151], v[228:231], v[212:215], v[148:151]
    v_mfma_f32_16x16x32_bf16 v[152:155], v[232:235], v[212:215], v[152:155]
    v_mfma_f32_16x16x32_bf16 v[156:159], v[236:239], v[212:215], v[156:159]
    s_waitcnt lgkmcnt(0)
    v_mfma_f32_16x16x32_bf16 v[64:67], v[176:179], v[160:163], v[64:67]
    ds_read_b128 v[200:203], v10 offset:8192
    v_mfma_f32_16x16x32_bf16 v[68:71], v[180:183], v[160:163], v[68:71]
    ds_read_b64_tr_b16 v[216:217], v40 offset:4096
    v_mfma_f32_16x16x32_bf16 v[72:75], v[184:187], v[160:163], v[72:75]
    ds_read_b64_tr_b16 v[218:219], v40 offset:4608
    v_mfma_f32_16x16x32_bf16 v[88:91], v[176:179], v[164:167], v[88:91]
    ds_read_b64_tr_b16 v[220:221], v41 offset:4096
    v_mfma_f32_16x16x32_bf16 v[92:95], v[180:183], v[164:167], v[92:95]
    ds_read_b64_tr_b16 v[222:223], v41 offset:4608
    v_mfma_f32_16x16x32_bf16 v[96:99], v[184:187], v[164:167], v[96:99]
    ds_read_b64_tr_b16 v[224:225], v4 offset:20480
    v_mfma_f32_16x16x32_bf16 v[112:115], v[176:179], v[168:171], v[112:115]
    ds_read_b64_tr_b16 v[226:227], v4 offset:20992
    v_mfma_f32_16x16x32_bf16 v[116:119], v[180:183], v[168:171], v[116:119]
    ds_read_b128 v[204:207], v10 offset:8448
    v_mfma_f32_16x16x32_bf16 v[120:123], v[184:187], v[168:171], v[120:123]
    ds_read_b128 v[208:211], v10 offset:8704
    v_mfma_f32_16x16x32_bf16 v[136:139], v[176:179], v[172:175], v[136:139]
    ds_read_b128 v[212:215], v10 offset:8960
    v_mfma_f32_16x16x32_bf16 v[140:143], v[180:183], v[172:175], v[140:143]
    ds_read_b64_tr_b16 v[228:229], v40 offset:12288
    v_mfma_f32_16x16x32_bf16 v[144:147], v[184:187], v[172:175], v[144:147]
    ds_read_b64_tr_b16 v[230:231], v40 offset:12800
    v_mfma_f32_16x16x32_bf16 v[76:79], v[188:191], v[160:163], v[76:79]
    ds_read_b64_tr_b16 v[232:233], v41 offset:12288
    v_mfma_f32_16x16x32_bf16 v[80:83], v[192:195], v[160:163], v[80:83]
    ds_read_b64_tr_b16 v[234:235], v41 offset:12800
    v_mfma_f32_16x16x32_bf16 v[84:87], v[196:199], v[160:163], v[84:87]
    ds_read_b64_tr_b16 v[236:237], v5 offset:20480
    v_mfma_f32_16x16x32_bf16 v[100:103], v[188:191], v[164:167], v[100:103]
    ds_read_b64_tr_b16 v[238:239], v5 offset:20992
    v_mfma_f32_16x16x32_bf16 v[104:107], v[192:195], v[164:167], v[104:107]
    v_mfma_f32_16x16x32_bf16 v[108:111], v[196:199], v[164:167], v[108:111]
    v_mfma_f32_16x16x32_bf16 v[124:127], v[188:191], v[168:171], v[124:127]
    v_mfma_f32_16x16x32_bf16 v[128:131], v[192:195], v[168:171], v[128:131]
    v_mfma_f32_16x16x32_bf16 v[132:135], v[196:199], v[168:171], v[132:135]
    v_mfma_f32_16x16x32_bf16 v[148:151], v[188:191], v[172:175], v[148:151]
    v_mfma_f32_16x16x32_bf16 v[152:155], v[192:195], v[172:175], v[152:155]
    v_mfma_f32_16x16x32_bf16 v[156:159], v[196:199], v[172:175], v[156:159]
    s_waitcnt lgkmcnt(0)
    s_barrier
    v_mfma_f32_16x16x32_bf16 v[64:67], v[216:219], v[200:203], v[64:67]
    ds_read_b128 v[160:163], v10 offset:16384
    v_mfma_f32_16x16x32_bf16 v[68:71], v[220:223], v[200:203], v[68:71]
    ds_read_b64_tr_b16 v[176:177], v40 offset:24576
    v_mfma_f32_16x16x32_bf16 v[72:75], v[224:227], v[200:203], v[72:75]
    ds_read_b64_tr_b16 v[178:179], v40 offset:25088
    v_mfma_f32_16x16x32_bf16 v[88:91], v[216:219], v[204:207], v[88:91]
    ds_read_b64_tr_b16 v[180:181], v41 offset:24576
    v_mfma_f32_16x16x32_bf16 v[92:95], v[220:223], v[204:207], v[92:95]
    ds_read_b64_tr_b16 v[182:183], v41 offset:25088
    v_mfma_f32_16x16x32_bf16 v[96:99], v[224:227], v[204:207], v[96:99]
    ds_read_b64_tr_b16 v[184:185], v4 offset:40960
    v_mfma_f32_16x16x32_bf16 v[112:115], v[216:219], v[208:211], v[112:115]
    ds_read_b64_tr_b16 v[186:187], v4 offset:41472
    v_mfma_f32_16x16x32_bf16 v[116:119], v[220:223], v[208:211], v[116:119]
    ds_read_b128 v[164:167], v10 offset:16640
    v_mfma_f32_16x16x32_bf16 v[120:123], v[224:227], v[208:211], v[120:123]
    ds_read_b128 v[168:171], v10 offset:16896
    v_mfma_f32_16x16x32_bf16 v[136:139], v[216:219], v[212:215], v[136:139]
    ds_read_b128 v[172:175], v10 offset:17152
    v_mfma_f32_16x16x32_bf16 v[140:143], v[220:223], v[212:215], v[140:143]
    ds_read_b64_tr_b16 v[188:189], v40 offset:32768
    v_mfma_f32_16x16x32_bf16 v[144:147], v[224:227], v[212:215], v[144:147]
    ds_read_b64_tr_b16 v[190:191], v40 offset:33280
    v_mfma_f32_16x16x32_bf16 v[76:79], v[228:231], v[200:203], v[76:79]
    ds_read_b64_tr_b16 v[192:193], v41 offset:32768
    v_mfma_f32_16x16x32_bf16 v[80:83], v[232:235], v[200:203], v[80:83]
    ds_read_b64_tr_b16 v[194:195], v41 offset:33280
    v_mfma_f32_16x16x32_bf16 v[84:87], v[236:239], v[200:203], v[84:87]
    ds_read_b64_tr_b16 v[196:197], v5 offset:40960
    v_mfma_f32_16x16x32_bf16 v[100:103], v[228:231], v[204:207], v[100:103]
    ds_read_b64_tr_b16 v[198:199], v5 offset:41472
    v_mfma_f32_16x16x32_bf16 v[104:107], v[232:235], v[204:207], v[104:107]
    v_mfma_f32_16x16x32_bf16 v[108:111], v[236:239], v[204:207], v[108:111]
    v_mfma_f32_16x16x32_bf16 v[124:127], v[228:231], v[208:211], v[124:127]
    v_mfma_f32_16x16x32_bf16 v[128:131], v[232:235], v[208:211], v[128:131]
    v_mfma_f32_16x16x32_bf16 v[132:135], v[236:239], v[208:211], v[132:135]
    v_mfma_f32_16x16x32_bf16 v[148:151], v[228:231], v[212:215], v[148:151]
    v_mfma_f32_16x16x32_bf16 v[152:155], v[232:235], v[212:215], v[152:155]
    v_mfma_f32_16x16x32_bf16 v[156:159], v[236:239], v[212:215], v[156:159]
    s_waitcnt lgkmcnt(0)
    v_mfma_f32_16x16x32_bf16 v[64:67], v[176:179], v[160:163], v[64:67]
    ds_read_b128 v[200:203], v10 offset:24576
    v_mfma_f32_16x16x32_bf16 v[68:71], v[180:183], v[160:163], v[68:71]
    ds_read_b64_tr_b16 v[216:217], v40 offset:28672
    v_mfma_f32_16x16x32_bf16 v[72:75], v[184:187], v[160:163], v[72:75]
    ds_read_b64_tr_b16 v[218:219], v40 offset:29184
    v_mfma_f32_16x16x32_bf16 v[88:91], v[176:179], v[164:167], v[88:91]
    ds_read_b64_tr_b16 v[220:221], v41 offset:28672
    v_mfma_f32_16x16x32_bf16 v[92:95], v[180:183], v[164:167], v[92:95]
    ds_read_b64_tr_b16 v[222:223], v41 offset:29184
    v_mfma_f32_16x16x32_bf16 v[96:99], v[184:187], v[164:167], v[96:99]
    ds_read_b64_tr_b16 v[224:225], v4 offset:45056
    v_mfma_f32_16x16x32_bf16 v[112:115], v[176:179], v[168:171], v[112:115]
    ds_read_b64_tr_b16 v[226:227], v4 offset:45568
    v_mfma_f32_16x16x32_bf16 v[116:119], v[180:183], v[168:171], v[116:119]
    ds_read_b128 v[204:207], v10 offset:24832
    v_mfma_f32_16x16x32_bf16 v[120:123], v[184:187], v[168:171], v[120:123]
    ds_read_b128 v[208:211], v10 offset:25088
    v_mfma_f32_16x16x32_bf16 v[136:139], v[176:179], v[172:175], v[136:139]
    ds_read_b128 v[212:215], v10 offset:25344
    v_mfma_f32_16x16x32_bf16 v[140:143], v[180:183], v[172:175], v[140:143]
    ds_read_b64_tr_b16 v[228:229], v40 offset:36864
    v_mfma_f32_16x16x32_bf16 v[144:147], v[184:187], v[172:175], v[144:147]
    ds_read_b64_tr_b16 v[230:231], v40 offset:37376
    v_mfma_f32_16x16x32_bf16 v[76:79], v[188:191], v[160:163], v[76:79]
    ds_read_b64_tr_b16 v[232:233], v41 offset:36864
    v_mfma_f32_16x16x32_bf16 v[80:83], v[192:195], v[160:163], v[80:83]
    ds_read_b64_tr_b16 v[234:235], v41 offset:37376
    v_mfma_f32_16x16x32_bf16 v[84:87], v[196:199], v[160:163], v[84:87]
    ds_read_b64_tr_b16 v[236:237], v5 offset:45056
    v_mfma_f32_16x16x32_bf16 v[100:103], v[188:191], v[164:167], v[100:103]
    ds_read_b64_tr_b16 v[238:239], v5 offset:45568
    v_mfma_f32_16x16x32_bf16 v[104:107], v[192:195], v[164:167], v[104:107]
    v_mfma_f32_16x16x32_bf16 v[108:111], v[196:199], v[164:167], v[108:111]
    v_mfma_f32_16x16x32_bf16 v[124:127], v[188:191], v[168:171], v[124:127]
    v_mfma_f32_16x16x32_bf16 v[128:131], v[192:195], v[168:171], v[128:131]
    v_mfma_f32_16x16x32_bf16 v[132:135], v[196:199], v[168:171], v[132:135]
    v_mfma_f32_16x16x32_bf16 v[148:151], v[188:191], v[172:175], v[148:151]
    v_mfma_f32_16x16x32_bf16 v[152:155], v[192:195], v[172:175], v[152:155]
    v_mfma_f32_16x16x32_bf16 v[156:159], v[196:199], v[172:175], v[156:159]
    s_waitcnt lgkmcnt(0)
    s_barrier
    v_mfma_f32_16x16x32_bf16 v[64:67], v[216:219], v[200:203], v[64:67]
    ds_read_b128 v[160:163], v10 offset:32768
    v_mfma_f32_16x16x32_bf16 v[68:71], v[220:223], v[200:203], v[68:71]
    ds_read_b64_tr_b16 v[176:177], v42 offset:8192
    v_mfma_f32_16x16x32_bf16 v[72:75], v[224:227], v[200:203], v[72:75]
    ds_read_b64_tr_b16 v[178:179], v42 offset:8704
    v_mfma_f32_16x16x32_bf16 v[88:91], v[216:219], v[204:207], v[88:91]
    ds_read_b64_tr_b16 v[180:181], v43 offset:8192
    v_mfma_f32_16x16x32_bf16 v[92:95], v[220:223], v[204:207], v[92:95]
    ds_read_b64_tr_b16 v[182:183], v43 offset:8704
    v_mfma_f32_16x16x32_bf16 v[96:99], v[224:227], v[204:207], v[96:99]
    ds_read_b64_tr_b16 v[184:185], v6 offset:24576
    v_mfma_f32_16x16x32_bf16 v[112:115], v[216:219], v[208:211], v[112:115]
    ds_read_b64_tr_b16 v[186:187], v6 offset:25088
    v_mfma_f32_16x16x32_bf16 v[116:119], v[220:223], v[208:211], v[116:119]
    ds_read_b128 v[164:167], v10 offset:33024
    v_mfma_f32_16x16x32_bf16 v[120:123], v[224:227], v[208:211], v[120:123]
    ds_read_b128 v[168:171], v10 offset:33280
    v_mfma_f32_16x16x32_bf16 v[136:139], v[216:219], v[212:215], v[136:139]
    ds_read_b128 v[172:175], v10 offset:33536
    v_mfma_f32_16x16x32_bf16 v[140:143], v[220:223], v[212:215], v[140:143]
    ds_read_b64_tr_b16 v[188:189], v42 offset:16384
    v_mfma_f32_16x16x32_bf16 v[144:147], v[224:227], v[212:215], v[144:147]
    ds_read_b64_tr_b16 v[190:191], v42 offset:16896
    v_mfma_f32_16x16x32_bf16 v[76:79], v[228:231], v[200:203], v[76:79]
    ds_read_b64_tr_b16 v[192:193], v43 offset:16384
    v_mfma_f32_16x16x32_bf16 v[80:83], v[232:235], v[200:203], v[80:83]
    ds_read_b64_tr_b16 v[194:195], v43 offset:16896
    v_mfma_f32_16x16x32_bf16 v[84:87], v[236:239], v[200:203], v[84:87]
    ds_read_b64_tr_b16 v[196:197], v7 offset:24576
    v_mfma_f32_16x16x32_bf16 v[100:103], v[228:231], v[204:207], v[100:103]
    ds_read_b64_tr_b16 v[198:199], v7 offset:25088
    v_mfma_f32_16x16x32_bf16 v[104:107], v[232:235], v[204:207], v[104:107]
    v_mfma_f32_16x16x32_bf16 v[108:111], v[236:239], v[204:207], v[108:111]
    v_mfma_f32_16x16x32_bf16 v[124:127], v[228:231], v[208:211], v[124:127]
    v_mfma_f32_16x16x32_bf16 v[128:131], v[232:235], v[208:211], v[128:131]
    v_mfma_f32_16x16x32_bf16 v[132:135], v[236:239], v[208:211], v[132:135]
    v_mfma_f32_16x16x32_bf16 v[148:151], v[228:231], v[212:215], v[148:151]
    v_mfma_f32_16x16x32_bf16 v[152:155], v[232:235], v[212:215], v[152:155]
    v_mfma_f32_16x16x32_bf16 v[156:159], v[236:239], v[212:215], v[156:159]
    s_waitcnt lgkmcnt(0)
    v_mfma_f32_16x16x32_bf16 v[64:67], v[176:179], v[160:163], v[64:67]
    ds_read_b128 v[200:203], v10 offset:40960
    v_mfma_f32_16x16x32_bf16 v[68:71], v[180:183], v[160:163], v[68:71]
    ds_read_b64_tr_b16 v[216:217], v42 offset:12288
    v_mfma_f32_16x16x32_bf16 v[72:75], v[184:187], v[160:163], v[72:75]
    ds_read_b64_tr_b16 v[218:219], v42 offset:12800
    v_mfma_f32_16x16x32_bf16 v[88:91], v[176:179], v[164:167], v[88:91]
    ds_read_b64_tr_b16 v[220:221], v43 offset:12288
    v_mfma_f32_16x16x32_bf16 v[92:95], v[180:183], v[164:167], v[92:95]
    ds_read_b64_tr_b16 v[222:223], v43 offset:12800
    v_mfma_f32_16x16x32_bf16 v[96:99], v[184:187], v[164:167], v[96:99]
    ds_read_b64_tr_b16 v[224:225], v6 offset:28672
    v_mfma_f32_16x16x32_bf16 v[112:115], v[176:179], v[168:171], v[112:115]
    ds_read_b64_tr_b16 v[226:227], v6 offset:29184
    v_mfma_f32_16x16x32_bf16 v[116:119], v[180:183], v[168:171], v[116:119]
    ds_read_b128 v[204:207], v10 offset:41216
    v_mfma_f32_16x16x32_bf16 v[120:123], v[184:187], v[168:171], v[120:123]
    ds_read_b128 v[208:211], v10 offset:41472
    v_mfma_f32_16x16x32_bf16 v[136:139], v[176:179], v[172:175], v[136:139]
    ds_read_b128 v[212:215], v10 offset:41728
    v_mfma_f32_16x16x32_bf16 v[140:143], v[180:183], v[172:175], v[140:143]
    ds_read_b64_tr_b16 v[228:229], v42 offset:20480
    v_mfma_f32_16x16x32_bf16 v[144:147], v[184:187], v[172:175], v[144:147]
    ds_read_b64_tr_b16 v[230:231], v42 offset:20992
    v_mfma_f32_16x16x32_bf16 v[76:79], v[188:191], v[160:163], v[76:79]
    ds_read_b64_tr_b16 v[232:233], v43 offset:20480
    v_mfma_f32_16x16x32_bf16 v[80:83], v[192:195], v[160:163], v[80:83]
    ds_read_b64_tr_b16 v[234:235], v43 offset:20992
    v_mfma_f32_16x16x32_bf16 v[84:87], v[196:199], v[160:163], v[84:87]
    ds_read_b64_tr_b16 v[236:237], v7 offset:28672
    v_mfma_f32_16x16x32_bf16 v[100:103], v[188:191], v[164:167], v[100:103]
    ds_read_b64_tr_b16 v[238:239], v7 offset:29184
    v_mfma_f32_16x16x32_bf16 v[104:107], v[192:195], v[164:167], v[104:107]
    v_mfma_f32_16x16x32_bf16 v[108:111], v[196:199], v[164:167], v[108:111]
    v_mfma_f32_16x16x32_bf16 v[124:127], v[188:191], v[168:171], v[124:127]
    v_mfma_f32_16x16x32_bf16 v[128:131], v[192:195], v[168:171], v[128:131]
    v_mfma_f32_16x16x32_bf16 v[132:135], v[196:199], v[168:171], v[132:135]
    v_mfma_f32_16x16x32_bf16 v[148:151], v[188:191], v[172:175], v[148:151]
    v_mfma_f32_16x16x32_bf16 v[152:155], v[192:195], v[172:175], v[152:155]
    v_mfma_f32_16x16x32_bf16 v[156:159], v[196:199], v[172:175], v[156:159]
    s_waitcnt lgkmcnt(0)
    s_barrier
    v_mfma_f32_16x16x32_bf16 v[64:67], v[216:219], v[200:203], v[64:67]
    ds_read_b128 v[160:163], v10 offset:0
    v_mfma_f32_16x16x32_bf16 v[68:71], v[220:223], v[200:203], v[68:71]
    ds_read_b64_tr_b16 v[176:177], v42 offset:32768
    v_mfma_f32_16x16x32_bf16 v[72:75], v[224:227], v[200:203], v[72:75]
    ds_read_b64_tr_b16 v[178:179], v42 offset:33280
    v_mfma_f32_16x16x32_bf16 v[88:91], v[216:219], v[204:207], v[88:91]
    ds_read_b64_tr_b16 v[180:181], v43 offset:32768
    v_mfma_f32_16x16x32_bf16 v[92:95], v[220:223], v[204:207], v[92:95]
    ds_read_b64_tr_b16 v[182:183], v43 offset:33280
    v_mfma_f32_16x16x32_bf16 v[96:99], v[224:227], v[204:207], v[96:99]
    ds_read_b64_tr_b16 v[184:185], v6 offset:49152
    v_mfma_f32_16x16x32_bf16 v[112:115], v[216:219], v[208:211], v[112:115]
    ds_read_b64_tr_b16 v[186:187], v6 offset:49664
    v_mfma_f32_16x16x32_bf16 v[116:119], v[220:223], v[208:211], v[116:119]
    ds_read_b128 v[164:167], v10 offset:256
    v_mfma_f32_16x16x32_bf16 v[120:123], v[224:227], v[208:211], v[120:123]
    ds_read_b128 v[168:171], v10 offset:512
    v_mfma_f32_16x16x32_bf16 v[136:139], v[216:219], v[212:215], v[136:139]
    ds_read_b128 v[172:175], v10 offset:768
    v_mfma_f32_16x16x32_bf16 v[140:143], v[220:223], v[212:215], v[140:143]
    ds_read_b64_tr_b16 v[188:189], v42 offset:40960
    v_mfma_f32_16x16x32_bf16 v[144:147], v[224:227], v[212:215], v[144:147]
    ds_read_b64_tr_b16 v[190:191], v42 offset:41472
    v_mfma_f32_16x16x32_bf16 v[76:79], v[228:231], v[200:203], v[76:79]
    ds_read_b64_tr_b16 v[192:193], v43 offset:40960
    v_mfma_f32_16x16x32_bf16 v[80:83], v[232:235], v[200:203], v[80:83]
    ds_read_b64_tr_b16 v[194:195], v43 offset:41472
    v_mfma_f32_16x16x32_bf16 v[84:87], v[236:239], v[200:203], v[84:87]
    ds_read_b64_tr_b16 v[196:197], v7 offset:49152
    v_mfma_f32_16x16x32_bf16 v[100:103], v[228:231], v[204:207], v[100:103]
    ds_read_b64_tr_b16 v[198:199], v7 offset:49664
    v_mfma_f32_16x16x32_bf16 v[104:107], v[232:235], v[204:207], v[104:107]
    v_mfma_f32_16x16x32_bf16 v[108:111], v[236:239], v[204:207], v[108:111]
    v_mfma_f32_16x16x32_bf16 v[124:127], v[228:231], v[208:211], v[124:127]
    v_mfma_f32_16x16x32_bf16 v[128:131], v[232:235], v[208:211], v[128:131]
    v_mfma_f32_16x16x32_bf16 v[132:135], v[236:239], v[208:211], v[132:135]
    v_mfma_f32_16x16x32_bf16 v[148:151], v[228:231], v[212:215], v[148:151]
    v_mfma_f32_16x16x32_bf16 v[152:155], v[232:235], v[212:215], v[152:155]
    v_mfma_f32_16x16x32_bf16 v[156:159], v[236:239], v[212:215], v[156:159]
    s_waitcnt lgkmcnt(0)
    v_mfma_f32_16x16x32_bf16 v[64:67], v[176:179], v[160:163], v[64:67]
    ds_read_b128 v[200:203], v10 offset:8192
    v_mfma_f32_16x16x32_bf16 v[68:71], v[180:183], v[160:163], v[68:71]
    ds_read_b64_tr_b16 v[216:217], v42 offset:36864
    v_mfma_f32_16x16x32_bf16 v[72:75], v[184:187], v[160:163], v[72:75]
    ds_read_b64_tr_b16 v[218:219], v42 offset:37376
    v_mfma_f32_16x16x32_bf16 v[88:91], v[176:179], v[164:167], v[88:91]
    ds_read_b64_tr_b16 v[220:221], v43 offset:36864
    v_mfma_f32_16x16x32_bf16 v[92:95], v[180:183], v[164:167], v[92:95]
    ds_read_b64_tr_b16 v[222:223], v43 offset:37376
    v_mfma_f32_16x16x32_bf16 v[96:99], v[184:187], v[164:167], v[96:99]
    ds_read_b64_tr_b16 v[224:225], v6 offset:53248
    v_mfma_f32_16x16x32_bf16 v[112:115], v[176:179], v[168:171], v[112:115]
    ds_read_b64_tr_b16 v[226:227], v6 offset:53760
    v_mfma_f32_16x16x32_bf16 v[116:119], v[180:183], v[168:171], v[116:119]
    ds_read_b128 v[204:207], v10 offset:8448
    v_mfma_f32_16x16x32_bf16 v[120:123], v[184:187], v[168:171], v[120:123]
    ds_read_b128 v[208:211], v10 offset:8704
    v_mfma_f32_16x16x32_bf16 v[136:139], v[176:179], v[172:175], v[136:139]
    ds_read_b128 v[212:215], v10 offset:8960
    v_mfma_f32_16x16x32_bf16 v[140:143], v[180:183], v[172:175], v[140:143]
    ds_read_b64_tr_b16 v[228:229], v42 offset:45056
    v_mfma_f32_16x16x32_bf16 v[144:147], v[184:187], v[172:175], v[144:147]
    ds_read_b64_tr_b16 v[230:231], v42 offset:45568
    v_mfma_f32_16x16x32_bf16 v[76:79], v[188:191], v[160:163], v[76:79]
    ds_read_b64_tr_b16 v[232:233], v43 offset:45056
    v_mfma_f32_16x16x32_bf16 v[80:83], v[192:195], v[160:163], v[80:83]
    ds_read_b64_tr_b16 v[234:235], v43 offset:45568
    v_mfma_f32_16x16x32_bf16 v[84:87], v[196:199], v[160:163], v[84:87]
    ds_read_b64_tr_b16 v[236:237], v7 offset:53248
    v_mfma_f32_16x16x32_bf16 v[100:103], v[188:191], v[164:167], v[100:103]
    ds_read_b64_tr_b16 v[238:239], v7 offset:53760
    v_mfma_f32_16x16x32_bf16 v[104:107], v[192:195], v[164:167], v[104:107]
    v_mfma_f32_16x16x32_bf16 v[108:111], v[196:199], v[164:167], v[108:111]
    v_mfma_f32_16x16x32_bf16 v[124:127], v[188:191], v[168:171], v[124:127]
    v_mfma_f32_16x16x32_bf16 v[128:131], v[192:195], v[168:171], v[128:131]
    v_mfma_f32_16x16x32_bf16 v[132:135], v[196:199], v[168:171], v[132:135]
    v_mfma_f32_16x16x32_bf16 v[148:151], v[188:191], v[172:175], v[148:151]
    v_mfma_f32_16x16x32_bf16 v[152:155], v[192:195], v[172:175], v[152:155]
    v_mfma_f32_16x16x32_bf16 v[156:159], v[196:199], v[172:175], v[156:159]
    s_waitcnt lgkmcnt(0)
    s_barrier
    v_mfma_f32_16x16x32_bf16 v[64:67], v[216:219], v[200:203], v[64:67]
    ds_read_b128 v[160:163], v11 offset:0
    v_mfma_f32_16x16x32_bf16 v[68:71], v[220:223], v[200:203], v[68:71]
    ds_read_b128 v[164:167], v11 offset:256
    v_mfma_f32_16x16x32_bf16 v[72:75], v[224:227], v[200:203], v[72:75]
    ds_read_b128 v[168:171], v11 offset:512
    v_mfma_f32_16x16x32_bf16 v[88:91], v[216:219], v[204:207], v[88:91]
    ds_read_b128 v[172:175], v11 offset:768
    v_mfma_f32_16x16x32_bf16 v[92:95], v[220:223], v[204:207], v[92:95]
    ds_read_b128 v[12:15], v36 offset:0
    v_mfma_f32_16x16x32_bf16 v[96:99], v[224:227], v[204:207], v[96:99]
    ds_read_b128 v[16:19], v37 offset:0
    v_mfma_f32_16x16x32_bf16 v[112:115], v[216:219], v[208:211], v[112:115]
    ds_read_b128 v[20:23], v38 offset:0
    v_mfma_f32_16x16x32_bf16 v[116:119], v[220:223], v[208:211], v[116:119]
    ds_read_b128 v[24:27], v36 offset:384
    v_mfma_f32_16x16x32_bf16 v[120:123], v[224:227], v[208:211], v[120:123]
    ds_read_b128 v[28:31], v37 offset:384
    v_mfma_f32_16x16x32_bf16 v[136:139], v[216:219], v[212:215], v[136:139]
    ds_read_b128 v[32:35], v38 offset:384
    v_mfma_f32_16x16x32_bf16 v[140:143], v[220:223], v[212:215], v[140:143]
    v_mfma_f32_16x16x32_bf16 v[144:147], v[224:227], v[212:215], v[144:147]
    v_mfma_f32_16x16x32_bf16 v[76:79], v[228:231], v[200:203], v[76:79]
    v_mfma_f32_16x16x32_bf16 v[80:83], v[232:235], v[200:203], v[80:83]
    v_mfma_f32_16x16x32_bf16 v[84:87], v[236:239], v[200:203], v[84:87]
    v_mfma_f32_16x16x32_bf16 v[100:103], v[228:231], v[204:207], v[100:103]
    v_mfma_f32_16x16x32_bf16 v[104:107], v[232:235], v[204:207], v[104:107]
    v_mfma_f32_16x16x32_bf16 v[108:111], v[236:239], v[204:207], v[108:111]
    v_mfma_f32_16x16x32_bf16 v[124:127], v[228:231], v[208:211], v[124:127]
    v_mfma_f32_16x16x32_bf16 v[128:131], v[232:235], v[208:211], v[128:131]
    v_mfma_f32_16x16x32_bf16 v[132:135], v[236:239], v[208:211], v[132:135]
    v_mfma_f32_16x16x32_bf16 v[148:151], v[228:231], v[212:215], v[148:151]
    v_mfma_f32_16x16x32_bf16 v[152:155], v[232:235], v[212:215], v[152:155]
    v_mfma_f32_16x16x32_bf16 v[156:159], v[236:239], v[212:215], v[156:159]
    s_waitcnt lgkmcnt(0)
    v_pk_fma_f32 v[64:65], v[12:13], v[160:161], v[64:65] op_sel_hi:[1,0,1]
    v_pk_fma_f32 v[68:69], v[16:17], v[160:161], v[68:69] op_sel_hi:[1,0,1]
    v_pk_fma_f32 v[72:73], v[20:21], v[160:161], v[72:73] op_sel_hi:[1,0,1]
    v_pk_fma_f32 v[66:67], v[14:15], v[160:161], v[66:67] op_sel_hi:[1,0,1]
    v_pk_fma_f32 v[70:71], v[18:19], v[160:161], v[70:71] op_sel_hi:[1,0,1]
    v_pk_fma_f32 v[74:75], v[22:23], v[160:161], v[74:75] op_sel_hi:[1,0,1]
    v_pk_mul_f32 v[176:177], v[64:65], v[160:161] op_sel:[0,1] op_sel_hi:[1,1]
    v_pk_mul_f32 v[180:181], v[68:69], v[160:161] op_sel:[0,1] op_sel_hi:[1,1]
    v_pk_mul_f32 v[184:185], v[72:73], v[160:161] op_sel:[0,1] op_sel_hi:[1,1]
    v_pk_mul_f32 v[178:179], v[66:67], v[160:161] op_sel:[0,1] op_sel_hi:[1,1]
    v_pk_mul_f32 v[182:183], v[70:71], v[160:161] op_sel:[0,1] op_sel_hi:[1,1]
    v_pk_mul_f32 v[186:187], v[74:75], v[160:161] op_sel:[0,1] op_sel_hi:[1,1]
    v_exp_f32 v176, v176
    v_exp_f32 v180, v180
    v_exp_f32 v184, v184
    v_exp_f32 v177, v177
    v_exp_f32 v181, v181
    v_exp_f32 v185, v185
    v_exp_f32 v178, v178
    v_exp_f32 v182, v182
    v_exp_f32 v186, v186
    v_exp_f32 v179, v179
    v_exp_f32 v183, v183
    v_exp_f32 v187, v187
    v_pk_fma_f32 v[76:77], v[24:25], v[160:161], v[76:77] op_sel_hi:[1,0,1]
    v_pk_fma_f32 v[80:81], v[28:29], v[160:161], v[80:81] op_sel_hi:[1,0,1]
    v_pk_fma_f32 v[84:85], v[32:33], v[160:161], v[84:85] op_sel_hi:[1,0,1]
    v_pk_fma_f32 v[78:79], v[26:27], v[160:161], v[78:79] op_sel_hi:[1,0,1]
    v_pk_fma_f32 v[82:83], v[30:31], v[160:161], v[82:83] op_sel_hi:[1,0,1]
    v_pk_fma_f32 v[86:87], v[34:35], v[160:161], v[86:87] op_sel_hi:[1,0,1]
    v_pk_fma_f32 v[176:177], v[176:177], v[162:163], v[162:163] op_sel_hi:[1,0,0]
    v_pk_fma_f32 v[180:181], v[180:181], v[162:163], v[162:163] op_sel_hi:[1,0,0]
    v_pk_fma_f32 v[184:185], v[184:185], v[162:163], v[162:163] op_sel_hi:[1,0,0]
    v_pk_fma_f32 v[178:179], v[178:179], v[162:163], v[162:163] op_sel_hi:[1,0,0]
    v_pk_fma_f32 v[182:183], v[182:183], v[162:163], v[162:163] op_sel_hi:[1,0,0]
    v_pk_fma_f32 v[186:187], v[186:187], v[162:163], v[162:163] op_sel_hi:[1,0,0]
    v_pk_mul_f32 v[64:65], v[64:65], v[76:77]
    v_pk_mul_f32 v[68:69], v[68:69], v[80:81]
    v_pk_mul_f32 v[72:73], v[72:73], v[84:85]
    v_pk_mul_f32 v[66:67], v[66:67], v[78:79]
    v_pk_mul_f32 v[70:71], v[70:71], v[82:83]
    v_pk_mul_f32 v[74:75], v[74:75], v[86:87]
    v_rcp_f32 v176, v176
    v_rcp_f32 v180, v180
    v_rcp_f32 v184, v184
    v_rcp_f32 v177, v177
    v_rcp_f32 v181, v181
    v_rcp_f32 v185, v185
    v_rcp_f32 v178, v178
    v_rcp_f32 v182, v182
    v_rcp_f32 v186, v186
    v_rcp_f32 v179, v179
    v_rcp_f32 v183, v183
    v_rcp_f32 v187, v187
    v_pk_mul_f32 v[64:65], v[64:65], v[176:177]
L_pad6:
    s_cbranch_execz L_back
    s_nop 0
    v_pk_mul_f32 v[68:69], v[68:69], v[180:181]
    v_pk_mul_f32 v[72:73], v[72:73], v[184:185]
    v_pk_mul_f32 v[66:67], v[66:67], v[178:179]
    v_pk_mul_f32 v[70:71], v[70:71], v[182:183]
    v_pk_mul_f32 v[74:75], v[74:75], v[186:187]
    v_cvt_pk_bf16_f32 v200, v64, v65
    v_cvt_pk_bf16_f32 v202, v68, v69
    v_cvt_pk_bf16_f32 v216, v72, v73
    v_cvt_pk_bf16_f32 v201, v66, v67
    v_cvt_pk_bf16_f32 v203, v70, v71
    v_cvt_pk_bf16_f32 v217, v74, v75
    buffer_store_dwordx4 v[200:203], v52, s[32:35], 0 offen offset:0 sc1
    v_pk_fma_f32 v[88:89], v[12:13], v[164:165], v[88:89] op_sel_hi:[1,0,1]
    v_pk_fma_f32 v[92:93], v[16:17], v[164:165], v[92:93] op_sel_hi:[1,0,1]
    v_pk_fma_f32 v[96:97], v[20:21], v[164:165], v[96:97] op_sel_hi:[1,0,1]
    v_pk_fma_f32 v[90:91], v[14:15], v[164:165], v[90:91] op_sel_hi:[1,0,1]
    v_pk_fma_f32 v[94:95], v[18:19], v[164:165], v[94:95] op_sel_hi:[1,0,1]
    v_pk_fma_f32 v[98:99], v[22:23], v[164:165], v[98:99] op_sel_hi:[1,0,1]
    v_pk_mul_f32 v[176:177], v[88:89], v[164:165] op_sel:[0,1] op_sel_hi:[1,1]
    v_pk_mul_f32 v[180:181], v[92:93], v[164:165] op_sel:[0,1] op_sel_hi:[1,1]
    v_pk_mul_f32 v[184:185], v[96:97], v[164:165] op_sel:[0,1] op_sel_hi:[1,1]
    v_pk_mul_f32 v[178:179], v[90:91], v[164:165] op_sel:[0,1] op_sel_hi:[1,1]
    v_pk_mul_f32 v[182:183], v[94:95], v[164:165] op_sel:[0,1] op_sel_hi:[1,1]
    v_pk_mul_f32 v[186:187], v[98:99], v[164:165] op_sel:[0,1] op_sel_hi:[1,1]
    v_exp_f32 v176, v176
    v_exp_f32 v180, v180
    v_exp_f32 v184, v184
    v_exp_f32 v177, v177
    v_exp_f32 v181, v181
    v_exp_f32 v185, v185
    v_exp_f32 v178, v178
    v_exp_f32 v182, v182
    v_exp_f32 v186, v186
    v_exp_f32 v179, v179
    v_exp_f32 v183, v183
    v_exp_f32 v187, v187
    v_pk_fma_f32 v[100:101], v[24:25], v[164:165], v[100:101] op_sel_hi:[1,0,1]
    v_pk_fma_f32 v[104:105], v[28:29], v[164:165], v[104:105] op_sel_hi:[1,0,1]
    v_pk_fma_f32 v[108:109], v[32:33], v[164:165], v[108:109] op_sel_hi:[1,0,1]
    v_pk_fma_f32 v[102:103], v[26:27], v[164:165], v[102:103] op_sel_hi:[1,0,1]
    v_pk_fma_f32 v[106:107], v[30:31], v[164:165], v[106:107] op_sel_hi:[1,0,1]
    v_pk_fma_f32 v[110:111], v[34:35], v[164:165], v[110:111] op_sel_hi:[1,0,1]
    v_pk_fma_f32 v[176:177], v[176:177], v[166:167], v[166:167] op_sel_hi:[1,0,0]
    v_pk_fma_f32 v[180:181], v[180:181], v[166:167], v[166:167] op_sel_hi:[1,0,0]
    v_pk_fma_f32 v[184:185], v[184:185], v[166:167], v[166:167] op_sel_hi:[1,0,0]
    v_pk_fma_f32 v[178:179], v[178:179], v[166:167], v[166:167] op_sel_hi:[1,0,0]
    v_pk_fma_f32 v[182:183], v[182:183], v[166:167], v[166:167] op_sel_hi:[1,0,0]
    v_pk_fma_f32 v[186:187], v[186:187], v[166:167], v[166:167] op_sel_hi:[1,0,0]
    v_pk_mul_f32 v[88:89], v[88:89], v[100:101]
    v_pk_mul_f32 v[92:93], v[92:93], v[104:105]
    v_pk_mul_f32 v[96:97], v[96:97], v[108:109]
    v_pk_mul_f32 v[90:91], v[90:91], v[102:103]
    v_pk_mul_f32 v[94:95], v[94:95], v[106:107]
    v_pk_mul_f32 v[98:99], v[98:99], v[110:111]
    v_rcp_f32 v176, v176
    v_rcp_f32 v180, v180
    v_rcp_f32 v184, v184
    v_rcp_f32 v177, v177
    v_rcp_f32 v181, v181
    v_rcp_f32 v185, v185
    v_rcp_f32 v178, v178
    v_rcp_f32 v182, v182
    v_rcp_f32 v186, v186
    v_rcp_f32 v179, v179
    v_rcp_f32 v183, v183
    v_rcp_f32 v187, v187
    v_pk_mul_f32 v[88:89], v[88:89], v[176:177]
    v_pk_mul_f32 v[92:93], v[92:93], v[180:181]
    v_pk_mul_f32 v[96:97], v[96:97], v[184:185]
    v_pk_mul_f32 v[90:91], v[90:91], v[178:179]
    v_pk_mul_f32 v[94:95], v[94:95], v[182:183]
    v_pk_mul_f32 v[98:99], v[98:99], v[186:187]
    v_cvt_pk_bf16_f32 v204, v88, v89
    v_cvt_pk_bf16_f32 v206, v92, v93
    v_cvt_pk_bf16_f32 v218, v96, v97
    v_cvt_pk_bf16_f32 v205, v90, v91
    v_cvt_pk_bf16_f32 v207, v94, v95
    v_cvt_pk_bf16_f32 v219, v98, v99
    buffer_store_dwordx4 v[204:207], v52, s[32:35], 0 offen offset:256 sc1
    v_permlane16_swap_b32 v216, v218
    v_permlane16_swap_b32 v217, v219
    buffer_store_dwordx4 v[216:219], v53, s[32:35], 0 offen offset:0 sc1
    v_pk_fma_f32 v[112:113], v[12:13], v[168:169], v[112:113] op_sel_hi:[1,0,1]
    v_pk_fma_f32 v[116:117], v[16:17], v[168:169], v[116:117] op_sel_hi:[1,0,1]
    v_pk_fma_f32 v[120:121], v[20:21], v[168:169], v[120:121] op_sel_hi:[1,0,1]
    v_pk_fma_f32 v[114:115], v[14:15], v[168:169], v[114:115] op_sel_hi:[1,0,1]
    v_pk_fma_f32 v[118:119], v[18:19], v[168:169], v[118:119] op_sel_hi:[1,0,1]
    v_pk_fma_f32 v[122:123], v[22:23], v[168:169], v[122:123] op_sel_hi:[1,0,1]
    v_pk_mul_f32 v[176:177], v[112:113], v[168:169] op_sel:[0,1] op_sel_hi:[1,1]
    v_pk_mul_f32 v[180:181], v[116:117], v[168:169] op_sel:[0,1] op_sel_hi:[1,1]
    v_pk_mul_f32 v[184:185], v[120:121], v[168:169] op_sel:[0,1] op_sel_hi:[1,1]
    v_pk_mul_f32 v[178:179], v[114:115], v[168:169] op_sel:[0,1] op_sel_hi:[1,1]
    v_pk_mul_f32 v[182:183], v[118:119], v[168:169] op_sel:[0,1] op_sel_hi:[1,1]
    v_pk_mul_f32 v[186:187], v[122:123], v[168:169] op_sel:[0,1] op_sel_hi:[1,1]
    v_exp_f32 v176, v176
    v_exp_f32 v180, v180
    v_exp_f32 v184, v184
    v_exp_f32 v177, v177
    v_exp_f32 v181, v181
    v_exp_f32 v185, v185
    v_exp_f32 v178, v178
    v_exp_f32 v182, v182
    v_exp_f32 v186, v186
    v_exp_f32 v179, v179
    v_exp_f32 v183, v183
    v_exp_f32 v187, v187
    v_pk_fma_f32 v[124:125], v[24:25], v[168:169], v[124:125] op_sel_hi:[1,0,1]
    v_pk_fma_f32 v[128:129], v[28:29], v[168:169], v[128:129] op_sel_hi:[1,0,1]
    v_pk_fma_f32 v[132:133], v[32:33], v[168:169], v[132:133] op_sel_hi:[1,0,1]
    v_pk_fma_f32 v[126:127], v[26:27], v[168:169], v[126:127] op_sel_hi:[1,0,1]
    v_pk_fma_f32 v[130:131], v[30:31], v[168:169], v[130:131] op_sel_hi:[1,0,1]
    v_pk_fma_f32 v[134:135], v[34:35], v[168:169], v[134:135] op_sel_hi:[1,0,1]
    v_pk_fma_f32 v[176:177], v[176:177], v[170:171], v[170:171] op_sel_hi:[1,0,0]
    v_pk_fma_f32 v[180:181], v[180:181], v[170:171], v[170:171] op_sel_hi:[1,0,0]
    v_pk_fma_f32 v[184:185], v[184:185], v[170:171], v[170:171] op_sel_hi:[1,0,0]
    v_pk_fma_f32 v[178:179], v[178:179], v[170:171], v[170:171] op_sel_hi:[1,0,0]
    v_pk_fma_f32 v[182:183], v[182:183], v[170:171], v[170:171] op_sel_hi:[1,0,0]
    v_pk_fma_f32 v[186:187], v[186:187], v[170:171], v[170:171] op_sel_hi:[1,0,0]
    v_pk_mul_f32 v[112:113], v[112:113], v[124:125]
    v_pk_mul_f32 v[116:117], v[116:117], v[128:129]
    v_pk_mul_f32 v[120:121], v[120:121], v[132:133]
    v_pk_mul_f32 v[114:115], v[114:115], v[126:127]
    v_pk_mul_f32 v[118:119], v[118:119], v[130:131]
    v_pk_mul_f32 v[122:123], v[122:123], v[134:135]
    v_rcp_f32 v176, v176
    v_rcp_f32 v180, v180
    v_rcp_f32 v184, v184
    v_rcp_f32 v177, v177
    v_rcp_f32 v181, v181
    v_rcp_f32 v185, v185
    v_rcp_f32 v178, v178
    v_rcp_f32 v182, v182
    v_rcp_f32 v186, v186
    v_rcp_f32 v179, v179
    v_rcp_f32 v183, v183
    v_rcp_f32 v187, v187
    v_pk_mul_f32 v[112:113], v[112:113], v[176:177]
    v_pk_mul_f32 v[116:117], v[116:117], v[180:181]
    v_pk_mul_f32 v[120:121], v[120:121], v[184:185]
    v_pk_mul_f32 v[114:115], v[114:115], v[178:179]
    v_pk_mul_f32 v[118:119], v[118:119], v[182:183]
    v_pk_mul_f32 v[122:123], v[122:123], v[186:187]
    v_cvt_pk_bf16_f32 v208, v112, v113
    v_cvt_pk_bf16_f32 v210, v116, v117
    v_cvt_pk_bf16_f32 v220, v120, v121
    v_cvt_pk_bf16_f32 v209, v114, v115
    v_cvt_pk_bf16_f32 v211, v118, v119
    v_cvt_pk_bf16_f32 v221, v122, v123
    buffer_store_dwordx4 v[208:211], v52, s[32:35], 0 offen offset:512 sc1
    v_pk_fma_f32 v[136:137], v[12:13], v[172:173], v[136:137] op_sel_hi:[1,0,1]
    v_pk_fma_f32 v[140:141], v[16:17], v[172:173], v[140:141] op_sel_hi:[1,0,1]
    v_pk_fma_f32 v[144:145], v[20:21], v[172:173], v[144:145] op_sel_hi:[1,0,1]
L_pad7:
    s_cbranch_execz L_pad8
    s_nop 0
    v_pk_fma_f32 v[138:139], v[14:15], v[172:173], v[138:139] op_sel_hi:[1,0,1]
    v_pk_fma_f32 v[142:143], v[18:19], v[172:173], v[142:143] op_sel_hi:[1,0,1]
    v_pk_fma_f32 v[146:147], v[22:23], v[172:173], v[146:147] op_sel_hi:[1,0,1]
    v_pk_mul_f32 v[176:177], v[136:137], v[172:173] op_sel:[0,1] op_sel_hi:[1,1]
    v_pk_mul_f32 v[180:181], v[140:141], v[172:173] op_sel:[0,1] op_sel_hi:[1,1]
    v_pk_mul_f32 v[184:185], v[144:145], v[172:173] op_sel:[0,1] op_sel_hi:[1,1]
    v_pk_mul_f32 v[178:179], v[138:139], v[172:173] op_sel:[0,1] op_sel_hi:[1,1]
    v_pk_mul_f32 v[182:183], v[142:143], v[172:173] op_sel:[0,1] op_sel_hi:[1,1]
    v_pk_mul_f32 v[186:187], v[146:147], v[172:173] op_sel:[0,1] op_sel_hi:[1,1]
    v_exp_f32 v176, v176
    v_exp_f32 v180, v180
    v_exp_f32 v184, v184
    v_exp_f32 v177, v177
    v_exp_f32 v181, v181
    v_exp_f32 v185, v185
    v_exp_f32 v178, v178
    v_exp_f32 v182, v182
    v_exp_f32 v186, v186
    v_exp_f32 v179, v179
    v_exp_f32 v183, v183
    v_exp_f32 v187, v187
    v_pk_fma_f32 v[148:149], v[24:25], v[172:173], v[148:149] op_sel_hi:[1,0,1]
    v_pk_fma_f32 v[152:153], v[28:29], v[172:173], v[152:153] op_sel_hi:[1,0,1]
    v_pk_fma_f32 v[156:157], v[32:33], v[172:173], v[156:157] op_sel_hi:[1,0,1]
    v_pk_fma_f32 v[150:151], v[26:27], v[172:173], v[150:151] op_sel_hi:[1,0,1]
    v_pk_fma_f32 v[154:155], v[30:31], v[172:173], v[154:155] op_sel_hi:[1,0,1]
    v_pk_fma_f32 v[158:159], v[34:35], v[172:173], v[158:159] op_sel_hi:[1,0,1]
    v_pk_fma_f32 v[176:177], v[176:177], v[174:175], v[174:175] op_sel_hi:[1,0,0]
    v_pk_fma_f32 v[180:181], v[180:181], v[174:175], v[174:175] op_sel_hi:[1,0,0]
    v_pk_fma_f32 v[184:185], v[184:185], v[174:175], v[174:175] op_sel_hi:[1,0,0]
    v_pk_fma_f32 v[178:179], v[178:179], v[174:175], v[174:175] op_sel_hi:[1,0,0]
    v_pk_fma_f32 v[182:183], v[182:183], v[174:175], v[174:175] op_sel_hi:[1,0,0]
    v_pk_fma_f32 v[186:187], v[186:187], v[174:175], v[174:175] op_sel_hi:[1,0,0]
    v_pk_mul_f32 v[136:137], v[136:137], v[148:149]
    v_pk_mul_f32 v[140:141], v[140:141], v[152:153]
    v_pk_mul_f32 v[144:145], v[144:145], v[156:157]
    v_pk_mul_f32 v[138:139], v[138:139], v[150:151]
    v_pk_mul_f32 v[142:143], v[142:143], v[154:155]
    v_pk_mul_f32 v[146:147], v[146:147], v[158:159]
    v_rcp_f32 v176, v176
    v_rcp_f32 v180, v180
    v_rcp_f32 v184, v184
    v_rcp_f32 v177, v177
    v_rcp_f32 v181, v181
    v_rcp_f32 v185, v185
    v_rcp_f32 v178, v178
    v_rcp_f32 v182, v182
    v_rcp_f32 v186, v186
    v_rcp_f32 v179, v179
    v_rcp_f32 v183, v183
    v_rcp_f32 v187, v187
    v_pk_mul_f32 v[136:137], v[136:137], v[176:177]
    v_pk_mul_f32 v[140:141], v[140:141], v[180:181]
    v_pk_mul_f32 v[144:145], v[144:145], v[184:185]
    v_pk_mul_f32 v[138:139], v[138:139], v[178:179]
    v_pk_mul_f32 v[142:143], v[142:143], v[182:183]
    v_pk_mul_f32 v[146:147], v[146:147], v[186:187]
    v_cvt_pk_bf16_f32 v212, v136, v137
    v_cvt_pk_bf16_f32 v214, v140, v141
    v_cvt_pk_bf16_f32 v222, v144, v145
    v_cvt_pk_bf16_f32 v213, v138, v139
    v_cvt_pk_bf16_f32 v215, v142, v143
    v_cvt_pk_bf16_f32 v223, v146, v147
    buffer_store_dwordx4 v[212:215], v52, s[32:35], 0 offen offset:768 sc1
    v_permlane16_swap_b32 v220, v222
    v_permlane16_swap_b32 v221, v223
    buffer_store_dwordx4 v[220:223], v53, s[32:35], 0 offen offset:512 sc1
    v_mov_b32 v60, 1
    s_add_u32 s48, s55, s40
    s_cmp_eq_u32 s47, 0
    s_mov_b64 exec, 1
    s_waitcnt vmcnt(0)
    s_cbranch_scc1 L_sigf_30
    buffer_wbl2 sc1
    s_waitcnt vmcnt(0)
    buffer_store_byte v60, off, s[32:35], s48 offset:768 sc1
    s_branch L_sigd_31
L_sigf_30:
    buffer_store_byte v60, off, s[32:35], s48 offset:768
L_sigd_31:
    s_mov_b64 exec, -1
    s_cmp_ge_u32 s42, 30
    s_cbranch_scc1 L_fin
    v_lshlrev_b32 v64, 16, v240
    v_and_b32 v65, 0xffff0000, v240
    v_lshlrev_b32_e64 v66, 16, v241
    v_and_b32 v67, 0xffff0000, v241
    v_lshlrev_b32_e64 v68, 16, v242
    v_and_b32 v69, 0xffff0000, v242
    v_lshlrev_b32_e64 v70, 16, v243
    v_and_b32 v71, 0xffff0000, v243
    v_lshlrev_b32_e64 v72, 16, v244
    v_and_b32 v73, 0xffff0000, v244
    v_lshlrev_b32_e64 v74, 16, v245
    v_and_b32 v75, 0xffff0000, v245
    v_lshlrev_b32_e64 v76, 16, v246
    v_and_b32 v77, 0xffff0000, v246
    v_lshlrev_b32_e64 v78, 16, v247
    v_and_b32 v79, 0xffff0000, v247
    v_lshlrev_b32_e64 v80, 16, v248
    v_and_b32 v81, 0xffff0000, v248
    v_lshlrev_b32_e64 v82, 16, v249
    v_and_b32 v83, 0xffff0000, v249
    v_lshlrev_b32_e64 v84, 16, v250
    v_and_b32 v85, 0xffff0000, v250
    v_lshlrev_b32_e64 v86, 16, v251
    v_and_b32 v87, 0xffff0000, v251
    v_add_u32 v44, 16384, v44
    v_lshrrev_b32 v56, 2, v1
    v_and_b32 v55, 3, v1
    s_lshl_b32 s48, s44, 7
    s_lshl_b32 s49, s64, 6
    s_add_u32 s48, s48, s49
    v_lshl_add_u32 v54, v55, 4, s48
    v_mov_b32 v60, 0x80000000
    s_sub_u32 s49, s67, 1
    s_movk_i32 s50, 1280
    s_add_u32 s48, s66, 0
    v_add_u32 v57, s48, v56
    v_lshlrev_b32 v58, 1, v57
    v_subrev_u32 v59, s49, v58
    v_cmp_gt_u32 vcc, s54, v57
    s_nop 1
    v_cndmask_b32 v58, v59, v58, vcc
    v_add_u32_e64 v58, s62, v58
    v_mad_u32_u24 v58, v58, s50, v54
    v_cmp_gt_u32 vcc, s67, v57
    s_nop 1
    v_cndmask_b32 v46, v60, v58, vcc
    s_add_u32 s48, s66, 16
    v_add_u32 v57, s48, v56
    v_lshlrev_b32 v58, 1, v57
    v_subrev_u32 v59, s49, v58
    v_cmp_gt_u32 vcc, s54, v57
    s_nop 1
    v_cndmask_b32 v58, v59, v58, vcc
    v_add_u32_e64 v58, s62, v58
    v_mad_u32_u24 v58, v58, s50, v54
    v_cmp_gt_u32 vcc, s67, v57
    s_nop 1
    v_cndmask_b32 v47, v60, v58, vcc
    s_add_u32 s48, s66, 32
    v_add_u32 v57, s48, v56
    v_lshlrev_b32 v58, 1, v57
    v_subrev_u32 v59, s49, v58
    v_cmp_gt_u32 vcc, s54, v57
    s_nop 1
    v_cndmask_b32 v58, v59, v58, vcc
    v_add_u32_e64 v58, s62, v58
    v_mad_u32_u24 v58, v58, s50, v54
    v_cmp_gt_u32 vcc, s67, v57
    s_nop 1
    v_cndmask_b32_e64 v48, v60, v58, vcc
    s_mul_i32 s48, s40, 1280
    s_add_u32 s48, s48, 158720
    s_movk_i32 s49, 80
    v_lshl_add_u32 v57, v3, 3, s48
    v_mad_u32_u24 v49, v2, s49, v57
    v_lshl_add_u32 v57, v55, 4, s48
    v_mad_u32_u24 v50, v56, s49, v57
    s_barrier
    s_barrier
    s_nop 0
    ds_read_b64_tr_b16 v[100:101], v40 offset:0
    ds_read_b64_tr_b16 v[102:103], v40 offset:512
    ds_read_b64_tr_b16 v[104:105], v41 offset:0
    ds_read_b64_tr_b16 v[106:107], v41 offset:512
    ds_read_b128 v[88:91], v44 offset:0
    ds_read_b128 v[92:95], v44 offset:256
    ds_read_b128 v[96:99], v44 offset:512
    ds_read_b64_tr_b16 v[120:121], v40 offset:4096
    ds_read_b64_tr_b16 v[122:123], v40 offset:4608
    ds_read_b64_tr_b16 v[124:125], v41 offset:4096
    ds_read_b64_tr_b16 v[126:127], v41 offset:4608
    ds_read_b128 v[108:111], v44 offset:1408
    ds_read_b128 v[112:115], v44 offset:1664
    ds_read_b128 v[116:119], v44 offset:1920
    s_barrier
    s_waitcnt lgkmcnt(7)
    v_mfma_f32_16x16x32_bf16 v[64:67], v[100:103], v[88:91], v[64:67]
    ds_read_b64_tr_b16 v[140:141], v40 offset:8192
    ds_read_b64_tr_b16 v[142:143], v40 offset:8704
    v_mfma_f32_16x16x32_bf16 v[68:71], v[104:107], v[88:91], v[68:71]
    ds_read_b64_tr_b16 v[144:145], v41 offset:8192
    v_mfma_f32_16x16x32_bf16 v[72:75], v[100:103], v[92:95], v[72:75]
    ds_read_b64_tr_b16 v[146:147], v41 offset:8704
    v_mfma_f32_16x16x32_bf16 v[76:79], v[104:107], v[92:95], v[76:79]
    ds_read_b128 v[128:131], v44 offset:11264
    v_mfma_f32_16x16x32_bf16 v[80:83], v[100:103], v[96:99], v[80:83]
    ds_read_b128 v[132:135], v44 offset:11520
    v_mfma_f32_16x16x32_bf16 v[84:87], v[104:107], v[96:99], v[84:87]
    ds_read_b128 v[136:139], v44 offset:11776
    s_waitcnt lgkmcnt(7)
    s_nop 0
    v_mfma_f32_16x16x32_bf16 v[64:67], v[120:123], v[108:111], v[64:67]
    ds_read_b64_tr_b16 v[160:161], v40 offset:12288
    ds_read_b64_tr_b16 v[162:163], v40 offset:12800
    v_mfma_f32_16x16x32_bf16 v[68:71], v[124:127], v[108:111], v[68:71]
    ds_read_b64_tr_b16 v[164:165], v41 offset:12288
    v_mfma_f32_16x16x32_bf16 v[72:75], v[120:123], v[112:115], v[72:75]
    ds_read_b64_tr_b16 v[166:167], v41 offset:12800
    v_mfma_f32_16x16x32_bf16 v[76:79], v[124:127], v[112:115], v[76:79]
    ds_read_b128 v[148:151], v44 offset:12672
    v_mfma_f32_16x16x32_bf16 v[80:83], v[120:123], v[116:119], v[80:83]
    ds_read_b128 v[152:155], v44 offset:12928
    v_mfma_f32_16x16x32_bf16 v[84:87], v[124:127], v[116:119], v[84:87]
    ds_read_b128 v[156:159], v44 offset:13184
    s_barrier
    s_waitcnt lgkmcnt(7)
    v_mfma_f32_16x16x32_bf16 v[64:67], v[140:143], v[128:131], v[64:67]
    ds_read_b64_tr_b16 v[100:101], v40 offset:16384
    ds_read_b64_tr_b16 v[102:103], v40 offset:16896
    v_mfma_f32_16x16x32_bf16 v[68:71], v[144:147], v[128:131], v[68:71]
    ds_read_b64_tr_b16 v[104:105], v41 offset:16384
    v_mfma_f32_16x16x32_bf16 v[72:75], v[140:143], v[132:135], v[72:75]
    ds_read_b64_tr_b16 v[106:107], v41 offset:16896
    v_mfma_f32_16x16x32_bf16 v[76:79], v[144:147], v[132:135], v[76:79]
    ds_read_b128 v[88:91], v44 offset:22528
    v_mfma_f32_16x16x32_bf16 v[80:83], v[140:143], v[136:139], v[80:83]
    ds_read_b128 v[92:95], v44 offset:22784
    v_mfma_f32_16x16x32_bf16 v[84:87], v[144:147], v[136:139], v[84:87]
    ds_read_b128 v[96:99], v44 offset:23040
    s_waitcnt lgkmcnt(7)
    s_nop 0
    v_mfma_f32_16x16x32_bf16 v[64:67], v[160:163], v[148:151], v[64:67]
    ds_read_b64_tr_b16 v[120:121], v40 offset:20480
    ds_read_b64_tr_b16 v[122:123], v40 offset:20992
    v_mfma_f32_16x16x32_bf16 v[68:71], v[164:167], v[148:151], v[68:71]
    ds_read_b64_tr_b16 v[124:125], v41 offset:20480
    v_mfma_f32_16x16x32_bf16 v[72:75], v[160:163], v[152:155], v[72:75]
    ds_read_b64_tr_b16 v[126:127], v41 offset:20992
    v_mfma_f32_16x16x32_bf16 v[76:79], v[164:167], v[152:155], v[76:79]
    ds_read_b128 v[108:111], v44 offset:23936
    v_mfma_f32_16x16x32_bf16 v[80:83], v[160:163], v[156:159], v[80:83]
    ds_read_b128 v[112:115], v44 offset:24192
    v_mfma_f32_16x16x32_bf16 v[84:87], v[164:167], v[156:159], v[84:87]
    ds_read_b128 v[116:119], v44 offset:24448
    s_barrier
    s_waitcnt lgkmcnt(7)
    v_mfma_f32_16x16x32_bf16 v[64:67], v[100:103], v[88:91], v[64:67]
    ds_read_b64_tr_b16 v[140:141], v40 offset:24576
    ds_read_b64_tr_b16 v[142:143], v40 offset:25088
    v_mfma_f32_16x16x32_bf16 v[68:71], v[104:107], v[88:91], v[68:71]
    ds_read_b64_tr_b16 v[144:145], v41 offset:24576
    v_mfma_f32_16x16x32_bf16 v[72:75], v[100:103], v[92:95], v[72:75]
    ds_read_b64_tr_b16 v[146:147], v41 offset:25088
    v_mfma_f32_16x16x32_bf16 v[76:79], v[104:107], v[92:95], v[76:79]
    ds_read_b128 v[128:131], v44 offset:33792
    v_mfma_f32_16x16x32_bf16 v[80:83], v[100:103], v[96:99], v[80:83]
    ds_read_b128 v[132:135], v44 offset:34048
    v_mfma_f32_16x16x32_bf16 v[84:87], v[104:107], v[96:99], v[84:87]
    ds_read_b128 v[136:139], v44 offset:34304
    s_waitcnt lgkmcnt(7)
    s_nop 0
    v_mfma_f32_16x16x32_bf16 v[64:67], v[120:123], v[108:111], v[64:67]
    ds_read_b64_tr_b16 v[160:161], v40 offset:28672
    ds_read_b64_tr_b16 v[162:163], v40 offset:29184
    v_mfma_f32_16x16x32_bf16 v[68:71], v[124:127], v[108:111], v[68:71]
    ds_read_b64_tr_b16 v[164:165], v41 offset:28672
    v_mfma_f32_16x16x32_bf16 v[72:75], v[120:123], v[112:115], v[72:75]
    ds_read_b64_tr_b16 v[166:167], v41 offset:29184
    v_mfma_f32_16x16x32_bf16 v[76:79], v[124:127], v[112:115], v[76:79]
    ds_read_b128 v[148:151], v44 offset:35200
    v_mfma_f32_16x16x32_bf16 v[80:83], v[120:123], v[116:119], v[80:83]
    ds_read_b128 v[152:155], v44 offset:35456
    v_mfma_f32_16x16x32_bf16 v[84:87], v[124:127], v[116:119], v[84:87]
    ds_read_b128 v[156:159], v44 offset:35712
    s_barrier
    s_waitcnt lgkmcnt(7)
    v_mfma_f32_16x16x32_bf16 v[64:67], v[140:143], v[128:131], v[64:67]
    ds_read_b64_tr_b16 v[100:101], v40 offset:32768
    ds_read_b64_tr_b16 v[102:103], v40 offset:33280
    v_mfma_f32_16x16x32_bf16 v[68:71], v[144:147], v[128:131], v[68:71]
    ds_read_b64_tr_b16 v[104:105], v41 offset:32768
    v_mfma_f32_16x16x32_bf16 v[72:75], v[140:143], v[132:135], v[72:75]
    ds_read_b64_tr_b16 v[106:107], v41 offset:33280
    v_mfma_f32_16x16x32_bf16 v[76:79], v[144:147], v[132:135], v[76:79]
    ds_read_b128 v[88:91], v44 offset:45056
    v_mfma_f32_16x16x32_bf16 v[80:83], v[140:143], v[136:139], v[80:83]
    ds_read_b128 v[92:95], v44 offset:45312
    v_mfma_f32_16x16x32_bf16 v[84:87], v[144:147], v[136:139], v[84:87]
    ds_read_b128 v[96:99], v44 offset:45568
    s_waitcnt lgkmcnt(7)
    s_nop 0
    v_mfma_f32_16x16x32_bf16 v[64:67], v[160:163], v[148:151], v[64:67]
    ds_read_b64_tr_b16 v[120:121], v40 offset:36864
    ds_read_b64_tr_b16 v[122:123], v40 offset:37376
    v_mfma_f32_16x16x32_bf16 v[68:71], v[164:167], v[148:151], v[68:71]
    ds_read_b64_tr_b16 v[124:125], v41 offset:36864
    v_mfma_f32_16x16x32_bf16 v[72:75], v[160:163], v[152:155], v[72:75]
    ds_read_b64_tr_b16 v[126:127], v41 offset:37376
    v_mfma_f32_16x16x32_bf16 v[76:79], v[164:167], v[152:155], v[76:79]
    ds_read_b128 v[108:111], v44 offset:46464
    v_mfma_f32_16x16x32_bf16 v[80:83], v[160:163], v[156:159], v[80:83]
    ds_read_b128 v[112:115], v44 offset:46720
    v_mfma_f32_16x16x32_bf16 v[84:87], v[164:167], v[156:159], v[84:87]
    ds_read_b128 v[116:119], v44 offset:46976
    s_barrier
    s_waitcnt lgkmcnt(7)
    v_mfma_f32_16x16x32_bf16 v[64:67], v[100:103], v[88:91], v[64:67]
    ds_read_b64_tr_b16 v[140:141], v40 offset:40960
    ds_read_b64_tr_b16 v[142:143], v40 offset:41472
    v_mfma_f32_16x16x32_bf16 v[68:71], v[104:107], v[88:91], v[68:71]
    ds_read_b64_tr_b16 v[144:145], v41 offset:40960
    v_mfma_f32_16x16x32_bf16 v[72:75], v[100:103], v[92:95], v[72:75]
    ds_read_b64_tr_b16 v[146:147], v41 offset:41472
    v_mfma_f32_16x16x32_bf16 v[76:79], v[104:107], v[92:95], v[76:79]
    ds_read_b128 v[128:131], v44 offset:56320
    v_mfma_f32_16x16x32_bf16 v[80:83], v[100:103], v[96:99], v[80:83]
    ds_read_b128 v[132:135], v44 offset:56576
    v_mfma_f32_16x16x32_bf16 v[84:87], v[104:107], v[96:99], v[84:87]
    ds_read_b128 v[136:139], v44 offset:56832
    s_waitcnt lgkmcnt(7)
    s_nop 0
    v_mfma_f32_16x16x32_bf16 v[64:67], v[120:123], v[108:111], v[64:67]
    ds_read_b64_tr_b16 v[160:161], v40 offset:45056
    ds_read_b64_tr_b16 v[162:163], v40 offset:45568
    v_mfma_f32_16x16x32_bf16 v[68:71], v[124:127], v[108:111], v[68:71]
    ds_read_b64_tr_b16 v[164:165], v41 offset:45056
    v_mfma_f32_16x16x32_bf16 v[72:75], v[120:123], v[112:115], v[72:75]
    ds_read_b64_tr_b16 v[166:167], v41 offset:45568
    v_mfma_f32_16x16x32_bf16 v[76:79], v[124:127], v[112:115], v[76:79]
    ds_read_b128 v[148:151], v44 offset:57728
    v_mfma_f32_16x16x32_bf16 v[80:83], v[120:123], v[116:119], v[80:83]
    ds_read_b128 v[152:155], v44 offset:57984
    v_mfma_f32_16x16x32_bf16 v[84:87], v[124:127], v[116:119], v[84:87]
    ds_read_b128 v[156:159], v44 offset:58240
    s_barrier
    s_waitcnt lgkmcnt(7)
    v_mfma_f32_16x16x32_bf16 v[64:67], v[140:143], v[128:131], v[64:67]
    ds_read_b64_tr_b16 v[100:101], v42 offset:24576
    ds_read_b64_tr_b16 v[102:103], v42 offset:25088
    v_mfma_f32_16x16x32_bf16 v[68:71], v[144:147], v[128:131], v[68:71]
    ds_read_b64_tr_b16 v[104:105], v43 offset:24576
    v_mfma_f32_16x16x32_bf16 v[72:75], v[140:143], v[132:135], v[72:75]
    ds_read_b64_tr_b16 v[106:107], v43 offset:25088
    v_mfma_f32_16x16x32_bf16 v[76:79], v[144:147], v[132:135], v[76:79]
    ds_read_b128 v[88:91], v44 offset:0
    v_mfma_f32_16x16x32_bf16 v[80:83], v[140:143], v[136:139], v[80:83]
    ds_read_b128 v[92:95], v44 offset:256
    v_mfma_f32_16x16x32_bf16 v[84:87], v[144:147], v[136:139], v[84:87]
    ds_read_b128 v[96:99], v44 offset:512
    s_waitcnt lgkmcnt(7)
    s_nop 0
    v_mfma_f32_16x16x32_bf16 v[64:67], v[160:163], v[148:151], v[64:67]
    ds_read_b64_tr_b16 v[120:121], v42 offset:28672
    ds_read_b64_tr_b16 v[122:123], v42 offset:29184
    v_mfma_f32_16x16x32_bf16 v[68:71], v[164:167], v[148:151], v[68:71]
    ds_read_b64_tr_b16 v[124:125], v43 offset:28672
    v_mfma_f32_16x16x32_bf16 v[72:75], v[160:163], v[152:155], v[72:75]
    ds_read_b64_tr_b16 v[126:127], v43 offset:29184
    v_mfma_f32_16x16x32_bf16 v[76:79], v[164:167], v[152:155], v[76:79]
    ds_read_b128 v[108:111], v44 offset:1408
    v_mfma_f32_16x16x32_bf16 v[80:83], v[160:163], v[156:159], v[80:83]
    ds_read_b128 v[112:115], v44 offset:1664
    v_mfma_f32_16x16x32_bf16 v[84:87], v[164:167], v[156:159], v[84:87]
    ds_read_b128 v[116:119], v44 offset:1920
    s_barrier
    s_waitcnt lgkmcnt(7)
    v_mfma_f32_16x16x32_bf16 v[64:67], v[100:103], v[88:91], v[64:67]
    ds_read_b64_tr_b16 v[140:141], v42 offset:32768
    ds_read_b64_tr_b16 v[142:143], v42 offset:33280
    v_mfma_f32_16x16x32_bf16 v[68:71], v[104:107], v[88:91], v[68:71]
    ds_read_b64_tr_b16 v[144:145], v43 offset:32768
    v_mfma_f32_16x16x32_bf16 v[72:75], v[100:103], v[92:95], v[72:75]
    ds_read_b64_tr_b16 v[146:147], v43 offset:33280
    v_mfma_f32_16x16x32_bf16 v[76:79], v[104:107], v[92:95], v[76:79]
    ds_read_b128 v[128:131], v44 offset:11264
    v_mfma_f32_16x16x32_bf16 v[80:83], v[100:103], v[96:99], v[80:83]
    ds_read_b128 v[132:135], v44 offset:11520
    v_mfma_f32_16x16x32_bf16 v[84:87], v[104:107], v[96:99], v[84:87]
    ds_read_b128 v[136:139], v44 offset:11776
    s_waitcnt lgkmcnt(7)
    s_nop 0
    v_mfma_f32_16x16x32_bf16 v[64:67], v[120:123], v[108:111], v[64:67]
    ds_read_b64_tr_b16 v[160:161], v42 offset:36864
    ds_read_b64_tr_b16 v[162:163], v42 offset:37376
    v_mfma_f32_16x16x32_bf16 v[68:71], v[124:127], v[108:111], v[68:71]
    ds_read_b64_tr_b16 v[164:165], v43 offset:36864
    v_mfma_f32_16x16x32_bf16 v[72:75], v[120:123], v[112:115], v[72:75]
    ds_read_b64_tr_b16 v[166:167], v43 offset:37376
    v_mfma_f32_16x16x32_bf16 v[76:79], v[124:127], v[112:115], v[76:79]
    ds_read_b128 v[148:151], v44 offset:12672
    v_mfma_f32_16x16x32_bf16 v[80:83], v[120:123], v[116:119], v[80:83]
    ds_read_b128 v[152:155], v44 offset:12928
    v_mfma_f32_16x16x32_bf16 v[84:87], v[124:127], v[116:119], v[84:87]
    ds_read_b128 v[156:159], v44 offset:13184
    s_barrier
    s_waitcnt lgkmcnt(7)
    v_mfma_f32_16x16x32_bf16 v[64:67], v[140:143], v[128:131], v[64:67]
    ds_read_b64_tr_b16 v[100:101], v42 offset:40960
    ds_read_b64_tr_b16 v[102:103], v42 offset:41472
    v_mfma_f32_16x16x32_bf16 v[68:71], v[144:147], v[128:131], v[68:71]
    ds_read_b64_tr_b16 v[104:105], v43 offset:40960
    v_mfma_f32_16x16x32_bf16 v[72:75], v[140:143], v[132:135], v[72:75]
    ds_read_b64_tr_b16 v[106:107], v43 offset:41472
    v_mfma_f32_16x16x32_bf16 v[76:79], v[144:147], v[132:135], v[76:79]
    ds_read_b128 v[88:91], v44 offset:22528
    v_mfma_f32_16x16x32_bf16 v[80:83], v[140:143], v[136:139], v[80:83]
    ds_read_b128 v[92:95], v44 offset:22784
    v_mfma_f32_16x16x32_bf16 v[84:87], v[144:147], v[136:139], v[84:87]
    ds_read_b128 v[96:99], v44 offset:23040
    s_waitcnt lgkmcnt(7)
    s_nop 0
    v_mfma_f32_16x16x32_bf16 v[64:67], v[160:163], v[148:151], v[64:67]
    ds_read_b64_tr_b16 v[120:121], v42 offset:45056
    ds_read_b64_tr_b16 v[122:123], v42 offset:45568
    v_mfma_f32_16x16x32_bf16 v[68:71], v[164:167], v[148:151], v[68:71]
    ds_read_b64_tr_b16 v[124:125], v43 offset:45056
    v_mfma_f32_16x16x32_bf16 v[72:75], v[160:163], v[152:155], v[72:75]
    ds_read_b64_tr_b16 v[126:127], v43 offset:45568
    v_mfma_f32_16x16x32_bf16 v[76:79], v[164:167], v[152:155], v[76:79]
    ds_read_b128 v[108:111], v44 offset:23936
    v_mfma_f32_16x16x32_bf16 v[80:83], v[160:163], v[156:159], v[80:83]
    ds_read_b128 v[112:115], v44 offset:24192
    v_mfma_f32_16x16x32_bf16 v[84:87], v[164:167], v[156:159], v[84:87]
    ds_read_b128 v[116:119], v44 offset:24448
    s_barrier
    s_waitcnt lgkmcnt(7)
    v_mfma_f32_16x16x32_bf16 v[64:67], v[100:103], v[88:91], v[64:67]
    ds_read_b64_tr_b16 v[140:141], v42 offset:49152
    ds_read_b64_tr_b16 v[142:143], v42 offset:49664
    v_mfma_f32_16x16x32_bf16 v[68:71], v[104:107], v[88:91], v[68:71]
    ds_read_b64_tr_b16 v[144:145], v43 offset:49152
    v_mfma_f32_16x16x32_bf16 v[72:75], v[100:103], v[92:95], v[72:75]
    ds_read_b64_tr_b16 v[146:147], v43 offset:49664
    v_mfma_f32_16x16x32_bf16 v[76:79], v[104:107], v[92:95], v[76:79]
    ds_read_b128 v[128:131], v44 offset:33792
    v_mfma_f32_16x16x32_bf16 v[80:83], v[100:103], v[96:99], v[80:83]
    ds_read_b128 v[132:135], v44 offset:34048
    v_mfma_f32_16x16x32_bf16 v[84:87], v[104:107], v[96:99], v[84:87]
    ds_read_b128 v[136:139], v44 offset:34304
    s_waitcnt lgkmcnt(7)
    s_nop 0
    v_mfma_f32_16x16x32_bf16 v[64:67], v[120:123], v[108:111], v[64:67]
    ds_read_b64_tr_b16 v[160:161], v42 offset:53248
    ds_read_b64_tr_b16 v[162:163], v42 offset:53760
    v_mfma_f32_16x16x32_bf16 v[68:71], v[124:127], v[108:111], v[68:71]
    ds_read_b64_tr_b16 v[164:165], v43 offset:53248
    v_mfma_f32_16x16x32_bf16 v[72:75], v[120:123], v[112:115], v[72:75]
    ds_read_b64_tr_b16 v[166:167], v43 offset:53760
    v_mfma_f32_16x16x32_bf16 v[76:79], v[124:127], v[112:115], v[76:79]
    ds_read_b128 v[148:151], v44 offset:35200
    v_mfma_f32_16x16x32_bf16 v[80:83], v[120:123], v[116:119], v[80:83]
    ds_read_b128 v[152:155], v44 offset:35456
    v_mfma_f32_16x16x32_bf16 v[84:87], v[124:127], v[116:119], v[84:87]
    ds_read_b128 v[156:159], v44 offset:35712
    s_barrier
    s_waitcnt lgkmcnt(7)
    v_mfma_f32_16x16x32_bf16 v[64:67], v[140:143], v[128:131], v[64:67]
    ds_read_b64_tr_b16 v[100:101], v40 offset:0
    ds_read_b64_tr_b16 v[102:103], v40 offset:512
    v_mfma_f32_16x16x32_bf16 v[68:71], v[144:147], v[128:131], v[68:71]
    ds_read_b64_tr_b16 v[104:105], v41 offset:0
    v_mfma_f32_16x16x32_bf16 v[72:75], v[140:143], v[132:135], v[72:75]
    ds_read_b64_tr_b16 v[106:107], v41 offset:512
    v_mfma_f32_16x16x32_bf16 v[76:79], v[144:147], v[132:135], v[76:79]
    ds_read_b128 v[88:91], v44 offset:45056
    v_mfma_f32_16x16x32_bf16 v[80:83], v[140:143], v[136:139], v[80:83]
    ds_read_b128 v[92:95], v44 offset:45312
    v_mfma_f32_16x16x32_bf16 v[84:87], v[144:147], v[136:139], v[84:87]
    ds_read_b128 v[96:99], v44 offset:45568
    s_waitcnt lgkmcnt(7)
    s_nop 0
    v_mfma_f32_16x16x32_bf16 v[64:67], v[160:163], v[148:151], v[64:67]
    ds_read_b64_tr_b16 v[120:121], v40 offset:4096
    ds_read_b64_tr_b16 v[122:123], v40 offset:4608
    v_mfma_f32_16x16x32_bf16 v[68:71], v[164:167], v[148:151], v[68:71]
    ds_read_b64_tr_b16 v[124:125], v41 offset:4096
    v_mfma_f32_16x16x32_bf16 v[72:75], v[160:163], v[152:155], v[72:75]
    ds_read_b64_tr_b16 v[126:127], v41 offset:4608
    v_mfma_f32_16x16x32_bf16 v[76:79], v[164:167], v[152:155], v[76:79]
    ds_read_b128 v[108:111], v44 offset:46464
    v_mfma_f32_16x16x32_bf16 v[80:83], v[160:163], v[156:159], v[80:83]
    ds_read_b128 v[112:115], v44 offset:46720
    v_mfma_f32_16x16x32_bf16 v[84:87], v[164:167], v[156:159], v[84:87]
    ds_read_b128 v[116:119], v44 offset:46976
    s_barrier
    s_waitcnt lgkmcnt(7)
    v_mfma_f32_16x16x32_bf16 v[64:67], v[100:103], v[88:91], v[64:67]
    ds_read_b64_tr_b16 v[140:141], v40 offset:8192
    ds_read_b64_tr_b16 v[142:143], v40 offset:8704
    v_mfma_f32_16x16x32_bf16 v[68:71], v[104:107], v[88:91], v[68:71]
    ds_read_b64_tr_b16 v[144:145], v41 offset:8192
    v_mfma_f32_16x16x32_bf16 v[72:75], v[100:103], v[92:95], v[72:75]
    ds_read_b64_tr_b16 v[146:147], v41 offset:8704
    v_mfma_f32_16x16x32_bf16 v[76:79], v[104:107], v[92:95], v[76:79]
    ds_read_b128 v[128:131], v44 offset:56320
    v_mfma_f32_16x16x32_bf16 v[80:83], v[100:103], v[96:99], v[80:83]
    ds_read_b128 v[132:135], v44 offset:56576
    v_mfma_f32_16x16x32_bf16 v[84:87], v[104:107], v[96:99], v[84:87]
    ds_read_b128 v[136:139], v44 offset:56832
    s_waitcnt lgkmcnt(7)
    s_nop 0
    v_mfma_f32_16x16x32_bf16 v[64:67], v[120:123], v[108:111], v[64:67]
    ds_read_b64_tr_b16 v[160:161], v40 offset:12288
    ds_read_b64_tr_b16 v[162:163], v40 offset:12800
    v_mfma_f32_16x16x32_bf16 v[68:71], v[124:127], v[108:111], v[68:71]
    ds_read_b64_tr_b16 v[164:165], v41 offset:12288
    v_mfma_f32_16x16x32_bf16 v[72:75], v[120:123], v[112:115], v[72:75]
    ds_read_b64_tr_b16 v[166:167], v41 offset:12800
    v_mfma_f32_16x16x32_bf16 v[76:79], v[124:127], v[112:115], v[76:79]
    ds_read_b128 v[148:151], v44 offset:57728
    v_mfma_f32_16x16x32_bf16 v[80:83], v[120:123], v[116:119], v[80:83]
    ds_read_b128 v[152:155], v44 offset:57984
    v_mfma_f32_16x16x32_bf16 v[84:87], v[124:127], v[116:119], v[84:87]
    ds_read_b128 v[156:159], v44 offset:58240
    s_barrier
    s_waitcnt lgkmcnt(7)
    v_mfma_f32_16x16x32_bf16 v[64:67], v[140:143], v[128:131], v[64:67]
    ds_read_b64_tr_b16 v[100:101], v40 offset:16384
    ds_read_b64_tr_b16 v[102:103], v40 offset:16896
    v_mfma_f32_16x16x32_bf16 v[68:71], v[144:147], v[128:131], v[68:71]
    ds_read_b64_tr_b16 v[104:105], v41 offset:16384
    v_mfma_f32_16x16x32_bf16 v[72:75], v[140:143], v[132:135], v[72:75]
    ds_read_b64_tr_b16 v[106:107], v41 offset:16896
    v_mfma_f32_16x16x32_bf16 v[76:79], v[144:147], v[132:135], v[76:79]
    ds_read_b128 v[88:91], v44 offset:0
    v_mfma_f32_16x16x32_bf16 v[80:83], v[140:143], v[136:139], v[80:83]
    ds_read_b128 v[92:95], v44 offset:256
    v_mfma_f32_16x16x32_bf16 v[84:87], v[144:147], v[136:139], v[84:87]
    ds_read_b128 v[96:99], v44 offset:512
    s_waitcnt lgkmcnt(7)
    s_nop 0
    v_mfma_f32_16x16x32_bf16 v[64:67], v[160:163], v[148:151], v[64:67]
    ds_read_b64_tr_b16 v[120:121], v40 offset:20480
    ds_read_b64_tr_b16 v[122:123], v40 offset:20992
    v_mfma_f32_16x16x32_bf16 v[68:71], v[164:167], v[148:151], v[68:71]
    ds_read_b64_tr_b16 v[124:125], v41 offset:20480
    v_mfma_f32_16x16x32_bf16 v[72:75], v[160:163], v[152:155], v[72:75]
    ds_read_b64_tr_b16 v[126:127], v41 offset:20992
    v_mfma_f32_16x16x32_bf16 v[76:79], v[164:167], v[152:155], v[76:79]
    ds_read_b128 v[108:111], v44 offset:1408
    v_mfma_f32_16x16x32_bf16 v[80:83], v[160:163], v[156:159], v[80:83]
    ds_read_b128 v[112:115], v44 offset:1664
    v_mfma_f32_16x16x32_bf16 v[84:87], v[164:167], v[156:159], v[84:87]
    ds_read_b128 v[116:119], v44 offset:1920
    s_barrier
    s_waitcnt lgkmcnt(7)
    v_mfma_f32_16x16x32_bf16 v[64:67], v[100:103], v[88:91], v[64:67]
    ds_read_b64_tr_b16 v[140:141], v40 offset:24576
    ds_read_b64_tr_b16 v[142:143], v40 offset:25088
    v_mfma_f32_16x16x32_bf16 v[68:71], v[104:107], v[88:91], v[68:71]
    ds_read_b64_tr_b16 v[144:145], v41 offset:24576
    v_mfma_f32_16x16x32_bf16 v[72:75], v[100:103], v[92:95], v[72:75]
    ds_read_b64_tr_b16 v[146:147], v41 offset:25088
    v_mfma_f32_16x16x32_bf16 v[76:79], v[104:107], v[92:95], v[76:79]
    ds_read_b128 v[128:131], v44 offset:11264
    v_mfma_f32_16x16x32_bf16 v[80:83], v[100:103], v[96:99], v[80:83]
    ds_read_b128 v[132:135], v44 offset:11520
    v_mfma_f32_16x16x32_bf16 v[84:87], v[104:107], v[96:99], v[84:87]
    ds_read_b128 v[136:139], v44 offset:11776
    s_waitcnt lgkmcnt(7)
    s_nop 0
    v_mfma_f32_16x16x32_bf16 v[64:67], v[120:123], v[108:111], v[64:67]
    ds_read_b64_tr_b16 v[160:161], v40 offset:28672
    ds_read_b64_tr_b16 v[162:163], v40 offset:29184
    v_mfma_f32_16x16x32_bf16 v[68:71], v[124:127], v[108:111], v[68:71]
    ds_read_b64_tr_b16 v[164:165], v41 offset:28672
    v_mfma_f32_16x16x32_bf16 v[72:75], v[120:123], v[112:115], v[72:75]
    ds_read_b64_tr_b16 v[166:167], v41 offset:29184
    v_mfma_f32_16x16x32_bf16 v[76:79], v[124:127], v[112:115], v[76:79]
    ds_read_b128 v[148:151], v44 offset:12672
    v_mfma_f32_16x16x32_bf16 v[80:83], v[120:123], v[116:119], v[80:83]
    ds_read_b128 v[152:155], v44 offset:12928
    v_mfma_f32_16x16x32_bf16 v[84:87], v[124:127], v[116:119], v[84:87]
    ds_read_b128 v[156:159], v44 offset:13184
    s_barrier
    s_waitcnt lgkmcnt(7)
    v_mfma_f32_16x16x32_bf16 v[64:67], v[140:143], v[128:131], v[64:67]
    ds_read_b64_tr_b16 v[100:101], v40 offset:32768
    ds_read_b64_tr_b16 v[102:103], v40 offset:33280
    v_mfma_f32_16x16x32_bf16 v[68:71], v[144:147], v[128:131], v[68:71]
    ds_read_b64_tr_b16 v[104:105], v41 offset:32768
    v_mfma_f32_16x16x32_bf16 v[72:75], v[140:143], v[132:135], v[72:75]
    ds_read_b64_tr_b16 v[106:107], v41 offset:33280
    v_mfma_f32_16x16x32_bf16 v[76:79], v[144:147], v[132:135], v[76:79]
    ds_read_b128 v[88:91], v44 offset:22528
    v_mfma_f32_16x16x32_bf16 v[80:83], v[140:143], v[136:139], v[80:83]
L_pad8:
    s_cbranch_execz L_pad9
    ds_read_b128 v[92:95], v44 offset:22784
    v_mfma_f32_16x16x32_bf16 v[84:87], v[144:147], v[136:139], v[84:87]
    ds_read_b128 v[96:99], v44 offset:23040
    s_waitcnt lgkmcnt(7)
    s_nop 0
    v_mfma_f32_16x16x32_bf16 v[64:67], v[160:163], v[148:151], v[64:67]
    ds_read_b64_tr_b16 v[120:121], v40 offset:36864
    ds_read_b64_tr_b16 v[122:123], v40 offset:37376
    v_mfma_f32_16x16x32_bf16 v[68:71], v[164:167], v[148:151], v[68:71]
    ds_read_b64_tr_b16 v[124:125], v41 offset:36864
    v_mfma_f32_16x16x32_bf16 v[72:75], v[160:163], v[152:155], v[72:75]
    ds_read_b64_tr_b16 v[126:127], v41 offset:37376
    v_mfma_f32_16x16x32_bf16 v[76:79], v[164:167], v[152:155], v[76:79]
    ds_read_b128 v[108:111], v44 offset:23936
    v_mfma_f32_16x16x32_bf16 v[80:83], v[160:163], v[156:159], v[80:83]
    ds_read_b128 v[112:115], v44 offset:24192
    v_mfma_f32_16x16x32_bf16 v[84:87], v[164:167], v[156:159], v[84:87]
    ds_read_b128 v[116:119], v44 offset:24448
    s_barrier
    s_waitcnt lgkmcnt(7)
    v_mfma_f32_16x16x32_bf16 v[64:67], v[100:103], v[88:91], v[64:67]
    ds_read_b64_tr_b16 v[140:141], v40 offset:40960
    ds_read_b64_tr_b16 v[142:143], v40 offset:41472
    v_mfma_f32_16x16x32_bf16 v[68:71], v[104:107], v[88:91], v[68:71]
    ds_read_b64_tr_b16 v[144:145], v41 offset:40960
    v_mfma_f32_16x16x32_bf16 v[72:75], v[100:103], v[92:95], v[72:75]
    ds_read_b64_tr_b16 v[146:147], v41 offset:41472
    v_mfma_f32_16x16x32_bf16 v[76:79], v[104:107], v[92:95], v[76:79]
    ds_read_b128 v[128:131], v44 offset:33792
    v_mfma_f32_16x16x32_bf16 v[80:83], v[100:103], v[96:99], v[80:83]
    ds_read_b128 v[132:135], v44 offset:34048
    v_mfma_f32_16x16x32_bf16 v[84:87], v[104:107], v[96:99], v[84:87]
    ds_read_b128 v[136:139], v44 offset:34304
    s_waitcnt lgkmcnt(7)
    s_nop 0
    v_mfma_f32_16x16x32_bf16 v[64:67], v[120:123], v[108:111], v[64:67]
    ds_read_b64_tr_b16 v[160:161], v40 offset:45056
    ds_read_b64_tr_b16 v[162:163], v40 offset:45568
    v_mfma_f32_16x16x32_bf16 v[68:71], v[124:127], v[108:111], v[68:71]
    ds_read_b64_tr_b16 v[164:165], v41 offset:45056
    v_mfma_f32_16x16x32_bf16 v[72:75], v[120:123], v[112:115], v[72:75]
    ds_read_b64_tr_b16 v[166:167], v41 offset:45568
    v_mfma_f32_16x16x32_bf16 v[76:79], v[124:127], v[112:115], v[76:79]
    ds_read_b128 v[148:151], v44 offset:35200
    v_mfma_f32_16x16x32_bf16 v[80:83], v[120:123], v[116:119], v[80:83]
    ds_read_b128 v[152:155], v44 offset:35456
    v_mfma_f32_16x16x32_bf16 v[84:87], v[124:127], v[116:119], v[84:87]
    ds_read_b128 v[156:159], v44 offset:35712
    s_barrier
    s_waitcnt lgkmcnt(7)
    v_mfma_f32_16x16x32_bf16 v[64:67], v[140:143], v[128:131], v[64:67]
    ds_read_b64_tr_b16 v[100:101], v42 offset:24576
    ds_read_b64_tr_b16 v[102:103], v42 offset:25088
    v_mfma_f32_16x16x32_bf16 v[68:71], v[144:147], v[128:131], v[68:71]
    ds_read_b64_tr_b16 v[104:105], v43 offset:24576
    v_mfma_f32_16x16x32_bf16 v[72:75], v[140:143], v[132:135], v[72:75]
    ds_read_b64_tr_b16 v[106:107], v43 offset:25088
    v_mfma_f32_16x16x32_bf16 v[76:79], v[144:147], v[132:135], v[76:79]
    ds_read_b128 v[88:91], v44 offset:45056
    v_mfma_f32_16x16x32_bf16 v[80:83], v[140:143], v[136:139], v[80:83]
    ds_read_b128 v[92:95], v44 offset:45312
    v_mfma_f32_16x16x32_bf16 v[84:87], v[144:147], v[136:139], v[84:87]
    ds_read_b128 v[96:99], v44 offset:45568
    s_waitcnt lgkmcnt(7)
    s_nop 0
    v_mfma_f32_16x16x32_bf16 v[64:67], v[160:163], v[148:151], v[64:67]
    ds_read_b64_tr_b16 v[120:121], v42 offset:28672
    ds_read_b64_tr_b16 v[122:123], v42 offset:29184
    v_mfma_f32_16x16x32_bf16 v[68:71], v[164:167], v[148:151], v[68:71]
    ds_read_b64_tr_b16 v[124:125], v43 offset:28672
    v_mfma_f32_16x16x32_bf16 v[72:75], v[160:163], v[152:155], v[72:75]
    ds_read_b64_tr_b16 v[126:127], v43 offset:29184
    v_mfma_f32_16x16x32_bf16 v[76:79], v[164:167], v[152:155], v[76:79]
    ds_read_b128 v[108:111], v44 offset:46464
    v_mfma_f32_16x16x32_bf16 v[80:83], v[160:163], v[156:159], v[80:83]
    ds_read_b128 v[112:115], v44 offset:46720
    v_mfma_f32_16x16x32_bf16 v[84:87], v[164:167], v[156:159], v[84:87]
    ds_read_b128 v[116:119], v44 offset:46976
    s_barrier
    s_waitcnt lgkmcnt(7)
    v_mfma_f32_16x16x32_bf16 v[64:67], v[100:103], v[88:91], v[64:67]
    ds_read_b64_tr_b16 v[140:141], v42 offset:32768
    ds_read_b64_tr_b16 v[142:143], v42 offset:33280
    v_mfma_f32_16x16x32_bf16 v[68:71], v[104:107], v[88:91], v[68:71]
    ds_read_b64_tr_b16 v[144:145], v43 offset:32768
    v_mfma_f32_16x16x32_bf16 v[72:75], v[100:103], v[92:95], v[72:75]
    ds_read_b64_tr_b16 v[146:147], v43 offset:33280
    v_mfma_f32_16x16x32_bf16 v[76:79], v[104:107], v[92:95], v[76:79]
    ds_read_b128 v[128:131], v44 offset:56320
    v_mfma_f32_16x16x32_bf16 v[80:83], v[100:103], v[96:99], v[80:83]
    ds_read_b128 v[132:135], v44 offset:56576
    v_mfma_f32_16x16x32_bf16 v[84:87], v[104:107], v[96:99], v[84:87]
    ds_read_b128 v[136:139], v44 offset:56832
    s_waitcnt lgkmcnt(7)
    s_nop 0
    v_mfma_f32_16x16x32_bf16 v[64:67], v[120:123], v[108:111], v[64:67]
    ds_read_b64_tr_b16 v[160:161], v42 offset:36864
    ds_read_b64_tr_b16 v[162:163], v42 offset:37376
    v_mfma_f32_16x16x32_bf16 v[68:71], v[124:127], v[108:111], v[68:71]
    ds_read_b64_tr_b16 v[164:165], v43 offset:36864
    v_mfma_f32_16x16x32_bf16 v[72:75], v[120:123], v[112:115], v[72:75]
    ds_read_b64_tr_b16 v[166:167], v43 offset:37376
    v_mfma_f32_16x16x32_bf16 v[76:79], v[124:127], v[112:115], v[76:79]
    ds_read_b128 v[148:151], v44 offset:57728
    v_mfma_f32_16x16x32_bf16 v[80:83], v[120:123], v[116:119], v[80:83]
    ds_read_b128 v[152:155], v44 offset:57984
    v_mfma_f32_16x16x32_bf16 v[84:87], v[124:127], v[116:119], v[84:87]
    ds_read_b128 v[156:159], v44 offset:58240
    s_barrier
    s_waitcnt lgkmcnt(7)
    v_mfma_f32_16x16x32_bf16 v[64:67], v[140:143], v[128:131], v[64:67]
    ds_read_b64_tr_b16 v[100:101], v42 offset:40960
    ds_read_b64_tr_b16 v[102:103], v42 offset:41472
    v_mfma_f32_16x16x32_bf16 v[68:71], v[144:147], v[128:131], v[68:71]
    ds_read_b64_tr_b16 v[104:105], v43 offset:40960
    v_mfma_f32_16x16x32_bf16 v[72:75], v[140:143], v[132:135], v[72:75]
    ds_read_b64_tr_b16 v[106:107], v43 offset:41472
    v_mfma_f32_16x16x32_bf16 v[76:79], v[144:147], v[132:135], v[76:79]
    ds_read_b128 v[88:91], v44 offset:0
    v_mfma_f32_16x16x32_bf16 v[80:83], v[140:143], v[136:139], v[80:83]
    ds_read_b128 v[92:95], v44 offset:256
    v_mfma_f32_16x16x32_bf16 v[84:87], v[144:147], v[136:139], v[84:87]
    ds_read_b128 v[96:99], v44 offset:512
    s_waitcnt lgkmcnt(7)
    s_nop 0
    v_mfma_f32_16x16x32_bf16 v[64:67], v[160:163], v[148:151], v[64:67]
    ds_read_b64_tr_b16 v[120:121], v42 offset:45056
    ds_read_b64_tr_b16 v[122:123], v42 offset:45568
    v_mfma_f32_16x16x32_bf16 v[68:71], v[164:167], v[148:151], v[68:71]
    ds_read_b64_tr_b16 v[124:125], v43 offset:45056
    v_mfma_f32_16x16x32_bf16 v[72:75], v[160:163], v[152:155], v[72:75]
    ds_read_b64_tr_b16 v[126:127], v43 offset:45568
    v_mfma_f32_16x16x32_bf16 v[76:79], v[164:167], v[152:155], v[76:79]
    ds_read_b128 v[108:111], v44 offset:1408
    v_mfma_f32_16x16x32_bf16 v[80:83], v[160:163], v[156:159], v[80:83]
    ds_read_b128 v[112:115], v44 offset:1664
    v_mfma_f32_16x16x32_bf16 v[84:87], v[164:167], v[156:159], v[84:87]
    ds_read_b128 v[116:119], v44 offset:1920
    s_barrier
    s_waitcnt lgkmcnt(7)
    v_mfma_f32_16x16x32_bf16 v[64:67], v[100:103], v[88:91], v[64:67]
    ds_read_b64_tr_b16 v[140:141], v42 offset:49152
    ds_read_b64_tr_b16 v[142:143], v42 offset:49664
    v_mfma_f32_16x16x32_bf16 v[68:71], v[104:107], v[88:91], v[68:71]
    ds_read_b64_tr_b16 v[144:145], v43 offset:49152
    v_mfma_f32_16x16x32_bf16 v[72:75], v[100:103], v[92:95], v[72:75]
    ds_read_b64_tr_b16 v[146:147], v43 offset:49664
    v_mfma_f32_16x16x32_bf16 v[76:79], v[104:107], v[92:95], v[76:79]
    ds_read_b128 v[128:131], v44 offset:11264
    v_mfma_f32_16x16x32_bf16 v[80:83], v[100:103], v[96:99], v[80:83]
    ds_read_b128 v[132:135], v44 offset:11520
    v_mfma_f32_16x16x32_bf16 v[84:87], v[104:107], v[96:99], v[84:87]
    ds_read_b128 v[136:139], v44 offset:11776
    s_waitcnt lgkmcnt(7)
    s_nop 0
    v_mfma_f32_16x16x32_bf16 v[64:67], v[120:123], v[108:111], v[64:67]
    ds_read_b64_tr_b16 v[160:161], v42 offset:53248
    ds_read_b64_tr_b16 v[162:163], v42 offset:53760
    v_mfma_f32_16x16x32_bf16 v[68:71], v[124:127], v[108:111], v[68:71]
    ds_read_b64_tr_b16 v[164:165], v43 offset:53248
    v_mfma_f32_16x16x32_bf16 v[72:75], v[120:123], v[112:115], v[72:75]
    ds_read_b64_tr_b16 v[166:167], v43 offset:53760
    v_mfma_f32_16x16x32_bf16 v[76:79], v[124:127], v[112:115], v[76:79]
    ds_read_b128 v[148:151], v44 offset:12672
    v_mfma_f32_16x16x32_bf16 v[80:83], v[120:123], v[116:119], v[80:83]
    ds_read_b128 v[152:155], v44 offset:12928
    v_mfma_f32_16x16x32_bf16 v[84:87], v[124:127], v[116:119], v[84:87]
    ds_read_b128 v[156:159], v44 offset:13184
    s_barrier
    s_waitcnt lgkmcnt(7)
    v_mfma_f32_16x16x32_bf16 v[64:67], v[140:143], v[128:131], v[64:67]
    ds_read_b64_tr_b16 v[100:101], v40 offset:0
    ds_read_b64_tr_b16 v[102:103], v40 offset:512
    v_mfma_f32_16x16x32_bf16 v[68:71], v[144:147], v[128:131], v[68:71]
    ds_read_b64_tr_b16 v[104:105], v41 offset:0
    v_mfma_f32_16x16x32_bf16 v[72:75], v[140:143], v[132:135], v[72:75]
    ds_read_b64_tr_b16 v[106:107], v41 offset:512
    v_mfma_f32_16x16x32_bf16 v[76:79], v[144:147], v[132:135], v[76:79]
    ds_read_b128 v[88:91], v44 offset:22528
    v_mfma_f32_16x16x32_bf16 v[80:83], v[140:143], v[136:139], v[80:83]
    ds_read_b128 v[92:95], v44 offset:22784
    v_mfma_f32_16x16x32_bf16 v[84:87], v[144:147], v[136:139], v[84:87]
    ds_read_b128 v[96:99], v44 offset:23040
    s_waitcnt lgkmcnt(7)
    s_nop 0
    v_mfma_f32_16x16x32_bf16 v[64:67], v[160:163], v[148:151], v[64:67]
    ds_read_b64_tr_b16 v[120:121], v40 offset:4096
    ds_read_b64_tr_b16 v[122:123], v40 offset:4608
    v_mfma_f32_16x16x32_bf16 v[68:71], v[164:167], v[148:151], v[68:71]
    ds_read_b64_tr_b16 v[124:125], v41 offset:4096
    v_mfma_f32_16x16x32_bf16 v[72:75], v[160:163], v[152:155], v[72:75]
    ds_read_b64_tr_b16 v[126:127], v41 offset:4608
    v_mfma_f32_16x16x32_bf16 v[76:79], v[164:167], v[152:155], v[76:79]
    ds_read_b128 v[108:111], v44 offset:23936
    v_mfma_f32_16x16x32_bf16 v[80:83], v[160:163], v[156:159], v[80:83]
    ds_read_b128 v[112:115], v44 offset:24192
    v_mfma_f32_16x16x32_bf16 v[84:87], v[164:167], v[156:159], v[84:87]
    ds_read_b128 v[116:119], v44 offset:24448
    s_barrier
    s_waitcnt lgkmcnt(7)
    v_mfma_f32_16x16x32_bf16 v[64:67], v[100:103], v[88:91], v[64:67]
    ds_read_b64_tr_b16 v[140:141], v40 offset:8192
    ds_read_b64_tr_b16 v[142:143], v40 offset:8704
    v_mfma_f32_16x16x32_bf16 v[68:71], v[104:107], v[88:91], v[68:71]
    ds_read_b64_tr_b16 v[144:145], v41 offset:8192
    v_mfma_f32_16x16x32_bf16 v[72:75], v[100:103], v[92:95], v[72:75]
    ds_read_b64_tr_b16 v[146:147], v41 offset:8704
    v_mfma_f32_16x16x32_bf16 v[76:79], v[104:107], v[92:95], v[76:79]
    ds_read_b128 v[128:131], v44 offset:33792
    v_mfma_f32_16x16x32_bf16 v[80:83], v[100:103], v[96:99], v[80:83]
    ds_read_b128 v[132:135], v44 offset:34048
    v_mfma_f32_16x16x32_bf16 v[84:87], v[104:107], v[96:99], v[84:87]
    ds_read_b128 v[136:139], v44 offset:34304
    s_waitcnt lgkmcnt(7)
    s_nop 0
    v_mfma_f32_16x16x32_bf16 v[64:67], v[120:123], v[108:111], v[64:67]
    ds_read_b64_tr_b16 v[160:161], v40 offset:12288
    ds_read_b64_tr_b16 v[162:163], v40 offset:12800
    v_mfma_f32_16x16x32_bf16 v[68:71], v[124:127], v[108:111], v[68:71]
    ds_read_b64_tr_b16 v[164:165], v41 offset:12288
    v_mfma_f32_16x16x32_bf16 v[72:75], v[120:123], v[112:115], v[72:75]
    ds_read_b64_tr_b16 v[166:167], v41 offset:12800
    v_mfma_f32_16x16x32_bf16 v[76:79], v[124:127], v[112:115], v[76:79]
    ds_read_b128 v[148:151], v44 offset:35200
    v_mfma_f32_16x16x32_bf16 v[80:83], v[120:123], v[116:119], v[80:83]
    ds_read_b128 v[152:155], v44 offset:35456
    v_mfma_f32_16x16x32_bf16 v[84:87], v[124:127], v[116:119], v[84:87]
    ds_read_b128 v[156:159], v44 offset:35712
    s_barrier
    s_waitcnt lgkmcnt(7)
    v_mfma_f32_16x16x32_bf16 v[64:67], v[140:143], v[128:131], v[64:67]
    ds_read_b64_tr_b16 v[100:101], v40 offset:16384
    ds_read_b64_tr_b16 v[102:103], v40 offset:16896
    v_mfma_f32_16x16x32_bf16 v[68:71], v[144:147], v[128:131], v[68:71]
    ds_read_b64_tr_b16 v[104:105], v41 offset:16384
    v_mfma_f32_16x16x32_bf16 v[72:75], v[140:143], v[132:135], v[72:75]
    ds_read_b64_tr_b16 v[106:107], v41 offset:16896
    v_mfma_f32_16x16x32_bf16 v[76:79], v[144:147], v[132:135], v[76:79]
    ds_read_b128 v[88:91], v44 offset:45056
    v_mfma_f32_16x16x32_bf16 v[80:83], v[140:143], v[136:139], v[80:83]
    ds_read_b128 v[92:95], v44 offset:45312
    v_mfma_f32_16x16x32_bf16 v[84:87], v[144:147], v[136:139], v[84:87]
    ds_read_b128 v[96:99], v44 offset:45568
    s_waitcnt lgkmcnt(7)
    s_nop 0
    v_mfma_f32_16x16x32_bf16 v[64:67], v[160:163], v[148:151], v[64:67]
    ds_read_b64_tr_b16 v[120:121], v40 offset:20480
    ds_read_b64_tr_b16 v[122:123], v40 offset:20992
    v_mfma_f32_16x16x32_bf16 v[68:71], v[164:167], v[148:151], v[68:71]
    ds_read_b64_tr_b16 v[124:125], v41 offset:20480
    v_mfma_f32_16x16x32_bf16 v[72:75], v[160:163], v[152:155], v[72:75]
    ds_read_b64_tr_b16 v[126:127], v41 offset:20992
    v_mfma_f32_16x16x32_bf16 v[76:79], v[164:167], v[152:155], v[76:79]
    ds_read_b128 v[108:111], v44 offset:46464
    v_mfma_f32_16x16x32_bf16 v[80:83], v[160:163], v[156:159], v[80:83]
    ds_read_b128 v[112:115], v44 offset:46720
    v_mfma_f32_16x16x32_bf16 v[84:87], v[164:167], v[156:159], v[84:87]
    ds_read_b128 v[116:119], v44 offset:46976
    s_waitcnt lgkmcnt(7)
    v_mfma_f32_16x16x32_bf16 v[64:67], v[100:103], v[88:91], v[64:67]
    v_mfma_f32_16x16x32_bf16 v[68:71], v[104:107], v[88:91], v[68:71]
    v_mfma_f32_16x16x32_bf16 v[72:75], v[100:103], v[92:95], v[72:75]
    v_mfma_f32_16x16x32_bf16 v[76:79], v[104:107], v[92:95], v[76:79]
    v_mfma_f32_16x16x32_bf16 v[80:83], v[100:103], v[96:99], v[80:83]
    v_mfma_f32_16x16x32_bf16 v[84:87], v[104:107], v[96:99], v[84:87]
    s_waitcnt lgkmcnt(0)
    v_mfma_f32_16x16x32_bf16 v[64:67], v[120:123], v[108:111], v[64:67]
    v_mfma_f32_16x16x32_bf16 v[68:71], v[124:127], v[108:111], v[68:71]
    v_mfma_f32_16x16x32_bf16 v[72:75], v[120:123], v[112:115], v[72:75]
    v_mfma_f32_16x16x32_bf16 v[76:79], v[124:127], v[112:115], v[76:79]
    v_mfma_f32_16x16x32_bf16 v[80:83], v[120:123], v[116:119], v[80:83]
    v_mfma_f32_16x16x32_bf16 v[84:87], v[124:127], v[116:119], v[84:87]
    s_barrier
    ds_read_b64_tr_b16 v[140:141], v40 offset:24576
    ds_read_b64_tr_b16 v[142:143], v40 offset:25088
    ds_read_b64_tr_b16 v[144:145], v41 offset:24576
    ds_read_b64_tr_b16 v[146:147], v41 offset:25088
    ds_read_b128 v[128:131], v44 offset:56320
    ds_read_b128 v[132:135], v44 offset:56576
    ds_read_b128 v[136:139], v44 offset:56832
    ds_read_b64_tr_b16 v[160:161], v40 offset:28672
    ds_read_b64_tr_b16 v[162:163], v40 offset:29184
    ds_read_b64_tr_b16 v[164:165], v41 offset:28672
    ds_read_b64_tr_b16 v[166:167], v41 offset:29184
    ds_read_b128 v[148:151], v44 offset:57728
    ds_read_b128 v[152:155], v44 offset:57984
    ds_read_b128 v[156:159], v44 offset:58240
    s_waitcnt lgkmcnt(7)
    v_mfma_f32_16x16x32_bf16 v[64:67], v[140:143], v[128:131], v[64:67]
    v_mfma_f32_16x16x32_bf16 v[68:71], v[144:147], v[128:131], v[68:71]
    v_mfma_f32_16x16x32_bf16 v[72:75], v[140:143], v[132:135], v[72:75]
    v_mfma_f32_16x16x32_bf16 v[76:79], v[144:147], v[132:135], v[76:79]
    v_mfma_f32_16x16x32_bf16 v[80:83], v[140:143], v[136:139], v[80:83]
    v_mfma_f32_16x16x32_bf16 v[84:87], v[144:147], v[136:139], v[84:87]
    s_waitcnt lgkmcnt(0)
    v_mfma_f32_16x16x32_bf16 v[64:67], v[160:163], v[148:151], v[64:67]
    v_mfma_f32_16x16x32_bf16 v[68:71], v[164:167], v[148:151], v[68:71]
    v_mfma_f32_16x16x32_bf16 v[72:75], v[160:163], v[152:155], v[72:75]
    v_mfma_f32_16x16x32_bf16 v[76:79], v[164:167], v[152:155], v[76:79]
    v_mfma_f32_16x16x32_bf16 v[80:83], v[160:163], v[156:159], v[80:83]
    v_mfma_f32_16x16x32_bf16 v[84:87], v[164:167], v[156:159], v[84:87]
    s_nop 2
    s_nop 0
    v_cvt_pk_bf16_f32 v64, v64, v65
    v_cvt_pk_bf16_f32 v65, v66, v67
    v_cvt_pk_bf16_f32 v68, v68, v69
    v_cvt_pk_bf16_f32 v69, v70, v71
    ds_write2_b64 v49, v[64:65], v[68:69] offset0:0 offset1:4
    ds_read_b128 v[88:91], v50
    v_cvt_pk_bf16_f32 v72, v72, v73
    v_cvt_pk_bf16_f32 v73, v74, v75
    v_cvt_pk_bf16_f32 v76, v76, v77
    v_cvt_pk_bf16_f32 v77, v78, v79
    ds_write2_b64 v49, v[72:73], v[76:77] offset0:0 offset1:4
    ds_read_b128 v[92:95], v50
    v_cvt_pk_bf16_f32 v80, v80, v81
    v_cvt_pk_bf16_f32 v81, v82, v83
    v_cvt_pk_bf16_f32 v84, v84, v85
    v_cvt_pk_bf16_f32 v85, v86, v87
    ds_write2_b64 v49, v[80:81], v[84:85] offset0:0 offset1:4
    ds_read_b128 v[96:99], v50
    s_waitcnt lgkmcnt(4)
    buffer_store_dwordx4 v[88:91], v46, s[28:31], 0 offen nt
    s_waitcnt lgkmcnt(2)
    buffer_store_dwordx4 v[92:95], v47, s[28:31], 0 offen nt
    s_waitcnt lgkmcnt(0)
    buffer_store_dwordx4 v[96:99], v48, s[28:31], 0 offen nt
    s_branch L_fin
L_ldloop:
L_pad9:
    s_cbranch_execz L_back
    s_bfe_u32 s59, s89, 0x30003
    s_add_u32 s59, s59, s88
    s_add_u32 s59, s59, 1
    s_mul_i32 s56, s59, 26
    s_lshr_b32 s56, s56, 8
    s_mul_i32 s56, s56, 10
    s_sub_u32 s59, s59, s56
    s_lshl_b32 s56, s59, 7
    s_mul_i32 s57, s59, 245760
    s_add_u32 s58, s57, 122880
    s_add_u32 m0, s46, 81920
    s_nop 0
    buffer_load_dwordx4 v10, s[8:11], s57 offen offset:0 lds
    s_add_u32 m0, s46, 14336
    s_nop 0
    buffer_load_dwordx4 v6, s[4:7], s56 offen lds
    s_add_u32 m0, s46, 88832
    s_nop 0
    buffer_load_dwordx4 v10, s[8:11], s57 offen offset:1280 lds
    s_add_u32 m0, s46, 95744
    s_nop 0
    buffer_load_dwordx4 v10, s[8:11], s57 offen offset:2560 lds
    s_add_u32 m0, s46, 18432
    s_nop 0
    buffer_load_dwordx4 v7, s[4:7], s56 offen lds
    s_add_u32 m0, s46, 86016
    s_nop 0
    buffer_load_dwordx4 v10, s[8:11], s58 offen offset:0 lds
    s_add_u32 m0, s46, 92928
    s_nop 0
    buffer_load_dwordx4 v10, s[8:11], s58 offen offset:1280 lds
    s_add_u32 m0, s46, 22528
    s_nop 0
    buffer_load_dwordx4 v8, s[4:7], s56 offen lds
    s_add_u32 m0, s46, 99840
    s_nop 0
    buffer_load_dwordx4 v10, s[8:11], s58 offen offset:2560 lds
    s_mov_b32 m0, 26624
    s_mov_b64 exec, s[52:53]
    buffer_load_dwordx4 v9, s[4:7], s56 offen lds
    s_mov_b64 exec, -1
    s_waitcnt vmcnt(10)
    s_barrier
    buffer_store_dwordx4 v[92:95], v25, s[32:35], 0 offen sc1
    s_load_dword s91, s[98:99], -491520
    s_load_dword s91, s[98:99], -491456
    s_bfm_b64 exec, 16, 0
    buffer_store_dwordx4 v[92:95], v25, s[32:35], 0 offen offset:1024 sc1
    s_mov_b64 exec, -1
    v_mul_u32_u24 v57, s48, v2
    v_add_u32_e64 v57, s67, v57
    v_lshl_add_u32 v240, v3, 3, v57
    v_add_u32_e64 v241, 32, v57
    s_bfe_u32 s59, s89, 0x30006
    s_add_u32 s59, s59, s88
    s_add_u32 s59, s59, 2
    s_mul_i32 s56, s59, 26
    s_lshr_b32 s56, s56, 8
    s_mul_i32 s56, s56, 10
    s_sub_u32 s59, s59, s56
    s_lshl_b32 s56, s59, 7
    s_mul_i32 s57, s59, 245760
    s_add_u32 s58, s57, 122880
    s_add_u32 m0, s46, 106496
    s_nop 0
    buffer_load_dwordx4 v10, s[8:11], s57 offen offset:0 lds
    v_add_u32 v56, 16, v2
    v_cmp_gt_u32 vcc, 8, v2
    s_nop 1
    v_cndmask_b32 v56, v2, v56, vcc
    s_add_u32 m0, s46, 28672
    s_nop 0
    buffer_load_dwordx4 v6, s[4:7], s56 offen lds
    v_mul_u32_u24 v57, s48, v56
    v_add_u32_e64 v57, s67, v57
    v_lshl_add_u32 v242, v3, 3, v57
    v_add_u32_e64 v243, 32, v57
    s_add_u32 m0, s46, 113408
    s_nop 0
    buffer_load_dwordx4 v10, s[8:11], s57 offen offset:1280 lds
    s_load_dword s91, s[98:99], -430080
    s_load_dword s91, s[98:99], -430016
    s_add_u32 m0, s46, 120320
    s_nop 0
    buffer_load_dwordx4 v10, s[8:11], s57 offen offset:2560 lds
    v_min_u32 v56, 19, v56
    v_mul_u32_u24 v57, s48, v56
    v_add_u32_e64 v57, s67, v57
    v_lshl_add_u32 v244, v3, 3, v57
    v_add_u32_e64 v245, 32, v57
    s_add_u32 m0, s46, 32768
    s_nop 0
    buffer_load_dwordx4 v7, s[4:7], s56 offen lds
    v_mov_b32 v58, 49760
    v_cndmask_b32 v232, v58, v240, vcc
    v_cndmask_b32_e64 v234, v240, v58, vcc
    s_add_u32 m0, s46, 110592
    s_nop 0
    buffer_load_dwordx4 v10, s[8:11], s58 offen offset:0 lds
    v_cmp_gt_u32 vcc, 8, v1
    s_nop 1
    v_cndmask_b32 v233, v58, v241, vcc
    v_lshrrev_b32 v57, 3, v1
    v_cmp_eq_u32 vcc, 1, v57
    s_nop 1
    v_cndmask_b32 v235, v58, v241, vcc
    s_add_u32 m0, s46, 117504
    s_nop 0
    buffer_load_dwordx4 v10, s[8:11], s58 offen offset:1280 lds
    v_lshrrev_b32 v57, 2, v1
    v_and_b32_e64 v56, 3, v1
    s_add_u32 m0, s46, 36864
    s_nop 0
    buffer_load_dwordx4 v8, s[4:7], s56 offen lds
    s_add_u32 m0, s46, 124416
    s_nop 0
    buffer_load_dwordx4 v10, s[8:11], s58 offen offset:2560 lds
    s_mov_b32 m0, 40960
    s_mov_b64 exec, s[52:53]
    buffer_load_dwordx4 v9, s[4:7], s56 offen lds
    s_mov_b64 exec, -1
    s_waitcnt vmcnt(12)
    s_barrier
    s_bfe_u32 s59, s89, 0x30009
    s_add_u32 s59, s59, s88
    s_add_u32 s59, s59, 3
    s_mul_i32 s56, s59, 26
    s_lshr_b32 s56, s56, 8
    s_mul_i32 s56, s56, 10
    s_sub_u32 s59, s59, s56
    s_lshl_b32 s56, s59, 7
    s_mul_i32 s57, s59, 245760
    s_add_u32 s58, s57, 122880
    s_add_u32 m0, s46, 131072
    s_nop 0
    buffer_load_dwordx4 v10, s[8:11], s57 offen offset:0 lds
    s_load_dword s91, s[98:99], -368640
    s_load_dword s91, s[98:99], -368576
    s_add_u32 m0, s46, 43008
    s_nop 0
    buffer_load_dwordx4 v6, s[4:7], s56 offen lds
    v_mul_u32_u24 v59, s48, v57
    v_add_u32_e64 v59, s67, v59
    v_lshl_add_u32 v252, v56, 3, v59
    s_add_u32 m0, s46, 137984
    s_nop 0
    buffer_load_dwordx4 v10, s[8:11], s57 offen offset:1280 lds
    v_min_u32 v57, 3, v57
    v_mul_u32_u24 v57, s48, v57
    v_add_u32 v57, s67, v57
    v_lshl_add_u32 v253, v56, 3, v57
    s_add_u32 m0, s46, 144896
    s_nop 0
    buffer_load_dwordx4 v10, s[8:11], s57 offen offset:2560 lds
    v_mov_b32 v58, 53376
    s_add_u32 m0, s46, 47104
    s_nop 0
    buffer_load_dwordx4 v7, s[4:7], s56 offen lds
    s_load_dword s91, s[98:99], -307200
    s_load_dword s91, s[98:99], -307136
    s_add_u32 m0, s46, 135168
    s_nop 0
    buffer_load_dwordx4 v10, s[8:11], s58 offen offset:0 lds
    v_cmp_eq_u32 vcc, 0, v56
    s_nop 1
    v_cndmask_b32 v249, v58, v59, vcc
    s_add_u32 m0, s46, 142080
    s_nop 0
    buffer_load_dwordx4 v10, s[8:11], s58 offen offset:1280 lds
    v_cmp_eq_u32 vcc, 1, v56
    s_nop 1
    v_cndmask_b32 v250, v58, v59, vcc
    s_add_u32 m0, s46, 51200
    s_nop 0
    buffer_load_dwordx4 v8, s[4:7], s56 offen lds
    v_cmp_eq_u32 vcc, 2, v56
    s_nop 1
    v_cndmask_b32 v251, v58, v59, vcc
    s_add_u32 m0, s46, 148992
    s_nop 0
    buffer_load_dwordx4 v10, s[8:11], s58 offen offset:2560 lds
    v_cndmask_b32_e64 v254, v58, v57, vcc
    s_mov_b32 m0, 55296
    s_mov_b64 exec, s[52:53]
    buffer_load_dwordx4 v9, s[4:7], s56 offen lds
    s_mov_b64 exec, -1
    s_waitcnt vmcnt(10)
    s_barrier
    s_bfe_u32 s59, s89, 0x3000c
    s_add_u32 s59, s59, s88
    s_add_u32 s59, s59, 4
    s_mul_i32 s56, s59, 26
    s_lshr_b32 s56, s56, 8
    s_mul_i32 s56, s56, 10
    s_sub_u32 s59, s59, s56
    s_lshl_b32 s56, s59, 7
    s_mul_i32 s57, s59, 245760
    s_add_u32 s58, s57, 122880
    s_add_u32 m0, s46, 57344
    s_nop 0
    buffer_load_dwordx4 v10, s[8:11], s57 offen offset:0 lds
    s_load_dword s91, s[98:99], -245760
    s_load_dword s91, s[98:99], -245696
    s_add_u32 m0, s46, 0
    s_nop 0
    buffer_load_dwordx4 v6, s[4:7], s56 offen lds
    s_lshl_b32 s49, s65, 3
    s_add_u32 s49, s49, 155776
    v_lshl_add_u32 v255, v2, 4, s49
    s_add_u32 m0, s46, 64256
    s_nop 0
    buffer_load_dwordx4 v10, s[8:11], s57 offen offset:1280 lds
    s_mul_i32 s49, s43, 88
    s_mul_i32 s50, s54, s65
    s_add_u32 s49, s49, s50
    s_lshl_b32 s49, s49, 4
    s_add_u32 m0, s46, 71168
    s_nop 0
    buffer_load_dwordx4 v10, s[8:11], s57 offen offset:2560 lds
    s_lshl_b32 s50, s66, 13
    s_add_u32 s49, s49, s50
    s_add_u32 m0, s46, 4096
    s_nop 0
    buffer_load_dwordx4 v7, s[4:7], s56 offen lds
    s_load_dword s91, s[98:99], -184320
    s_load_dword s91, s[98:99], -184256
    s_add_u32 m0, s46, 61440
    s_nop 0
    buffer_load_dwordx4 v10, s[8:11], s58 offen offset:0 lds
    s_add_u32 s49, s49, 786432
    s_add_u32 m0, s46, 68352
    s_nop 0
    buffer_load_dwordx4 v10, s[8:11], s58 offen offset:1280 lds
    v_lshrrev_b32 v57, 1, v3
    v_lshlrev_b32 v57, 12, v57
    v_lshl_add_u32 v57, v2, 4, v57
    v_add_u32_e64 v57, s49, v57
    s_add_u32 m0, s46, 8192
    s_nop 0
    buffer_load_dwordx4 v8, s[4:7], s56 offen lds
    v_and_b32 v56, 1, v3
    v_lshl_add_u32 v246, v56, 8, v57
    v_mov_b32 v58, 0x80000000
    s_add_u32 m0, s46, 75264
    s_nop 0
    buffer_load_dwordx4 v10, s[8:11], s58 offen offset:2560 lds
    s_sub_u32 s50, s54, 32
    v_lshl_add_u32 v56, v56, 4, v2
    v_cmp_gt_u32 vcc, s50, v56
    s_nop 1
    v_cndmask_b32_e64 v247, v58, v57, vcc
    s_mov_b32 m0, 12288
    s_mov_b64 exec, s[52:53]
    buffer_load_dwordx4 v9, s[4:7], s56 offen lds
    s_mov_b64 exec, -1
    s_waitcnt vmcnt(10)
    s_barrier
    s_bfe_u32 s59, s89, 0x3000f
    s_add_u32 s59, s59, s88
    s_add_u32 s59, s59, 5
    s_mul_i32 s56, s59, 26
    s_lshr_b32 s56, s56, 8
    s_mul_i32 s56, s56, 10
    s_sub_u32 s59, s59, s56
    s_lshl_b32 s56, s59, 7
    s_mul_i32 s57, s59, 245760
    s_add_u32 s58, s57, 122880
    s_add_u32 m0, s46, 81920
    s_nop 0
    buffer_load_dwordx4 v10, s[8:11], s57 offen offset:0 lds
    s_load_dword s91, s[98:99], -122880
    s_load_dword s91, s[98:99], -122816
L_pad10:
    s_cbranch_execz L_pad11
    s_add_u32 m0, s46, 14336
    s_nop 0
    buffer_load_dwordx4 v6, s[4:7], s56 offen lds
    s_lshl_b32 s49, s43, 1
    s_add_u32 s49, s49, s65
    s_lshl_b32 s49, s49, 5
    s_add_u32 s49, s49, s66
    s_mul_i32 s49, s49, 384
    s_add_u32 s49, s49, 1328128
    s_add_u32 m0, s46, 88832
    s_nop 0
    buffer_load_dwordx4 v10, s[8:11], s57 offen offset:1280 lds
    v_lshl_add_u32 v57, v1, 3, s49
    v_cmp_gt_u32 vcc, 48, v1
    s_nop 1
    v_cndmask_b32 v248, v58, v57, vcc
    s_add_u32 m0, s46, 95744
    s_nop 0
    buffer_load_dwordx4 v10, s[8:11], s57 offen offset:2560 lds
    s_lshr_b32 s48, s60, 1
    s_and_b32 s49, s60, 1
    s_sub_u32 s50, s45, s48
    s_sub_u32 s50, s50, 1
    s_cmp_lt_u32 s50, 2
    s_cselect_b32 s69, 1, 0
    s_add_u32 m0, s46, 18432
    s_nop 0
    buffer_load_dwordx4 v7, s[4:7], s56 offen lds
    s_load_dword s91, s[98:99], -61440
    s_load_dword s91, s[98:99], -61376
    s_add_u32 m0, s46, 86016
    s_nop 0
    buffer_load_dwordx4 v10, s[8:11], s58 offen offset:0 lds
    s_lshl_b32 s50, s48, 1
    s_add_u32 s50, s50, s42
    s_sub_u32 s50, s50, 1
    s_mul_i32 s50, s50, 5120
    s_add_u32 s50, s50, 1155072
    s_add_u32 m0, s46, 92928
    s_nop 0
    buffer_load_dwordx4 v10, s[8:11], s58 offen offset:1280 lds
    v_lshl_add_u32 v57, v1, 1, s49
    v_lshl_add_u32 v38, v57, 4, s50
    s_add_u32 m0, s46, 22528
    s_nop 0
    buffer_load_dwordx4 v8, s[4:7], s56 offen lds
    v_max_u32 v57, 16, v57
    v_subrev_u32 v57, 16, v57
    v_lshrrev_b32 v58, 5, v57
    v_lshlrev_b32 v58, 8, v58
    v_and_b32_e64 v59, 15, v57
    s_add_u32 m0, s46, 99840
    s_nop 0
    buffer_load_dwordx4 v10, s[8:11], s58 offen offset:2560 lds
    v_lshl_add_u32 v58, v59, 4, v58
    v_lshrrev_b32 v59, 1, v57
    v_and_b32_e64 v59, 8, v59
    s_add_u32 s50, s50, 3584
    v_add3_u32 v40, v58, v59, s50
    s_mov_b32 m0, 26624
    s_mov_b64 exec, s[52:53]
    buffer_load_dwordx4 v9, s[4:7], s56 offen lds
    s_mov_b64 exec, -1
    s_waitcnt vmcnt(10)
    s_barrier
    s_bfe_u32 s59, s89, 0x30012
    s_add_u32 s59, s59, s88
    s_add_u32 s59, s59, 6
    s_mul_i32 s56, s59, 26
    s_lshr_b32 s56, s56, 8
    s_mul_i32 s56, s56, 10
    s_sub_u32 s59, s59, s56
    s_lshl_b32 s56, s59, 7
    s_mul_i32 s57, s59, 245760
    s_add_u32 s58, s57, 122880
    s_add_u32 m0, s46, 106496
    s_nop 0
    buffer_load_dwordx4 v10, s[8:11], s57 offen offset:0 lds
    s_load_dword s91, s[98:99], 0
    s_load_dword s91, s[98:99], 64
    s_add_u32 m0, s46, 28672
    s_nop 0
    buffer_load_dwordx4 v6, s[4:7], s56 offen lds
    s_mul_i32 s50, s49, 25800
    s_mul_i32 s51, s48, 144
    s_add_u32 s50, s50, s51
    s_add_u32 s50, s50, 53248
    s_movk_i32 s51, 496
    s_add_u32 m0, s46, 113408
    s_nop 0
    buffer_load_dwordx4 v10, s[8:11], s57 offen offset:1280 lds
    v_mul_u32_u24 v39, s51, v1
    v_add_u32 v39, s50, v39
    s_add_u32 m0, s46, 120320
    s_nop 0
    buffer_load_dwordx4 v10, s[8:11], s57 offen offset:2560 lds
    s_movk_i32 s51, 7936
    v_mul_u32_u24_e64 v41, s51, v1
    v_add_u32 v41, 53728, v41
    s_add_u32 m0, s46, 32768
    s_nop 0
    buffer_load_dwordx4 v7, s[4:7], s56 offen lds
    s_load_dword s91, s[98:99], 61440
    s_load_dword s91, s[98:99], 61504
    s_add_u32 m0, s46, 110592
    s_nop 0
    buffer_load_dwordx4 v10, s[8:11], s58 offen offset:0 lds
    s_mul_i32 s48, s43, 88
    s_lshl_b32 s49, s60, 8
    s_add_u32 s48, s48, s49
    s_lshl_b32 s48, s48, 4
    s_add_u32 m0, s46, 117504
    s_nop 0
    buffer_load_dwordx4 v10, s[8:11], s58 offen offset:1280 lds
    v_lshl_add_u32 v15, v1, 4, s48
    s_add_u32 m0, s46, 36864
    s_nop 0
    buffer_load_dwordx4 v8, s[4:7], s56 offen lds
    v_add_u32 v16, 1024, v15
    v_add_u32 v57, 14976, v16
    v_cmp_gt_u32 vcc, 24, v1
    s_nop 1
    v_cndmask_b32 v16, v57, v16, vcc
    s_add_u32 m0, s46, 124416
    s_nop 0
    buffer_load_dwordx4 v10, s[8:11], s58 offen offset:2560 lds
    v_add_u32 v17, 17024, v15
    s_mov_b32 m0, 40960
    s_mov_b64 exec, s[52:53]
    buffer_load_dwordx4 v9, s[4:7], s56 offen lds
    s_mov_b64 exec, -1
    s_waitcnt vmcnt(10)
    s_barrier
    s_bfe_u32 s59, s89, 0x30015
    s_add_u32 s59, s59, s88
    s_add_u32 s59, s59, 7
    s_mul_i32 s56, s59, 26
    s_lshr_b32 s56, s56, 8
    s_mul_i32 s56, s56, 10
    s_sub_u32 s59, s59, s56
    s_lshl_b32 s56, s59, 7
    s_mul_i32 s57, s59, 245760
    s_add_u32 s58, s57, 122880
    s_add_u32 m0, s46, 131072
    s_nop 0
    buffer_load_dwordx4 v10, s[8:11], s57 offen offset:0 lds
    s_load_dword s91, s[98:99], 122880
    s_load_dword s91, s[98:99], 122944
    s_add_u32 m0, s46, 43008
    s_nop 0
    buffer_load_dwordx4 v6, s[4:7], s56 offen lds
    s_lshl_b32 s48, s43, 1
    s_lshr_b32 s49, s60, 1
    s_add_u32 s48, s48, s49
    s_mul_i32 s48, s48, 12288
    s_and_b32 s49, s60, 1
    s_mul_i32 s49, s49, 3072
    s_add_u32 m0, s46, 137984
    s_nop 0
    buffer_load_dwordx4 v10, s[8:11], s57 offen offset:1280 lds
    s_add_u32 s48, s48, s49
    s_add_u32 s48, s48, 1328128
    v_lshl_add_u32 v54, v1, 4, s48
    s_add_u32 m0, s46, 144896
    s_nop 0
    buffer_load_dwordx4 v10, s[8:11], s57 offen offset:2560 lds
    s_and_b32 s48, s42, 15
    s_and_b32 s49, s48, 1
    s_mul_i32 s50, s48, 192
    s_lshl_b32 s51, s49, 6
    s_add_u32 s51, s51, s50
    s_add_u32 m0, s46, 47104
    s_nop 0
    buffer_load_dwordx4 v7, s[4:7], s56 offen lds
    s_load_dword s91, s[98:99], 184320
    s_load_dword s91, s[98:99], 184384
    s_add_u32 m0, s46, 135168
    s_nop 0
    buffer_load_dwordx4 v10, s[8:11], s58 offen offset:0 lds
    v_lshrrev_b32 v57, 5, v1
    v_and_b32_e64 v56, 3, v4
    v_lshl_add_u32 v58, v57, 4, v56
    v_mul_u32_u24 v59, 3072, v58
    s_add_u32 m0, s46, 142080
    s_nop 0
    buffer_load_dwordx4 v10, s[8:11], s58 offen offset:1280 lds
    v_lshl_add_u32 v45, v42, 4, v59
    v_add_u32 v45, s51, v45
    s_add_u32 m0, s46, 51200
    s_nop 0
    buffer_load_dwordx4 v8, s[4:7], s56 offen lds
    s_xor_b32 s49, s49, 1
    s_lshl_b32 s49, s49, 7
    s_add_u32 s50, s50, s49
    v_and_b32_e64 v57, 3, v42
    v_lshl_add_u32 v47, v57, 4, v59
    v_add_u32_e64 v47, s50, v47
    s_add_u32 m0, s46, 148992
    s_nop 0
    buffer_load_dwordx4 v10, s[8:11], s58 offen offset:2560 lds
    s_mov_b32 m0, 55296
    s_mov_b64 exec, s[52:53]
    buffer_load_dwordx4 v9, s[4:7], s56 offen lds
    s_mov_b64 exec, -1
    s_waitcnt vmcnt(10)
    s_barrier
    s_bfe_u32 s59, s89, 0x30018
    s_add_u32 s59, s59, s88
    s_add_u32 s59, s59, 8
    s_mul_i32 s56, s59, 26
    s_lshr_b32 s56, s56, 8
    s_mul_i32 s56, s56, 10
    s_sub_u32 s59, s59, s56
    s_lshl_b32 s56, s59, 7
    s_mul_i32 s57, s59, 245760
    s_add_u32 s58, s57, 122880
    s_add_u32 m0, s46, 57344
    s_nop 0
    buffer_load_dwordx4 v10, s[8:11], s57 offen offset:0 lds
    s_load_dword s91, s[98:99], 245760
    s_load_dword s91, s[98:99], 245824
    s_add_u32 m0, s46, 0
    s_nop 0
    s_nop 0
    buffer_load_dwordx4 v6, s[4:7], s56 offen lds
    s_mul_i32 s48, s48, 245760
    s_add_u32 s48, s48, 16384
    v_mul_u32_u24 v58, 384, v58
    v_lshl_add_u32 v46, v42, 4, v58
    v_add_u32_e64 v46, s48, v46
    s_add_u32 m0, s46, 64256
    s_nop 0
    buffer_load_dwordx4 v10, s[8:11], s57 offen offset:1280 lds
    s_mul_i32 s70, s60, 12288
    s_mul_i32 s71, s60, 1536
    s_add_u32 m0, s46, 71168
    s_nop 0
    buffer_load_dwordx4 v10, s[8:11], s57 offen offset:2560 lds
    s_and_b32 s48, s60, 1
    s_lshl_b32 s48, s48, 2
    s_lshl_b32 s86, 0x0f0f0f0f, s48
    s_mov_b32 s87, s86
    s_add_u32 m0, s46, 4096
    s_nop 0
    buffer_load_dwordx4 v7, s[4:7], s56 offen lds
    s_load_dword s91, s[98:99], 307200
    s_load_dword s91, s[98:99], 307264
    s_add_u32 m0, s46, 61440
    s_nop 0
    buffer_load_dwordx4 v10, s[8:11], s58 offen offset:0 lds
    s_mul_i32 s78, s60, 3072
    s_add_u32 m0, s46, 68352
    s_nop 0
    buffer_load_dwordx4 v10, s[8:11], s58 offen offset:1280 lds
    s_lshr_b32 s48, s42, 4
    s_lshl_b32 s49, s48, 11
    s_lshl_b32 s50, s60, 12
    s_add_u32 s49, s49, s50
    s_add_u32 s49, s49, 786432
    s_add_u32 m0, s46, 8192
    s_nop 0
    buffer_load_dwordx4 v8, s[4:7], s56 offen lds
    v_lshl_add_u32 v48, v1, 4, s49
    s_add_u32 m0, s46, 75264
    s_nop 0
    buffer_load_dwordx4 v10, s[8:11], s58 offen offset:2560 lds
    s_mov_b32 m0, 12288
    s_mov_b64 exec, s[52:53]
    buffer_load_dwordx4 v9, s[4:7], s56 offen lds
    s_mov_b64 exec, -1
    s_waitcnt vmcnt(10)
    s_barrier
    buffer_load_dword v43, off, s[36:39], s83 sc1
    s_load_dword s91, s[98:99], 368640
    s_load_dword s91, s[98:99], 368704
    s_bfe_u32 s59, s89, 0x3001b
    s_add_u32 s59, s59, s88
    s_add_u32 s59, s59, 9
    s_mul_i32 s56, s59, 26
    s_lshr_b32 s56, s56, 8
    s_mul_i32 s56, s56, 10
    s_sub_u32 s59, s59, s56
    s_lshl_b32 s56, s59, 7
    s_mul_i32 s57, s59, 245760
    s_add_u32 s58, s57, 122880
    s_add_u32 m0, s46, 81920
    s_nop 0
    buffer_load_dwordx4 v10, s[8:11], s57 offen offset:0 lds
    s_lshl_b32 s79, s60, 11
    s_add_u32 m0, s46, 14336
    s_nop 0
    buffer_load_dwordx4 v6, s[4:7], s56 offen lds
    s_lshl_b32 s49, s48, 10
    s_lshl_b32 s50, s60, 8
    s_add_u32 s49, s49, s50
    s_add_u32 s49, s49, 1114112
    s_add_u32 m0, s46, 88832
    s_nop 0
    buffer_load_dwordx4 v10, s[8:11], s57 offen offset:1280 lds
    v_and_b32 v57, 31, v1
    v_lshrrev_b32 v58, 5, v1
    v_lshlrev_b32_e64 v58, 11, v58
    v_lshl_add_u32 v49, v57, 3, v58
    v_add_u32_e64 v49, s49, v49
    s_add_u32 m0, s46, 95744
    s_nop 0
    buffer_load_dwordx4 v10, s[8:11], s57 offen offset:2560 lds
    s_load_dword s91, s[98:99], 430080
    s_load_dword s91, s[98:99], 430144
    s_add_u32 m0, s46, 18432
    s_nop 0
    buffer_load_dwordx4 v7, s[4:7], s56 offen lds
    s_lshl_b32 s49, s60, 9
    s_add_u32 s49, s49, 156672
    v_lshl_add_u32 v50, v57, 4, s49
    s_add_u32 m0, s46, 86016
    s_nop 0
    buffer_load_dwordx4 v10, s[8:11], s58 offen offset:0 lds
    s_and_b32 s48, s42, 15
    s_mul_i32 s48, s48, 384
    v_lshl_add_u32 v11, v1, 4, s48
    v_add_u32 v57, 5760, v11
    v_cmp_gt_u32 vcc, 24, v1
    s_nop 1
    v_cndmask_b32 v11, v57, v11, vcc
    s_add_u32 m0, s46, 92928
    s_nop 0
    buffer_load_dwordx4 v10, s[8:11], s58 offen offset:1280 lds
    v_lshlrev_b32 v61, 3, v1
    v_add_u32 v61, 1327104, v61
    s_add_u32 m0, s46, 22528
    s_nop 0
    buffer_load_dwordx4 v8, s[4:7], s56 offen lds
    s_add_u32 m0, s46, 99840
    s_nop 0
    buffer_load_dwordx4 v10, s[8:11], s58 offen offset:2560 lds
    s_mov_b32 m0, 26624
    s_mov_b64 exec, s[52:53]
    buffer_load_dwordx4 v9, s[4:7], s56 offen lds
    s_mov_b64 exec, -1
    s_waitcnt vmcnt(11)
    s_barrier
    s_add_u32 s56, s73, 0
    s_add_u32 m0, s46, 106496
    s_nop 0
    buffer_load_dwordx4 v12, s[12:15], s56 offen lds
    s_add_u32 s56, s73, 51200
    s_add_u32 m0, s46, 110592
    s_nop 0
    buffer_load_dwordx4 v12, s[12:15], s56 offen lds
    s_add_u32 s56, s73, 102400
    s_add_u32 m0, s46, 114688
    s_nop 0
    buffer_load_dwordx4 v12, s[12:15], s56 offen lds
    s_add_u32 s56, s73, 153600
    s_add_u32 m0, s46, 118784
    s_nop 0
    buffer_load_dwordx4 v12, s[12:15], s56 offen lds
    s_add_u32 s56, s73, 204800
    s_add_u32 m0, s46, 122880
    s_nop 0
    buffer_load_dwordx4 v12, s[12:15], s56 offen lds
    s_add_u32 s56, s73, 256000
    s_add_u32 m0, s46, 126976
    s_nop 0
    buffer_load_dwordx4 v12, s[12:15], s56 offen lds
    s_add_u32 s56, s73, 307200
    s_add_u32 m0, s46, 131072
    s_nop 0
    buffer_load_dwordx4 v12, s[12:15], s56 offen lds
    s_add_u32 s56, s73, 358400
    s_add_u32 m0, s46, 135168
    s_nop 0
    buffer_load_dwordx4 v12, s[12:15], s56 offen lds
    s_waitcnt vmcnt(8)
    s_barrier
    s_waitcnt vmcnt(18)
    s_mov_b32 s50, 0
L_hl_32:
    v_readfirstlane_b32 s49, v43
    s_add_u32 s50, s50, 1
    s_and_b32 s51, s49, 0xff
    s_cmp_eq_u32 s51, 32
    s_cbranch_scc1 L_hok_33
    s_cmp_gt_u32 s50, 200000
    s_cbranch_scc1 L_hok_33
    buffer_load_dword v43, off, s[36:39], s83 sc1
    s_waitcnt vmcnt(0)
    s_branch L_hl_32
L_hok_33:
    s_mul_i32 s50, s63, s63
    s_lshl_b32 s50, s50, 16
    s_lshl_b32 s51, s63, 8
    s_add_u32 s50, s50, s51
    s_add_u32 s50, s50, 1
    s_lshl_b32 s50, s50, 5
    s_cmp_lg_u32 s50, s49
    s_cselect_b32 s47, 1, 0
    v_mov_b32_e64 v43, s47
    v_mov_b32 v60, 156544
    ds_write_b32 v60, v43
    s_add_u32 s56, s73, 409600
    s_add_u32 m0, s46, 139264
    s_nop 0
    buffer_load_dwordx4 v12, s[12:15], s56 offen lds
    s_add_u32 s56, s73, 460800
    s_add_u32 m0, s46, 143360
    s_nop 0
    buffer_load_dwordx4 v12, s[12:15], s56 offen lds
    s_add_u32 s56, s73, 512000
    s_add_u32 m0, s46, 147456
    s_nop 0
    buffer_load_dwordx4 v12, s[12:15], s56 offen lds
    s_add_u32 s56, s73, 563200
    s_add_u32 m0, s46, 151552
    s_nop 0
    buffer_load_dwordx4 v12, s[12:15], s56 offen lds
    s_add_u32 s56, s73, 614400
    s_add_u32 m0, s46, 0
    s_nop 0
    buffer_load_dwordx4 v12, s[12:15], s56 offen lds
    s_add_u32 s56, s73, 665600
    s_add_u32 m0, s46, 4096
    s_nop 0
    buffer_load_dwordx4 v12, s[12:15], s56 offen lds
    s_waitcnt lgkmcnt(0)
    s_barrier
    v_mov_b32 v26, 0
    v_mov_b32 v27, 0
    s_bfm_b64 exec, 4, 0
    ds_write_b64 v41, v[26:27]
    s_mov_b64 exec, -1
    s_cmp_eq_u32 s69, 0
    s_cbranch_scc1 L_imps_36
    s_bfm_b64 exec, 52, 0
    s_mov_b32 s49, 0
L_imp_34:
    buffer_load_dwordx4 v[64:67], v38, s[32:35], 0 offen offset:0 sc1
    buffer_load_dwordx4 v[68:71], v38, s[32:35], 0 offen offset:1792 sc1
    buffer_load_dwordx2 v[72:73], v40, s[32:35], 0 offen offset:0 sc1
    buffer_load_dwordx2 v[74:75], v40, s[32:35], 0 offen offset:768 sc1
    s_add_u32 s49, s49, 1
    s_cmp_gt_u32 s49, 200000
    s_waitcnt vmcnt(3)
    v_max3_u32 v76, v64, v65, v66
    s_waitcnt vmcnt(2)
    v_max3_u32 v77, v67, v68, v69
    v_max3_u32 v76, v76, v70, v71
    s_waitcnt vmcnt(1)
    v_max3_u32 v77, v77, v72, v73
    s_waitcnt vmcnt(0)
    v_max3_u32 v76, v76, v74, v75
    v_max_u32 v76, v76, v77
    s_cbranch_scc1 L_impo_35
    v_cmp_eq_u32 vcc, -1, v76
    s_cbranch_vccnz L_imp_34
L_impo_35:
    ds_write2_b64 v39, v[72:73], v[74:75] offset0:0 offset1:1
    ds_write2_b64 v39, v[64:65], v[68:69] offset0:20 offset1:21
    ds_write2_b64 v39, v[66:67], v[70:71] offset0:40 offset1:41
    s_mov_b64 exec, -1
L_imps_36:
    s_setprio 0
    s_branch L_attn
L_ld_p2:
L_pad11:
    s_cbranch_execz L_pad12
    s_setprio 2
    s_lshl_b32 s48, s42, 2
    s_add_u32 s48, s48, s60
    s_mul_i32 s48, s48, 192
    s_add_u32 s48, s48, 1114112
    s_add_u32 s98, s32, s48
    s_addc_u32 s99, s33, 0
    s_load_dword s96, s[98:99], 0
    s_load_dword s96, s[98:99], 64
    s_load_dword s96, s[98:99], 128
    s_lshl_b32 s48, s42, 2
    s_add_u32 s48, s48, s60
    s_mul_i32 s48, s48, 576
    s_add_u32 s48, s48, 1048576
    s_add_u32 s98, s32, s48
    s_addc_u32 s99, s33, 0
    s_nop 0
    s_load_dword s96, s[98:99], 0
    s_load_dword s96, s[98:99], 64
    s_load_dword s96, s[98:99], 128
    s_load_dword s96, s[98:99], 192
    s_load_dword s96, s[98:99], 256
    s_load_dword s96, s[98:99], 320
    s_load_dword s96, s[98:99], 384
    s_load_dword s96, s[98:99], 448
    s_load_dword s96, s[98:99], 512
    s_lshl_b32 s48, s2, 2
    s_add_u32 s48, s48, s60
    s_mul_i32 s48, s48, 1920
    s_add_u32 s98, s24, s48
    s_addc_u32 s99, s25, 0
    s_waitcnt vmcnt(0)
    s_cmp_lg_u32 s40, 4
    s_cbranch_scc1 L_np_37
    s_mul_i32 s48, s43, 10
    s_bfm_b64 exec, 10, s48
    s_mov_b32 s48, 0
    s_mov_b32 s49, 16843009
L_poll_38:
    buffer_load_dwordx2 v[58:59], v61, s[32:35], 0 offen offset:256 sc1
    s_add_u32 s48, s48, 1
    s_cmp_gt_u32 s48, 200000
    s_cbranch_scc1 L_pollo_39
    s_waitcnt vmcnt(0)
    v_and_b32 v58, v58, v59
    v_cmp_ne_u32 vcc, s49, v58
    s_cbranch_vccnz L_poll_38
L_pollo_39:
    s_cmp_eq_u32 s47, 0
    s_cbranch_scc1 L_polld_40
    buffer_inv sc1
    s_waitcnt vmcnt(0)
L_polld_40:
    s_mov_b64 exec, -1
L_np_37:
    s_barrier
    s_mov_b32 s56, 786432
    s_add_u32 m0, s75, 32768
    s_nop 0
    buffer_load_dwordx4 v15, s[32:35], s56 offen sc1 lds
    s_add_u32 m0, s75, 33792
    s_nop 0
    buffer_load_dwordx4 v16, s[32:35], s56 offen sc1 lds
    s_add_u32 m0, s75, 34816
    s_mov_b64 exec, s[76:77]
    buffer_load_dwordx4 v17, s[32:35], s56 offen sc1 lds
    s_mov_b64 exec, -1
    s_mov_b32 s56, 819200
    s_add_u32 m0, s75, 45056
    s_nop 0
    buffer_load_dwordx4 v15, s[32:35], s56 offen sc1 lds
    s_add_u32 m0, s75, 46080
    s_nop 0
    buffer_load_dwordx4 v16, s[32:35], s56 offen sc1 lds
    s_add_u32 m0, s75, 47104
    s_mov_b64 exec, s[76:77]
    buffer_load_dwordx4 v17, s[32:35], s56 offen sc1 lds
    s_mov_b64 exec, -1
    s_mov_b32 s56, 851968
    s_add_u32 m0, s75, 57344
    s_nop 0
    buffer_load_dwordx4 v15, s[32:35], s56 offen sc1 lds
    s_add_u32 m0, s75, 58368
    s_nop 0
    buffer_load_dwordx4 v16, s[32:35], s56 offen sc1 lds
    s_add_u32 m0, s75, 59392
    s_mov_b64 exec, s[76:77]
    buffer_load_dwordx4 v17, s[32:35], s56 offen sc1 lds
    s_mov_b64 exec, -1
    s_mov_b32 s56, 884736
    s_add_u32 m0, s75, 69632
    s_nop 0
    buffer_load_dwordx4 v15, s[32:35], s56 offen sc1 lds
    s_add_u32 m0, s75, 70656
    s_nop 0
    buffer_load_dwordx4 v16, s[32:35], s56 offen sc1 lds
    s_add_u32 m0, s75, 71680
    s_mov_b64 exec, s[76:77]
    buffer_load_dwordx4 v17, s[32:35], s56 offen sc1 lds
    s_mov_b64 exec, -1
    s_load_dword s96, s[98:99], 0
    s_waitcnt vmcnt(9)
    s_barrier
    s_mov_b32 s56, 917504
    s_add_u32 m0, s75, 81920
    s_nop 0
    buffer_load_dwordx4 v15, s[32:35], s56 offen sc1 lds
    s_add_u32 m0, s75, 82944
    s_nop 0
    buffer_load_dwordx4 v16, s[32:35], s56 offen sc1 lds
    s_add_u32 m0, s75, 83968
    s_mov_b64 exec, s[76:77]
    buffer_load_dwordx4 v17, s[32:35], s56 offen sc1 lds
    s_mov_b64 exec, -1
    s_load_dword s96, s[98:99], 64
    s_waitcnt vmcnt(9)
    s_barrier
    s_mov_b32 s56, 950272
    s_add_u32 m0, s75, 94208
    s_nop 0
    buffer_load_dwordx4 v15, s[32:35], s56 offen sc1 lds
    s_add_u32 m0, s75, 95232
    s_nop 0
    buffer_load_dwordx4 v16, s[32:35], s56 offen sc1 lds
    s_add_u32 m0, s75, 96256
    s_mov_b64 exec, s[76:77]
    buffer_load_dwordx4 v17, s[32:35], s56 offen sc1 lds
    s_mov_b64 exec, -1
    s_load_dword s96, s[98:99], 128
    s_waitcnt vmcnt(9)
    s_barrier
    s_mov_b32 s56, 983040
    s_add_u32 m0, s75, 32768
    s_nop 0
    buffer_load_dwordx4 v15, s[32:35], s56 offen sc1 lds
    s_add_u32 m0, s75, 33792
    s_nop 0
    buffer_load_dwordx4 v16, s[32:35], s56 offen sc1 lds
    s_add_u32 m0, s75, 34816
    s_mov_b64 exec, s[76:77]
    buffer_load_dwordx4 v17, s[32:35], s56 offen sc1 lds
    s_mov_b64 exec, -1
    s_load_dword s96, s[98:99], 192
    s_waitcnt vmcnt(9)
    s_barrier
    s_mov_b32 s56, 1015808
    s_add_u32 m0, s75, 45056
    s_nop 0
    buffer_load_dwordx4 v15, s[32:35], s56 offen sc1 lds
    s_add_u32 m0, s75, 46080
    s_nop 0
    buffer_load_dwordx4 v16, s[32:35], s56 offen sc1 lds
    s_add_u32 m0, s75, 47104
    s_mov_b64 exec, s[76:77]
    buffer_load_dwordx4 v17, s[32:35], s56 offen sc1 lds
    s_mov_b64 exec, -1
    s_load_dword s96, s[98:99], 256
    s_waitcnt vmcnt(9)
    s_barrier
    s_mov_b32 s56, 0
    s_add_u32 m0, s78, 57344
    s_nop 0
    buffer_load_dwordx4 v54, s[32:35], s56 offen offset:0 sc1 lds
    buffer_load_dwordx4 v54, s[32:35], s56 offen offset:1024 sc1 lds
    buffer_load_dwordx4 v54, s[32:35], s56 offen offset:2048 sc1 lds
    s_load_dword s96, s[98:99], 320
    s_waitcnt vmcnt(9)
    s_barrier
    s_mov_b32 s56, 6144
    s_add_u32 m0, s78, 69632
    s_nop 0
    buffer_load_dwordx4 v54, s[32:35], s56 offen offset:0 sc1 lds
    buffer_load_dwordx4 v54, s[32:35], s56 offen offset:1024 sc1 lds
    buffer_load_dwordx4 v54, s[32:35], s56 offen offset:2048 sc1 lds
    s_load_dword s96, s[98:99], 384
    s_waitcnt vmcnt(9)
    s_barrier
    s_load_dword s96, s[98:99], 448
    s_waitcnt vmcnt(6)
    s_barrier
    s_cmp_lg_u32 s40, 5
    s_cbranch_scc1 L_rd_41
    v_mov_b32 v60, 1
    s_mov_b32 s48, s55
    s_cmp_eq_u32 s47, 0
    s_mov_b64 exec, 1
    s_waitcnt vmcnt(63)
    s_cbranch_scc1 L_sigf_42
    buffer_store_byte v60, off, s[32:35], s48 offset:0 sc1
    s_branch L_sigd_43
L_sigf_42:
    buffer_store_byte v60, off, s[32:35], s48 offset:0
L_sigd_43:
    s_mov_b64 exec, -1
L_rd_41:
    s_add_u32 s57, s70, 0
    s_add_u32 m0, s46, 106496
    s_nop 0
    buffer_load_dwordx4 v45, s[16:19], s57 offen lds
    s_add_u32 m0, s46, 114688
    s_nop 0
    buffer_load_dwordx4 v45, s[20:23], s57 offen lds
    s_add_u32 m0, s46, 122880
    s_mov_b64 exec, s[86:87]
    buffer_load_dwordx4 v47, s[16:19], s57 offen lds
    s_not_b64 exec, s[86:87]
    buffer_load_dwordx4 v47, s[20:23], s57 offen lds
    s_mov_b64 exec, -1
    s_add_u32 s57, s70, 98304
    s_add_u32 m0, s46, 110592
    s_nop 0
    buffer_load_dwordx4 v45, s[16:19], s57 offen lds
    s_add_u32 m0, s46, 118784
    s_nop 0
    buffer_load_dwordx4 v45, s[20:23], s57 offen lds
    s_add_u32 m0, s46, 126976
    s_mov_b64 exec, s[86:87]
    buffer_load_dwordx4 v47, s[16:19], s57 offen lds
    s_not_b64 exec, s[86:87]
    buffer_load_dwordx4 v47, s[20:23], s57 offen lds
    s_mov_b64 exec, -1
L_pad12:
    s_cbranch_execz L_pad13
    s_load_dword s96, s[98:99], 512
    s_waitcnt vmcnt(11)
    s_barrier
    s_load_dword s96, s[98:99], 576
    s_waitcnt vmcnt(8)
    s_barrier
    s_cmp_lg_u32 s40, 4
    s_cbranch_scc1 L_rp_44
    s_mul_i32 s48, s43, 10
    s_bfm_b64 exec, 10, s48
    s_mov_b32 s48, 0
    s_mov_b32 s49, 1
L_poll_45:
    buffer_load_dword v58, v61, s[32:35], 0 offen offset:0 sc1
    s_add_u32 s48, s48, 1
    s_cmp_gt_u32 s48, 200000
    s_cbranch_scc1 L_pollo_46
    s_waitcnt vmcnt(0)
    v_cmp_ne_u32 vcc, s49, v58
    s_cbranch_vccnz L_poll_45
L_pollo_46:
L_polld_47:
    s_mov_b64 exec, -1
L_rp_44:
    s_barrier
    s_barrier
    s_add_u32 s57, s70, 196608
    s_add_u32 m0, s46, 131072
    s_nop 0
    buffer_load_dwordx4 v45, s[16:19], s57 offen lds
    s_add_u32 m0, s46, 139264
    s_nop 0
    buffer_load_dwordx4 v45, s[20:23], s57 offen lds
    s_add_u32 m0, s46, 147456
    s_mov_b64 exec, s[86:87]
    buffer_load_dwordx4 v47, s[16:19], s57 offen lds
    s_not_b64 exec, s[86:87]
    buffer_load_dwordx4 v47, s[20:23], s57 offen lds
    s_mov_b64 exec, -1
    s_nop 0
    s_load_dword s96, s[98:99], 640
    s_load_dword s96, s[98:99], 704
    s_load_dword s96, s[98:99], 768
    s_load_dword s96, s[98:99], 832
    s_load_dword s96, s[98:99], 896
    s_load_dword s96, s[98:99], 960
L_ld_p3:
    s_cmp_lg_u32 s40, 4
    s_cbranch_scc1 L_np_48
    s_lshr_b32 s48, s42, 4
    s_mul_i32 s48, s48, 10
    s_bfm_b64 exec, 20, s48
    s_mov_b32 s48, 0
    s_mov_b32 s49, 16843009
L_poll_49:
    buffer_load_dword v58, v61, s[32:35], 0 offen offset:512 sc1
    s_add_u32 s48, s48, 1
    s_cmp_gt_u32 s48, 200000
    s_cbranch_scc1 L_pollo_50
    s_waitcnt vmcnt(0)
    v_cmp_ne_u32 vcc, s49, v58
    s_cbranch_vccnz L_poll_49
L_pollo_50:
    s_cmp_eq_u32 s47, 0
    s_cbranch_scc1 L_polld_51
    buffer_inv sc1
    s_waitcnt vmcnt(0)
L_polld_51:
    s_mov_b64 exec, -1
L_np_48:
    s_barrier
    s_mov_b32 s56, 0
    s_add_u32 m0, s79, 49152
    s_nop 0
    buffer_load_dwordx4 v48, s[32:35], s56 offen offset:0 sc1 lds
    s_add_u32 m0, s79, 49152
    s_nop 0
    buffer_load_dwordx4 v48, s[32:35], s56 offen offset:1024 sc1 lds
    s_mov_b32 s56, 16384
    s_add_u32 m0, s79, 57344
    s_nop 0
    buffer_load_dwordx4 v48, s[32:35], s56 offen offset:0 sc1 lds
    s_add_u32 m0, s79, 57344
    s_nop 0
    buffer_load_dwordx4 v48, s[32:35], s56 offen offset:1024 sc1 lds
    s_add_u32 s57, s70, 294912
    s_add_u32 m0, s46, 135168
    s_nop 0
    buffer_load_dwordx4 v45, s[16:19], s57 offen lds
    s_mov_b32 s56, 32768
    s_add_u32 m0, s79, 65536
    s_nop 0
    buffer_load_dwordx4 v48, s[32:35], s56 offen offset:0 sc1 lds
    s_add_u32 m0, s46, 143360
    s_nop 0
    buffer_load_dwordx4 v45, s[20:23], s57 offen lds
    s_add_u32 m0, s79, 65536
    s_nop 0
    buffer_load_dwordx4 v48, s[32:35], s56 offen offset:1024 sc1 lds
    s_mov_b32 s56, 49152
    s_add_u32 m0, s79, 73728
    s_nop 0
    buffer_load_dwordx4 v48, s[32:35], s56 offen offset:0 sc1 lds
    s_add_u32 m0, s46, 151552
    s_mov_b64 exec, s[86:87]
    buffer_load_dwordx4 v47, s[16:19], s57 offen lds
    s_not_b64 exec, s[86:87]
    buffer_load_dwordx4 v47, s[20:23], s57 offen lds
    s_mov_b64 exec, -1
    s_add_u32 m0, s79, 73728
    s_nop 0
    buffer_load_dwordx4 v48, s[32:35], s56 offen offset:1024 sc1 lds
    s_load_dword s96, s[98:99], 1024
    s_load_dword s96, s[98:99], 1088
    s_waitcnt vmcnt(8)
    s_barrier
    s_lshr_b32 s48, s42, 4
    s_mul_i32 s48, s48, 10
    s_bfm_b64 s[52:53], 20, s48
    s_mov_b64 exec, s[52:53]
    buffer_load_dword v8, v61, s[32:35], 0 offen offset:516 sc1
    s_mov_b64 exec, -1
    buffer_load_dword v7, off, s[36:39], 0 offset:16 sc1
    s_add_u32 s57, s70, 393216
    s_add_u32 m0, s46, 0
    s_nop 0
    buffer_load_dwordx4 v45, s[16:19], s57 offen lds
    s_add_u32 m0, s46, 8192
    s_nop 0
    buffer_load_dwordx4 v45, s[20:23], s57 offen lds
    s_mov_b32 s56, 65536
    s_add_u32 m0, s79, 81920
    s_nop 0
    buffer_load_dwordx4 v48, s[32:35], s56 offen offset:0 sc1 lds
    s_add_u32 m0, s46, 16384
    s_mov_b64 exec, s[86:87]
    buffer_load_dwordx4 v47, s[16:19], s57 offen lds
    s_not_b64 exec, s[86:87]
    buffer_load_dwordx4 v47, s[20:23], s57 offen lds
    s_mov_b64 exec, -1
    s_add_u32 m0, s79, 81920
    s_nop 0
    buffer_load_dwordx4 v48, s[32:35], s56 offen offset:1024 sc1 lds
    s_add_u32 s57, s70, 491520
    s_add_u32 m0, s46, 4096
    s_nop 0
    buffer_load_dwordx4 v45, s[16:19], s57 offen lds
    s_mov_b32 s56, 81920
    s_add_u32 m0, s79, 90112
    s_nop 0
    buffer_load_dwordx4 v48, s[32:35], s56 offen offset:0 sc1 lds
    s_add_u32 m0, s46, 12288
    s_nop 0
    buffer_load_dwordx4 v45, s[20:23], s57 offen lds
    s_add_u32 m0, s79, 90112
    s_nop 0
    buffer_load_dwordx4 v48, s[32:35], s56 offen offset:1024 sc1 lds
    s_add_u32 m0, s46, 20480
    s_mov_b64 exec, s[86:87]
    buffer_load_dwordx4 v47, s[16:19], s57 offen lds
    s_not_b64 exec, s[86:87]
    buffer_load_dwordx4 v47, s[20:23], s57 offen lds
    s_mov_b64 exec, -1
    s_load_dword s96, s[98:99], 1152
    s_load_dword s96, s[98:99], 1216
    s_waitcnt vmcnt(14)
    s_barrier
    s_add_u32 s57, s70, 589824
    s_add_u32 m0, s46, 24576
    s_nop 0
    buffer_load_dwordx4 v45, s[16:19], s57 offen lds
    s_add_u32 m0, s46, 32768
    s_nop 0
    buffer_load_dwordx4 v45, s[20:23], s57 offen lds
    s_mov_b32 s56, 98304
    s_add_u32 m0, s79, 49152
    s_nop 0
    buffer_load_dwordx4 v48, s[32:35], s56 offen offset:0 sc1 lds
    s_add_u32 m0, s46, 40960
    s_mov_b64 exec, s[86:87]
    buffer_load_dwordx4 v47, s[16:19], s57 offen lds
    s_not_b64 exec, s[86:87]
    buffer_load_dwordx4 v47, s[20:23], s57 offen lds
    s_mov_b64 exec, -1
    s_add_u32 m0, s79, 49152
    s_nop 0
    buffer_load_dwordx4 v48, s[32:35], s56 offen offset:1024 sc1 lds
    s_add_u32 s57, s70, 688128
    s_add_u32 m0, s46, 28672
    s_nop 0
    buffer_load_dwordx4 v45, s[16:19], s57 offen lds
    s_mov_b32 s56, 114688
    s_add_u32 m0, s79, 57344
    s_nop 0
    buffer_load_dwordx4 v48, s[32:35], s56 offen offset:0 sc1 lds
    s_add_u32 m0, s46, 36864
    s_nop 0
    buffer_load_dwordx4 v45, s[20:23], s57 offen lds
    s_add_u32 m0, s79, 57344
    s_nop 0
    buffer_load_dwordx4 v48, s[32:35], s56 offen offset:1024 sc1 lds
    s_add_u32 m0, s46, 45056
    s_mov_b64 exec, s[86:87]
    buffer_load_dwordx4 v47, s[16:19], s57 offen lds
    s_not_b64 exec, s[86:87]
    buffer_load_dwordx4 v47, s[20:23], s57 offen lds
    s_mov_b64 exec, -1
    s_load_dword s96, s[98:99], 1280
    s_load_dword s96, s[98:99], 1344
    s_waitcnt vmcnt(12)
    s_barrier
    s_waitcnt vmcnt(24)
    s_mov_b32 s49, 0
L_csl_52:
    v_readfirstlane_b32 s48, v7
    s_add_u32 s49, s49, 1
    s_cmp_eq_u32 s48, 48
    s_cbranch_scc1 L_csok_53
    s_cmp_gt_u32 s49, 200000
    s_cbranch_scc1 L_csok_53
    buffer_load_dword v7, off, s[36:39], 0 offset:16 sc1
    s_waitcnt vmcnt(0)
    s_branch L_csl_52
L_csok_53:
    s_mov_b32 m0, 155648
    s_mov_b64 exec, s[76:77]
    buffer_load_dwordx4 v11, s[92:95], 0 offen sc1 lds
    s_mov_b64 exec, -1
    s_waitcnt vmcnt(26)
    s_mov_b64 exec, s[52:53]
    v_cmp_ne_u32 vcc, 0x10001, v8
    s_nop 0
    s_or_b32 s48, vcc_lo, s47
    s_mov_b64 exec, -1
    s_cbranch_scc0 L_stok_54
    s_mov_b64 exec, s[52:53]
    s_mov_b32 s48, 0
    s_mov_b32 s49, 65537
L_poll_55:
    buffer_load_dword v58, v61, s[32:35], 0 offen offset:516 sc1
    s_add_u32 s48, s48, 1
    s_cmp_gt_u32 s48, 200000
    s_cbranch_scc1 L_pollo_56
    s_waitcnt vmcnt(0)
    v_cmp_ne_u32 vcc, s49, v58
    s_cbranch_vccnz L_poll_55
L_pollo_56:
    s_cmp_eq_u32 s47, 0
    s_cbranch_scc1 L_polld_57
    buffer_inv sc1
    s_waitcnt vmcnt(0)
L_polld_57:
    s_mov_b64 exec, -1
L_stok_54:
    s_add_u32 s58, s71, 98304
    s_add_u32 m0, s46, 106496
    s_nop 0
    buffer_load_dwordx4 v46, s[92:95], s58 offen offset:0 sc1 lds
    s_mov_b32 s56, 131072
    s_add_u32 m0, s79, 65536
    s_nop 0
    buffer_load_dwordx4 v48, s[32:35], s56 offen offset:0 sc1 lds
    s_add_u32 m0, s46, 114560
    s_nop 0
    buffer_load_dwordx4 v46, s[92:95], s58 offen offset:128 sc1 lds
    s_add_u32 m0, s79, 65536
    s_nop 0
    buffer_load_dwordx4 v48, s[32:35], s56 offen offset:1024 sc1 lds
    s_add_u32 m0, s46, 122624
    s_nop 0
    buffer_load_dwordx4 v46, s[92:95], s58 offen offset:256 sc1 lds
    s_mov_b32 s59, 0
    buffer_load_dwordx2 v[20:21], v49, s[32:35], s59 offen sc1
    s_add_u32 s58, s71, 110592
    s_add_u32 m0, s46, 110592
    s_nop 0
    buffer_load_dwordx4 v46, s[92:95], s58 offen offset:0 sc1 lds
    s_mov_b32 s56, 147456
    s_add_u32 m0, s79, 73728
    s_nop 0
    buffer_load_dwordx4 v48, s[32:35], s56 offen offset:0 sc1 lds
    s_add_u32 m0, s46, 118656
    s_nop 0
    buffer_load_dwordx4 v46, s[92:95], s58 offen offset:128 sc1 lds
    s_add_u32 m0, s79, 73728
    s_nop 0
    buffer_load_dwordx4 v48, s[32:35], s56 offen offset:1024 sc1 lds
    s_add_u32 m0, s46, 126720
    s_nop 0
    buffer_load_dwordx4 v46, s[92:95], s58 offen offset:256 sc1 lds
    s_load_dword s96, s[98:99], 1408
    s_load_dword s96, s[98:99], 1472
    s_waitcnt vmcnt(12)
    s_barrier
    s_add_u32 s58, s71, 122880
    s_add_u32 m0, s46, 131072
    s_nop 0
    buffer_load_dwordx4 v46, s[92:95], s58 offen offset:0 sc1 lds
    s_mov_b32 s56, 163840
    s_add_u32 m0, s79, 81920
    s_nop 0
    buffer_load_dwordx4 v48, s[32:35], s56 offen offset:0 sc1 lds
    s_add_u32 m0, s46, 139136
    s_nop 0
    buffer_load_dwordx4 v46, s[92:95], s58 offen offset:128 sc1 lds
    s_add_u32 m0, s79, 81920
    s_nop 0
    buffer_load_dwordx4 v48, s[32:35], s56 offen offset:1024 sc1 lds
    s_add_u32 m0, s46, 147200
    s_nop 0
    buffer_load_dwordx4 v46, s[92:95], s58 offen offset:256 sc1 lds
    s_mov_b32 s59, 4096
    buffer_load_dwordx2 v[22:23], v49, s[32:35], s59 offen sc1
    s_add_u32 s58, s71, 135168
    s_add_u32 m0, s46, 135168
    s_nop 0
    buffer_load_dwordx4 v46, s[92:95], s58 offen offset:0 sc1 lds
    s_mov_b32 s56, 180224
    s_add_u32 m0, s79, 90112
    s_nop 0
    buffer_load_dwordx4 v48, s[32:35], s56 offen offset:0 sc1 lds
    s_add_u32 m0, s46, 143232
    s_nop 0
    buffer_load_dwordx4 v46, s[92:95], s58 offen offset:128 sc1 lds
    s_add_u32 m0, s79, 90112
    s_nop 0
    buffer_load_dwordx4 v48, s[32:35], s56 offen offset:1024 sc1 lds
    s_add_u32 m0, s46, 151296
    s_nop 0
    buffer_load_dwordx4 v46, s[92:95], s58 offen offset:256 sc1 lds
    s_load_dword s96, s[98:99], 1536
    s_load_dword s96, s[98:99], 1600
    s_waitcnt vmcnt(11)
    s_barrier
    s_add_u32 s58, s71, 147456
    s_add_u32 m0, s46, 0
    s_nop 0
    buffer_load_dwordx4 v46, s[92:95], s58 offen offset:0 sc1 lds
    s_mov_b32 s56, 196608
    s_add_u32 m0, s79, 49152
    s_nop 0
    buffer_load_dwordx4 v48, s[32:35], s56 offen offset:0 sc1 lds
    s_add_u32 m0, s46, 8064
    s_nop 0
    buffer_load_dwordx4 v46, s[92:95], s58 offen offset:128 sc1 lds
    s_add_u32 m0, s79, 49152
    s_nop 0
    buffer_load_dwordx4 v48, s[32:35], s56 offen offset:1024 sc1 lds
    s_add_u32 m0, s46, 16128
    s_nop 0
    s_nop 0
    buffer_load_dwordx4 v46, s[92:95], s58 offen offset:256 sc1 lds
    s_mov_b32 s59, 8192
    buffer_load_dwordx2 v[24:25], v49, s[32:35], s59 offen sc1
    s_add_u32 s58, s71, 159744
    s_add_u32 m0, s46, 4096
    s_nop 0
    buffer_load_dwordx4 v46, s[92:95], s58 offen offset:0 sc1 lds
    s_mov_b32 s56, 212992
    s_add_u32 m0, s79, 57344
    s_nop 0
    buffer_load_dwordx4 v48, s[32:35], s56 offen offset:0 sc1 lds
    s_add_u32 m0, s46, 12160
    s_nop 0
    buffer_load_dwordx4 v46, s[92:95], s58 offen offset:128 sc1 lds
    s_add_u32 m0, s79, 57344
    s_nop 0
    buffer_load_dwordx4 v48, s[32:35], s56 offen offset:1024 sc1 lds
    s_add_u32 m0, s46, 20224
    s_nop 0
    buffer_load_dwordx4 v46, s[92:95], s58 offen offset:256 sc1 lds
    s_load_dword s96, s[98:99], 1664
    s_load_dword s96, s[98:99], 1728
    s_waitcnt vmcnt(11)
    s_barrier
    s_add_u32 s58, s71, 172032
    s_add_u32 m0, s46, 24576
    s_nop 0
    buffer_load_dwordx4 v46, s[92:95], s58 offen offset:0 sc1 lds
    s_mov_b32 s56, 229376
    s_add_u32 m0, s79, 65536
    s_nop 0
    buffer_load_dwordx4 v48, s[32:35], s56 offen offset:0 sc1 lds
    s_add_u32 m0, s46, 32640
    s_nop 0
    buffer_load_dwordx4 v46, s[92:95], s58 offen offset:128 sc1 lds
    s_add_u32 m0, s79, 65536
    s_nop 0
    buffer_load_dwordx4 v48, s[32:35], s56 offen offset:1024 sc1 lds
    s_add_u32 m0, s46, 40704
    s_nop 0
    buffer_load_dwordx4 v46, s[92:95], s58 offen offset:256 sc1 lds
    s_mov_b32 s59, 12288
    buffer_load_dwordx2 v[26:27], v49, s[32:35], s59 offen sc1
    s_add_u32 s58, s71, 184320
    s_add_u32 m0, s46, 28672
    s_nop 0
    buffer_load_dwordx4 v46, s[92:95], s58 offen offset:0 sc1 lds
    s_mov_b32 s56, 245760
    s_add_u32 m0, s79, 73728
    s_nop 0
    buffer_load_dwordx4 v48, s[32:35], s56 offen offset:0 sc1 lds
    s_add_u32 m0, s46, 36736
    s_nop 0
    buffer_load_dwordx4 v46, s[92:95], s58 offen offset:128 sc1 lds
    s_mov_b32 s59, 16384
    buffer_load_dwordx2 v[28:29], v49, s[32:35], s59 offen sc1
    s_add_u32 m0, s46, 44800
    s_nop 0
    buffer_load_dwordx4 v46, s[92:95], s58 offen offset:256 sc1 lds
    s_add_u32 m0, s79, 73728
    s_nop 0
    buffer_load_dwordx4 v48, s[32:35], s56 offen offset:1024 sc1 lds
    s_load_dword s96, s[98:99], 1792
    s_load_dword s96, s[98:99], 1856
    s_waitcnt vmcnt(12)
    s_barrier
    s_add_u32 s58, s71, 196608
    s_add_u32 m0, s46, 106496
    s_nop 0
    buffer_load_dwordx4 v46, s[92:95], s58 offen offset:0 sc1 lds
    s_add_u32 m0, s46, 114560
    s_nop 0
    buffer_load_dwordx4 v46, s[92:95], s58 offen offset:128 sc1 lds
    s_mov_b32 s56, 262144
    s_add_u32 m0, s79, 81920
    s_nop 0
    buffer_load_dwordx4 v48, s[32:35], s56 offen offset:0 sc1 lds
    s_add_u32 m0, s46, 122624
    s_nop 0
    buffer_load_dwordx4 v46, s[92:95], s58 offen offset:256 sc1 lds
    s_add_u32 m0, s79, 81920
    s_nop 0
    buffer_load_dwordx4 v48, s[32:35], s56 offen offset:1024 sc1 lds
    s_add_u32 s58, s71, 208896
    s_add_u32 m0, s46, 110592
    s_nop 0
    buffer_load_dwordx4 v46, s[92:95], s58 offen offset:0 sc1 lds
    s_mov_b32 s56, 278528
    s_add_u32 m0, s79, 90112
    s_nop 0
    buffer_load_dwordx4 v48, s[32:35], s56 offen offset:0 sc1 lds
    s_add_u32 m0, s46, 118656
    s_nop 0
    buffer_load_dwordx4 v46, s[92:95], s58 offen offset:128 sc1 lds
    s_add_u32 m0, s79, 90112
    s_nop 0
    buffer_load_dwordx4 v48, s[32:35], s56 offen offset:1024 sc1 lds
    s_add_u32 m0, s46, 126720
    s_nop 0
    buffer_load_dwordx4 v46, s[92:95], s58 offen offset:256 sc1 lds
    s_waitcnt vmcnt(10)
    s_barrier
    s_add_u32 s58, s71, 221184
    s_add_u32 m0, s46, 131072
    s_nop 0
    buffer_load_dwordx4 v46, s[92:95], s58 offen offset:0 sc1 lds
    s_add_u32 m0, s46, 139136
    s_nop 0
    buffer_load_dwordx4 v46, s[92:95], s58 offen offset:128 sc1 lds
    s_mov_b32 s56, 294912
    s_add_u32 m0, s79, 49152
    s_nop 0
    buffer_load_dwordx4 v48, s[32:35], s56 offen offset:0 sc1 lds
    s_add_u32 m0, s46, 147200
    s_nop 0
    buffer_load_dwordx4 v46, s[92:95], s58 offen offset:256 sc1 lds
    s_add_u32 m0, s79, 49152
    s_nop 0
    buffer_load_dwordx4 v48, s[32:35], s56 offen offset:1024 sc1 lds
    s_add_u32 s58, s71, 233472
    s_add_u32 m0, s46, 135168
    s_nop 0
    buffer_load_dwordx4 v46, s[92:95], s58 offen offset:0 sc1 lds
    s_mov_b32 s56, 311296
    s_add_u32 m0, s79, 57344
    s_nop 0
    buffer_load_dwordx4 v48, s[32:35], s56 offen offset:0 sc1 lds
    s_add_u32 m0, s46, 143232
    s_nop 0
    buffer_load_dwordx4 v46, s[92:95], s58 offen offset:128 sc1 lds
    s_add_u32 m0, s79, 57344
    s_nop 0
    buffer_load_dwordx4 v48, s[32:35], s56 offen offset:1024 sc1 lds
    s_add_u32 m0, s46, 151296
    s_nop 0
    buffer_load_dwordx4 v46, s[92:95], s58 offen offset:256 sc1 lds
    s_waitcnt vmcnt(22)
    v_add_f32 v20, v20, v22
    v_add_f32 v21, v21, v23
    v_add_f32 v20, v20, v24
    v_add_f32 v21, v21, v25
    v_add_f32 v20, v20, v26
    v_add_f32 v21, v21, v27
    v_add_f32 v20, v20, v28
    v_add_f32 v21, v21, v29
    v_mov_b32 v22, v20
    v_mov_b32 v23, v21
    s_nop 0
    v_permlane32_swap_b32 v22, v20
    v_permlane32_swap_b32 v23, v21
    s_mov_b32 s48, 0x3acccccd
    s_mov_b32 s49, 0x3727c5ac
    v_add_f32 v20, v20, v22
    v_add_f32 v21, v21, v23
    v_mul_f32 v20, s48, v20
    v_mul_f32_e64 v21, s48, v21
    v_fma_f32 v21, -v20, v20, v21
    v_max_f32 v21, 0, v21
    v_add_f32 v26, s49, v21
    v_rsq_f32 v25, v26
    v_sub_f32 v24, 0, v20
    v_mov_b32_e64 v27, 0
    v_mul_f32 v25, 0xbfb8aa3b, v25
    ds_write_b128 v50, v[24:27]
    s_waitcnt vmcnt(10)
    s_barrier
    s_add_u32 s57, s80, 0
    s_add_u32 m0, s46, 0
    s_nop 0
    buffer_load_dwordx4 v14, s[24:27], s57 offen lds
    s_add_u32 s57, s80, 40960
    s_add_u32 m0, s46, 4096
    s_nop 0
    buffer_load_dwordx4 v14, s[24:27], s57 offen lds
    s_add_u32 s57, s81, 81920
    s_add_u32 m0, s46, 8192
    s_nop 0
    buffer_load_dwordx4 v12, s[24:27], s57 offen lds
    s_add_u32 s57, s81, 122880
    s_add_u32 m0, s46, 12288
    s_nop 0
    buffer_load_dwordx4 v12, s[24:27], s57 offen lds
    s_add_u32 s57, s80, 163840
    s_add_u32 m0, s46, 16384
    s_nop 0
    buffer_load_dwordx4 v14, s[24:27], s57 offen lds
    s_add_u32 s57, s80, 204800
    s_add_u32 m0, s46, 20480
    s_nop 0
    buffer_load_dwordx4 v14, s[24:27], s57 offen lds
    s_add_u32 s57, s80, 245760
    s_add_u32 m0, s46, 24576
    s_nop 0
    buffer_load_dwordx4 v14, s[24:27], s57 offen lds
    s_add_u32 s57, s80, 286720
    s_add_u32 m0, s46, 28672
    s_nop 0
    buffer_load_dwordx4 v14, s[24:27], s57 offen lds
    s_waitcnt vmcnt(8)
    s_barrier
    s_add_u32 s57, s81, 327680
    s_add_u32 m0, s46, 32768
    s_nop 0
    buffer_load_dwordx4 v12, s[24:27], s57 offen lds
    s_add_u32 s57, s81, 368640
    s_add_u32 m0, s46, 36864
    s_nop 0
    buffer_load_dwordx4 v12, s[24:27], s57 offen lds
    s_add_u32 s57, s80, 409600
    s_add_u32 m0, s46, 40960
    s_nop 0
    buffer_load_dwordx4 v14, s[24:27], s57 offen lds
    s_add_u32 s57, s80, 450560
    s_add_u32 m0, s46, 45056
    s_nop 0
    buffer_load_dwordx4 v14, s[24:27], s57 offen lds
    s_add_u32 s57, s80, 491520
    s_add_u32 m0, s46, 122880
    s_nop 0
    buffer_load_dwordx4 v14, s[24:27], s57 offen lds
    s_add_u32 s57, s80, 532480
    s_add_u32 m0, s46, 126976
    s_nop 0
    buffer_load_dwordx4 v14, s[24:27], s57 offen lds
    s_waitcnt lgkmcnt(0)
    s_barrier
    s_cmp_ge_u32 s42, 30
    s_cbranch_scc1 L_fin
    s_add_u32 s57, s81, 573440
    s_add_u32 m0, s46, 131072
    s_nop 0
    buffer_load_dwordx4 v12, s[24:27], s57 offen lds
    s_add_u32 s57, s81, 614400
    s_add_u32 m0, s46, 135168
    s_nop 0
    buffer_load_dwordx4 v12, s[24:27], s57 offen lds
    s_add_u32 s57, s80, 655360
    s_add_u32 m0, s46, 139264
    s_nop 0
    buffer_load_dwordx4 v14, s[24:27], s57 offen lds
    s_add_u32 s57, s80, 696320
    s_add_u32 m0, s46, 143360
    s_nop 0
    buffer_load_dwordx4 v14, s[24:27], s57 offen lds
    s_add_u32 s57, s80, 737280
    s_add_u32 m0, s46, 147456
    s_nop 0
    buffer_load_dwordx4 v14, s[24:27], s57 offen lds
    s_add_u32 s57, s80, 778240
    s_add_u32 m0, s46, 151552
    s_nop 0
    buffer_load_dwordx4 v14, s[24:27], s57 offen lds
    s_cmp_lg_u32 s40, 4
    s_cbranch_scc1 L_np_58
    s_cmp_eq_u32 s43, 1
    s_cselect_b32 s48, 32, 16
    s_cmp_eq_u32 s43, 2
    s_cselect_b32 s49, 16, 0
    s_bfm_b64 exec, s48, s49
    s_mov_b32 s48, 0
    s_mov_b32 s49, 16843009
L_poll_59:
    buffer_load_dword v58, v61, s[32:35], 0 offen offset:768 sc1
    s_add_u32 s48, s48, 1
    s_cmp_gt_u32 s48, 200000
    s_cbranch_scc1 L_pollo_60
    s_waitcnt vmcnt(0)
    v_cmp_ne_u32 vcc, s49, v58
    s_cbranch_vccnz L_poll_59
L_pollo_60:
    s_cmp_eq_u32 s47, 0
    s_cbranch_scc1 L_polld_61
    buffer_inv sc1
    s_waitcnt vmcnt(0)
L_polld_61:
    s_mov_b64 exec, -1
L_np_58:
    s_barrier
    s_mov_b32 s56, 0
    s_add_u32 m0, s75, 49152
    s_nop 0
    buffer_load_dwordx4 v15, s[32:35], s56 offen sc1 lds
    s_add_u32 m0, s75, 50176
    s_nop 0
    buffer_load_dwordx4 v16, s[32:35], s56 offen sc1 lds
    s_add_u32 m0, s75, 51200
    s_mov_b64 exec, s[76:77]
    buffer_load_dwordx4 v17, s[32:35], s56 offen sc1 lds
    s_mov_b64 exec, -1
    s_mov_b32 s56, 32768
    s_add_u32 m0, s75, 60416
    s_nop 0
    buffer_load_dwordx4 v15, s[32:35], s56 offen sc1 lds
    s_add_u32 m0, s75, 61440
    s_nop 0
    buffer_load_dwordx4 v16, s[32:35], s56 offen sc1 lds
    s_add_u32 m0, s75, 62464
    s_mov_b64 exec, s[76:77]
    buffer_load_dwordx4 v17, s[32:35], s56 offen sc1 lds
    s_mov_b64 exec, -1
    s_mov_b32 s56, 65536
    s_add_u32 m0, s75, 71680
    s_nop 0
    buffer_load_dwordx4 v15, s[32:35], s56 offen sc1 lds
    s_add_u32 m0, s75, 72704
    s_nop 0
    buffer_load_dwordx4 v16, s[32:35], s56 offen sc1 lds
    s_add_u32 m0, s75, 73728
    s_mov_b64 exec, s[76:77]
    buffer_load_dwordx4 v17, s[32:35], s56 offen sc1 lds
    s_mov_b64 exec, -1
    s_mov_b32 s56, 98304
    s_add_u32 m0, s75, 82944
    s_nop 0
    buffer_load_dwordx4 v15, s[32:35], s56 offen sc1 lds
    s_add_u32 m0, s75, 83968
L_pad13:
    s_cbranch_execz L_back
    s_nop 0
    buffer_load_dwordx4 v16, s[32:35], s56 offen sc1 lds
    s_add_u32 m0, s75, 84992
    s_mov_b64 exec, s[76:77]
    buffer_load_dwordx4 v17, s[32:35], s56 offen sc1 lds
    s_mov_b64 exec, -1
    s_waitcnt vmcnt(9)
    s_barrier
    s_mov_b32 s56, 131072
    s_add_u32 m0, s75, 94208
    s_nop 0
    buffer_load_dwordx4 v15, s[32:35], s56 offen sc1 lds
    s_add_u32 m0, s75, 95232
    s_nop 0
    buffer_load_dwordx4 v16, s[32:35], s56 offen sc1 lds
    s_add_u32 m0, s75, 96256
    s_mov_b64 exec, s[76:77]
    buffer_load_dwordx4 v17, s[32:35], s56 offen sc1 lds
    s_mov_b64 exec, -1
    s_waitcnt vmcnt(9)
    s_barrier
    s_mov_b32 s56, 163840
    s_add_u32 m0, s75, 105472
    s_nop 0
    buffer_load_dwordx4 v15, s[32:35], s56 offen sc1 lds
    s_add_u32 m0, s75, 106496
    s_nop 0
    buffer_load_dwordx4 v16, s[32:35], s56 offen sc1 lds
    s_add_u32 m0, s75, 107520
    s_mov_b64 exec, s[76:77]
    buffer_load_dwordx4 v17, s[32:35], s56 offen sc1 lds
    s_mov_b64 exec, -1
    s_waitcnt vmcnt(9)
    s_barrier
    s_mov_b32 s56, 196608
    s_add_u32 m0, s75, 49152
    s_nop 0
    buffer_load_dwordx4 v15, s[32:35], s56 offen sc1 lds
    s_add_u32 m0, s75, 50176
    s_nop 0
    buffer_load_dwordx4 v16, s[32:35], s56 offen sc1 lds
    s_add_u32 m0, s75, 51200
    s_mov_b64 exec, s[76:77]
    buffer_load_dwordx4 v17, s[32:35], s56 offen sc1 lds
    s_mov_b64 exec, -1
    s_add_u32 s57, s81, 819200
    s_add_u32 m0, s46, 0
    s_nop 0
    buffer_load_dwordx4 v12, s[24:27], s57 offen lds
    s_add_u32 s57, s81, 860160
    s_add_u32 m0, s46, 4096
    s_nop 0
    buffer_load_dwordx4 v12, s[24:27], s57 offen lds
    s_waitcnt vmcnt(11)
    s_barrier
    s_mov_b32 s56, 229376
    s_add_u32 m0, s75, 60416
    s_nop 0
    buffer_load_dwordx4 v15, s[32:35], s56 offen sc1 lds
    s_add_u32 m0, s75, 61440
    s_nop 0
    buffer_load_dwordx4 v16, s[32:35], s56 offen sc1 lds
    s_add_u32 m0, s75, 62464
    s_mov_b64 exec, s[76:77]
    buffer_load_dwordx4 v17, s[32:35], s56 offen sc1 lds
    s_mov_b64 exec, -1
    s_add_u32 s57, s80, 901120
    s_add_u32 m0, s46, 8192
    s_nop 0
    buffer_load_dwordx4 v14, s[24:27], s57 offen lds
    s_add_u32 s57, s80, 942080
    s_add_u32 m0, s46, 12288
    s_nop 0
    buffer_load_dwordx4 v14, s[24:27], s57 offen lds
    s_waitcnt vmcnt(13)
    s_barrier
    s_mov_b32 s56, 262144
    s_add_u32 m0, s75, 71680
    s_nop 0
    buffer_load_dwordx4 v15, s[32:35], s56 offen sc1 lds
    s_add_u32 m0, s75, 72704
    s_nop 0
    buffer_load_dwordx4 v16, s[32:35], s56 offen sc1 lds
    s_add_u32 m0, s75, 73728
    s_mov_b64 exec, s[76:77]
    buffer_load_dwordx4 v17, s[32:35], s56 offen sc1 lds
    s_mov_b64 exec, -1
    s_add_u32 s57, s80, 983040
    s_add_u32 m0, s46, 16384
    s_nop 0
    buffer_load_dwordx4 v14, s[24:27], s57 offen lds
    s_add_u32 s57, s80, 1024000
    s_add_u32 m0, s46, 20480
    s_nop 0
    buffer_load_dwordx4 v14, s[24:27], s57 offen lds
    s_waitcnt vmcnt(15)
    s_barrier
    s_mov_b32 s56, 294912
    s_add_u32 m0, s75, 82944
    s_nop 0
    buffer_load_dwordx4 v15, s[32:35], s56 offen sc1 lds
    s_add_u32 m0, s75, 83968
    s_nop 0
    buffer_load_dwordx4 v16, s[32:35], s56 offen sc1 lds
    s_add_u32 m0, s75, 84992
    s_mov_b64 exec, s[76:77]
    buffer_load_dwordx4 v17, s[32:35], s56 offen sc1 lds
    s_mov_b64 exec, -1
    s_add_u32 s57, s81, 1064960
    s_add_u32 m0, s46, 24576
    s_nop 0
    buffer_load_dwordx4 v12, s[24:27], s57 offen lds
    s_add_u32 s57, s81, 1105920
    s_add_u32 m0, s46, 28672
    s_nop 0
    buffer_load_dwordx4 v12, s[24:27], s57 offen lds
    s_waitcnt vmcnt(17)
    s_barrier
    s_mov_b32 s56, 327680
    s_add_u32 m0, s75, 94208
    s_nop 0
    buffer_load_dwordx4 v15, s[32:35], s56 offen sc1 lds
    s_add_u32 m0, s75, 95232
    s_nop 0
    buffer_load_dwordx4 v16, s[32:35], s56 offen sc1 lds
    s_add_u32 m0, s75, 96256
    s_mov_b64 exec, s[76:77]
    buffer_load_dwordx4 v17, s[32:35], s56 offen sc1 lds
    s_mov_b64 exec, -1
    s_waitcnt vmcnt(15)
    s_barrier
    s_mov_b32 s56, 360448
    s_add_u32 m0, s75, 105472
    s_nop 0
    buffer_load_dwordx4 v15, s[32:35], s56 offen sc1 lds
    s_add_u32 m0, s75, 106496
    s_nop 0
    buffer_load_dwordx4 v16, s[32:35], s56 offen sc1 lds
    s_add_u32 m0, s75, 107520
    s_mov_b64 exec, s[76:77]
    buffer_load_dwordx4 v17, s[32:35], s56 offen sc1 lds
    s_mov_b64 exec, -1
    s_add_u32 s57, s80, 1146880
    s_add_u32 m0, s46, 32768
    s_nop 0
    buffer_load_dwordx4 v14, s[24:27], s57 offen lds
    s_add_u32 s57, s80, 1187840
    s_add_u32 m0, s46, 36864
    s_nop 0
    buffer_load_dwordx4 v14, s[24:27], s57 offen lds
    s_waitcnt vmcnt(15)
    s_barrier
    s_mov_b32 s56, 393216
    s_add_u32 m0, s75, 49152
    s_nop 0
    buffer_load_dwordx4 v15, s[32:35], s56 offen sc1 lds
    s_add_u32 m0, s75, 50176
    s_nop 0
    buffer_load_dwordx4 v16, s[32:35], s56 offen sc1 lds
    s_add_u32 m0, s75, 51200
    s_mov_b64 exec, s[76:77]
    buffer_load_dwordx4 v17, s[32:35], s56 offen sc1 lds
    s_mov_b64 exec, -1
    s_add_u32 s57, s80, 1228800
    s_add_u32 m0, s46, 40960
    s_nop 0
    buffer_load_dwordx4 v14, s[24:27], s57 offen lds
    s_add_u32 s57, s80, 1269760
    s_add_u32 m0, s46, 45056
    s_nop 0
    buffer_load_dwordx4 v14, s[24:27], s57 offen lds
    s_waitcnt vmcnt(15)
    s_barrier
    s_mov_b32 s56, 425984
    s_add_u32 m0, s75, 60416
    s_nop 0
    buffer_load_dwordx4 v15, s[32:35], s56 offen sc1 lds
    s_add_u32 m0, s75, 61440
    s_nop 0
    buffer_load_dwordx4 v16, s[32:35], s56 offen sc1 lds
    s_add_u32 m0, s75, 62464
    s_mov_b64 exec, s[76:77]
    buffer_load_dwordx4 v17, s[32:35], s56 offen sc1 lds
    s_mov_b64 exec, -1
    s_add_u32 s57, s81, 1310720
    s_add_u32 m0, s46, 122880
    s_nop 0
    buffer_load_dwordx4 v12, s[24:27], s57 offen lds
    s_add_u32 s57, s81, 1351680
    s_add_u32 m0, s46, 126976
    s_nop 0
    buffer_load_dwordx4 v12, s[24:27], s57 offen lds
    s_waitcnt vmcnt(15)
    s_barrier
    s_mov_b32 s56, 458752
    s_add_u32 m0, s75, 71680
    s_nop 0
    buffer_load_dwordx4 v15, s[32:35], s56 offen sc1 lds
    s_add_u32 m0, s75, 72704
    s_nop 0
    buffer_load_dwordx4 v16, s[32:35], s56 offen sc1 lds
    s_add_u32 m0, s75, 73728
    s_mov_b64 exec, s[76:77]
    buffer_load_dwordx4 v17, s[32:35], s56 offen sc1 lds
    s_mov_b64 exec, -1
    s_waitcnt vmcnt(15)
    s_barrier
    s_mov_b32 s56, 491520
    s_add_u32 m0, s75, 82944
    s_nop 0
    buffer_load_dwordx4 v15, s[32:35], s56 offen sc1 lds
    s_add_u32 m0, s75, 83968
    s_nop 0
    buffer_load_dwordx4 v16, s[32:35], s56 offen sc1 lds
    s_add_u32 m0, s75, 84992
    s_mov_b64 exec, s[76:77]
    buffer_load_dwordx4 v17, s[32:35], s56 offen sc1 lds
    s_mov_b64 exec, -1
    s_add_u32 s57, s80, 1392640
    s_add_u32 m0, s46, 131072
    s_nop 0
    buffer_load_dwordx4 v14, s[24:27], s57 offen lds
    s_add_u32 s57, s80, 1433600
    s_add_u32 m0, s46, 135168
    s_nop 0
    buffer_load_dwordx4 v14, s[24:27], s57 offen lds
    s_waitcnt vmcnt(15)
    s_barrier
    s_mov_b32 s56, 524288
    s_add_u32 m0, s75, 94208
    s_nop 0
    buffer_load_dwordx4 v15, s[32:35], s56 offen sc1 lds
    s_add_u32 m0, s75, 95232
    s_nop 0
    buffer_load_dwordx4 v16, s[32:35], s56 offen sc1 lds
    s_add_u32 m0, s75, 96256
    s_mov_b64 exec, s[76:77]
    buffer_load_dwordx4 v17, s[32:35], s56 offen sc1 lds
    s_mov_b64 exec, -1
    s_add_u32 s57, s80, 1474560
    s_add_u32 m0, s46, 139264
    s_nop 0
    buffer_load_dwordx4 v14, s[24:27], s57 offen lds
    s_add_u32 s57, s80, 1515520
    s_add_u32 m0, s46, 143360
    s_nop 0
    buffer_load_dwordx4 v14, s[24:27], s57 offen lds
    s_waitcnt vmcnt(15)
    s_barrier
    s_mov_b32 s56, 557056
    s_add_u32 m0, s75, 105472
    s_nop 0
    buffer_load_dwordx4 v15, s[32:35], s56 offen sc1 lds
    s_add_u32 m0, s75, 106496
    s_nop 0
    buffer_load_dwordx4 v16, s[32:35], s56 offen sc1 lds
    s_add_u32 m0, s75, 107520
    s_mov_b64 exec, s[76:77]
    buffer_load_dwordx4 v17, s[32:35], s56 offen sc1 lds
    s_mov_b64 exec, -1
    s_add_u32 s57, s81, 1556480
    s_add_u32 m0, s46, 147456
    s_nop 0
    buffer_load_dwordx4 v12, s[24:27], s57 offen lds
    s_add_u32 s57, s81, 1597440
    s_add_u32 m0, s46, 151552
    s_nop 0
    buffer_load_dwordx4 v12, s[24:27], s57 offen lds
    s_waitcnt vmcnt(15)
    s_barrier
    s_mov_b32 s56, 589824
    s_add_u32 m0, s75, 49152
    s_nop 0
    buffer_load_dwordx4 v15, s[32:35], s56 offen sc1 lds
    s_add_u32 m0, s75, 50176
    s_nop 0
    buffer_load_dwordx4 v16, s[32:35], s56 offen sc1 lds
    s_add_u32 m0, s75, 51200
    s_mov_b64 exec, s[76:77]
    buffer_load_dwordx4 v17, s[32:35], s56 offen sc1 lds
    s_mov_b64 exec, -1
    s_add_u32 s57, s80, 1638400
    s_add_u32 m0, s46, 0
    s_nop 0
    buffer_load_dwordx4 v14, s[24:27], s57 offen lds
    s_add_u32 s57, s80, 1679360
    s_add_u32 m0, s46, 4096
    s_nop 0
    buffer_load_dwordx4 v14, s[24:27], s57 offen lds
    s_waitcnt vmcnt(17)
    s_barrier
    s_mov_b32 s56, 622592
    s_add_u32 m0, s75, 60416
    s_nop 0
    buffer_load_dwordx4 v15, s[32:35], s56 offen sc1 lds
    s_add_u32 m0, s75, 61440
    s_nop 0
    buffer_load_dwordx4 v16, s[32:35], s56 offen sc1 lds
    s_add_u32 m0, s75, 62464
    s_mov_b64 exec, s[76:77]
    buffer_load_dwordx4 v17, s[32:35], s56 offen sc1 lds
    s_mov_b64 exec, -1
    s_waitcnt vmcnt(15)
    s_barrier
    s_mov_b32 s56, 655360
    s_add_u32 m0, s75, 71680
    s_nop 0
    buffer_load_dwordx4 v15, s[32:35], s56 offen sc1 lds
    s_add_u32 m0, s75, 72704
    s_nop 0
    buffer_load_dwordx4 v16, s[32:35], s56 offen sc1 lds
    s_add_u32 m0, s75, 73728
    s_mov_b64 exec, s[76:77]
    buffer_load_dwordx4 v17, s[32:35], s56 offen sc1 lds
    s_mov_b64 exec, -1
    s_add_u32 s57, s80, 1720320
    s_add_u32 m0, s46, 8192
    s_nop 0
    buffer_load_dwordx4 v14, s[24:27], s57 offen lds
    s_add_u32 s57, s80, 1761280
    s_add_u32 m0, s46, 12288
    s_nop 0
    buffer_load_dwordx4 v14, s[24:27], s57 offen lds
    s_waitcnt vmcnt(15)
    s_barrier
    s_mov_b32 s56, 688128
    s_add_u32 m0, s75, 82944
    s_nop 0
    buffer_load_dwordx4 v15, s[32:35], s56 offen sc1 lds
    s_add_u32 m0, s75, 83968
    s_nop 0
    buffer_load_dwordx4 v16, s[32:35], s56 offen sc1 lds
    s_add_u32 m0, s75, 84992
    s_mov_b64 exec, s[76:77]
    buffer_load_dwordx4 v17, s[32:35], s56 offen sc1 lds
    s_mov_b64 exec, -1
    s_add_u32 s57, s81, 1802240
    s_add_u32 m0, s46, 16384
    s_nop 0
    buffer_load_dwordx4 v12, s[24:27], s57 offen lds
    s_add_u32 s57, s81, 1843200
    s_add_u32 m0, s46, 20480
    s_nop 0
    buffer_load_dwordx4 v12, s[24:27], s57 offen lds
    s_waitcnt vmcnt(15)
    s_barrier
    s_mov_b32 s56, 720896
    s_add_u32 m0, s75, 94208
    s_nop 0
    buffer_load_dwordx4 v15, s[32:35], s56 offen sc1 lds
    s_add_u32 m0, s75, 95232
    s_nop 0
    buffer_load_dwordx4 v16, s[32:35], s56 offen sc1 lds
    s_add_u32 m0, s75, 96256
    s_mov_b64 exec, s[76:77]
    buffer_load_dwordx4 v17, s[32:35], s56 offen sc1 lds
    s_mov_b64 exec, -1
    s_add_u32 s57, s80, 1884160
    s_add_u32 m0, s46, 24576
    s_nop 0
    buffer_load_dwordx4 v14, s[24:27], s57 offen lds
    s_add_u32 s57, s80, 1925120
    s_add_u32 m0, s46, 28672
    s_nop 0
    buffer_load_dwordx4 v14, s[24:27], s57 offen lds
    s_waitcnt vmcnt(15)
    s_barrier
    s_mov_b32 s56, 753664
    s_add_u32 m0, s75, 105472
    s_nop 0
    buffer_load_dwordx4 v15, s[32:35], s56 offen sc1 lds
    s_add_u32 m0, s75, 106496
    s_nop 0
    buffer_load_dwordx4 v16, s[32:35], s56 offen sc1 lds
    s_add_u32 m0, s75, 107520
    s_mov_b64 exec, s[76:77]
    buffer_load_dwordx4 v17, s[32:35], s56 offen sc1 lds
    s_mov_b64 exec, -1
    s_waitcnt vmcnt(15)
    s_barrier
    s_waitcnt vmcnt(10)
    s_barrier
    s_waitcnt vmcnt(5)
    s_barrier
    s_waitcnt vmcnt(0)
    s_barrier
L_fin:
L_end:
    s_endpgm
.section .rodata,"a"
.p2align 6
.amdhsa_kernel sequential_preLN__sliding_local_dilated__glu_gated_swiglu__prompt_kernel
  .amdhsa_next_free_vgpr 256
  .amdhsa_next_free_sgpr 102
  .amdhsa_accum_offset 256
  .amdhsa_group_segment_fixed_size 0
  .amdhsa_kernarg_size 80
  .amdhsa_user_sgpr_count 2
  .amdhsa_user_sgpr_kernarg_segment_ptr 1
  .amdhsa_system_sgpr_workgroup_id_x 1
  .amdhsa_float_denorm_mode_32 3
.end_amdhsa_kernel
```
